```python
import torch

def _softmax(x, axis=-1):
    return torch.softmax(x, dim=axis)
def _gelu(x):
    return torch.nn.functional.gelu(x, approximate="tanh")
def _silu(x):
    return torch.nn.functional.silu(x)
def _sigmoid(x):
    return torch.sigmoid(x)
def _layernorm(x, axis=-1, eps=1e-5):
    m = x.mean(dim=axis, keepdim=True)
    v = x.var(dim=axis, keepdim=True, unbiased=False)
    return (x - m) / torch.sqrt(v + eps)
def _scatter_add(tgt, idx, src, axis=0):
    return tgt.clone().index_add_(axis, idx, src)
def _segment_sum(src, seg, n):
    out = torch.zeros((n,) + src.shape[1:], dtype=src.dtype)
    return out.index_add_(0, seg, src)
def _pad(x, pw):
    flat = tuple(v for pair in reversed(pw) for v in pair)
    return torch.nn.functional.pad(x, flat)

kernel_name = 'interleave_layers__spectral_gfnet__glu_gated_bilinear__prompt'

def setup_inputs():

    _w = (lambda a: (lambda t: t.to(torch.bfloat16) if t.is_floating_point() else t)(torch.as_tensor(a)))
    def _A_setup():
        B, S, D = 1, 2048, 1024
        Df = D // 2 + 1
        return {
            "x": _w((lambda *s: torch.randn(*s, dtype=torch.bfloat16) * 0.05)(B, S, D)),
            "w_r": _w((lambda *s: torch.randn(*s, dtype=torch.bfloat16) * 0.4)(S, Df) * 0.02),
            "w_i": _w((lambda *s: torch.randn(*s, dtype=torch.bfloat16) * 0.4)(S, Df) * 0.02),
        }
    _A_in = _A_setup()

    def _B_setup():
        B, S, D, F = 1, 2048, 1024, 3584
        return {
            "x": _w((lambda *s: torch.randn(*s, dtype=torch.bfloat16) * 0.05)(B, S, D)),
            "w_gate": _w((lambda *s: torch.randn(*s, dtype=torch.bfloat16) * 0.2)(D, F) * (D ** -0.5)),
            "w_up": _w((lambda *s: torch.randn(*s, dtype=torch.bfloat16) * 0.2)(D, F) * (D ** -0.5)),
            "w_down": _w((lambda *s: torch.randn(*s, dtype=torch.bfloat16) * 0.2)(F, D) * (F ** -0.5)),
        }
    _B_in = _B_setup()

    return {
        "A_x": _A_in["x"],
        "A_w_r": _A_in["w_r"],
        "A_w_i": _A_in["w_i"],
        "B_x": _B_in["x"],
        "B_w_gate": _B_in["w_gate"],
        "B_w_up": _B_in["w_up"],
        "B_w_down": _B_in["w_down"],
    }

def reference(A_x, A_w_r, A_w_i, B_x, B_w_gate, B_w_up, B_w_down):
    def _A_ref(x, w_r, w_i):
        B, S, D = x.shape
        X = (lambda x, axes=(-2,-1): torch.fft.rfft2(x.float(), dim=axes))(x, axes=(-2, -1))
        W = w_r + 1j * w_i
        X = X * W
        y = (lambda x, s, axes=(-2,-1): torch.fft.irfft2(x, s=s, dim=axes).to(torch.bfloat16))(X, (S, D), axes=(-2, -1))
        return y

    def _B_ref(x, w_gate, w_up, w_down):
        g = torch.einsum("bsd,df->bsf", x, w_gate)
        u = torch.einsum("bsd,df->bsf", x, w_up)
        h = g * u
        return torch.einsum("bsf,fd->bsd", h, w_down)

    x = A_x
    x = x + _A_ref(_layernorm(x, axis=-1), A_w_r, A_w_i)
    x = x + _B_ref(_layernorm(x, axis=-1), B_w_gate, B_w_up, B_w_down)
    x = x + _A_ref(_layernorm(x, axis=-1), A_w_r, A_w_i)
    x = x + _B_ref(_layernorm(x, axis=-1), B_w_gate, B_w_up, B_w_down)
    return x
```

```asm
; @launch grid=(256,1,1) block=(256,1,1) lds=163840
.amdgcn_target "amdgcn-amd-amdhsa--gfx950"
.text
.globl interleave_layers__spectral_gfnet__glu_gated_bilinear__prompt_kernel
.p2align 8
.type interleave_layers__spectral_gfnet__glu_gated_bilinear__prompt_kernel,@function
interleave_layers__spectral_gfnet__glu_gated_bilinear__prompt_kernel:
    s_cmp_ge_u32 s2, 256
    s_cbranch_scc1 L_end
    s_load_dwordx4 s[60:63], s[0:1], 0
    s_load_dwordx2 s[64:65], s[0:1], 16
    s_load_dwordx8 s[68:75], s[0:1], 32
    s_load_dwordx4 s[76:79], s[0:1], 64
    s_getpc_b64 s[66:67]
L_pc:
    v_lshlrev_b32 v25, 7, v0
    v_min_u32 v25, (L_g1t-L_pc), v25
    global_load_dword a254, v25, s[66:67]
    v_lshrrev_b32 v17, 6, v0
    v_and_b32 v0, 63, v0
    v_readfirstlane_b32 s41, v17
    v_and_b32 v1, 15, v0
    v_lshrrev_b32 v2, 4, v0
    v_lshlrev_b32 v16, 7, v0
    s_and_b32 s56, s2, 7
    s_lshr_b32 s57, s2, 3
    s_lshl_b32 s40, s56, 5
    s_add_u32 s40, s40, s57
    s_and_b32 s47, s56, 1
    s_lshr_b32 s56, s56, 1
    s_lshr_b32 s58, s56, 1
    s_lshl_b32 s58, s58, 2
    s_and_b32 s59, s57, 3
    s_add_u32 s43, s59, s58
    s_lshr_b32 s57, s57, 2
    s_and_b32 s58, s56, 1
    s_lshl_b32 s58, s58, 3
    s_lshl_b32 s44, s47, 4
    s_add_u32 s44, s44, s58
    s_add_u32 s44, s44, s57
    s_lshl_b32 s45, s56, 2
    s_add_u32 s45, s45, s59
    s_mov_b32 s46, s57
    s_lshr_b32 s57, s2, 3
    s_bfe_u32 s56, s2, 0x20001
    s_and_b32 s43, s57, 7
    s_lshr_b32 s57, s57, 3
    s_lshl_b32 s44, s47, 4
    s_add_u32 s44, s44, s57
    s_lshl_b32 s56, s56, 2
    s_add_u32 s44, s44, s56
    s_mov_b32 s42, 0
    s_mov_b32 s48, 0
    s_lshl_b32 s53, s41, 12
    v_lshlrev_b32 v240, 3, v1
    v_lshl_add_u32 v240, v2, 9, v240
    v_lshlrev_b32_e64 v17, 4, v0
    v_mov_b64 v[20:21], 0
    v_mov_b64 v[22:23], 0
    s_waitcnt lgkmcnt(0)
    s_mov_b32 s8, s60
    s_mov_b32 s9, s61
    s_mov_b32 s10, 0x400000
    s_mov_b32 s11, 0x20000
    s_add_u32 s28, s78, 0x4800000
    s_addc_u32 s29, s79, 0
    s_mov_b32 s30, 0x48000
    s_mov_b32 s31, 0x20000
    s_sub_u32 s54, s2, 8
    s_cmp_ge_u32 s54, 4
    s_cbranch_scc1 L_interlea_nz1
    s_lshl_b32 s56, s54, 13
    s_lshl_b32 s57, s41, 11
    s_add_u32 s56, s56, s57
    buffer_store_dwordx4 v[20:23], v17, s[28:31], s56 offen offset:0 sc1
    buffer_store_dwordx4 v[20:23], v17, s[28:31], s56 offen offset:1024 sc1
L_interlea_nz1:
    s_lshl_b32 s56, s41, 20
    s_lshl_b32 s57, s40, 11
    s_add_u32 s56, s56, s57
    buffer_load_dwordx2 v[32:33], v240, s[8:11], s56 offen offset:0
    buffer_load_dwordx2 v[36:37], v240, s[8:11], s56 offen offset:128
    buffer_load_dwordx2 v[34:35], v240, s[8:11], s56 offen offset:256
    buffer_load_dwordx2 v[38:39], v240, s[8:11], s56 offen offset:384
    s_add_u32 s56, s56, 0x80000
    buffer_load_dwordx2 v[40:41], v240, s[8:11], s56 offen offset:0
    buffer_load_dwordx2 v[44:45], v240, s[8:11], s56 offen offset:128
    buffer_load_dwordx2 v[42:43], v240, s[8:11], s56 offen offset:256
    buffer_load_dwordx2 v[46:47], v240, s[8:11], s56 offen offset:384
    s_mov_b32 s4, s78
    s_mov_b32 s5, s79
    s_mov_b32 s6, 0x2400000
    s_mov_b32 s7, 0x20000
    s_mov_b32 s12, s68
    s_mov_b32 s13, s69
    s_mov_b32 s14, 0x700000
    s_mov_b32 s15, 0x20000
    s_sub_u32 s16, s70, 2048
    s_subb_u32 s17, s71, 0
    s_mov_b32 s18, 0x700800
    s_mov_b32 s19, 0x20000
    s_sub_u32 s20, s72, 3072
    s_subb_u32 s21, s73, 0
    s_mov_b32 s22, 0x700c00
    s_mov_b32 s23, 0x20000
    s_mov_b32 s24, s74
    s_mov_b32 s25, s75
    s_mov_b32 s26, 0x400000
    s_mov_b32 s27, 0x20000
    s_lshl_b32 s56, s2, 10
    s_lshl_b32 s57, s41, 8
    s_add_u32 s56, s56, s57
    s_add_u32 s56, s56, 0x8000
    s_mov_b32 exec_lo, 0xffff
    s_mov_b32 exec_hi, 0x0
    buffer_store_dwordx4 v[20:23], v17, s[28:31], s56 offen sc1
    s_mov_b64 exec, -1
    s_lshr_b32 s56, s40, 5
    s_and_b32 s57, s40, 31
    s_lshl_b32 s80, s57, 4
    s_sub_u32 s59, 1010, s80
    s_cmp_ge_u32 s41, 2
    s_cselect_b32 s80, s59, s80
    s_cselect_b32 s59, -1, 0
    s_cselect_b32 s58, 508, 0
    s_bitcmp1_b32 s41, 0
    s_cselect_b32 s32, s64, s62
    s_cselect_b32 s33, s65, s63
    s_mov_b32 s34, 0x201000
    s_mov_b32 s35, 0x20000
    s_lshl_b32 s81, s57, 6
    s_add_u32 s81, s81, s56
    v_and_b32 v17, 56, v0
    v_add_u32 v17, s81, v17
    v_xor_b32 v17, s59, v17
    v_subrev_u32 v17, s59, v17
    v_and_b32 v17, 2047, v17
    v_mul_u32_u24 v17, 1026, v17
    v_and_b32 v18, 7, v0
    v_lshlrev_b32 v18, 7, v18
    v_min_u32 v18, 514, v18
    v_add3_u32 v214, v17, v18, s58
    buffer_load_dword a255, v214, s[32:35], 0 offen
    v_lshlrev_b32 v17, 3, v1
    v_lshl_add_u32 v17, v2, 9, v17
    v_add_u32 v17, s56, v17
    v_add_u32 v208, 0, v17
    v_xor_b32 v208, s59, v208
    v_subrev_u32 v208, s59, v208
    v_and_b32 v208, 2047, v208
    v_mul_u32_u24 v208, 1026, v208
    v_add_u32 v209, 128, v17
    v_xor_b32 v209, s59, v209
    v_subrev_u32 v209, s59, v209
    v_and_b32 v209, 2047, v209
    v_mul_u32_u24 v209, 1026, v209
    v_add_u32 v210, 256, v17
    v_xor_b32 v210, s59, v210
    v_subrev_u32 v210, s59, v210
    v_and_b32 v210, 2047, v210
    v_mul_u32_u24 v210, 1026, v210
    v_add_u32 v211, 384, v17
    v_xor_b32 v211, s59, v211
    v_subrev_u32 v211, s59, v211
    v_and_b32 v211, 2047, v211
    v_mul_u32_u24 v211, 1026, v211
    s_and_b32 s56, s41, 2
    s_add_u32 s56, s56, 0
    s_lshl_b32 s56, s56, 7
    v_add_u32 v212, s56, v17
    v_mul_u32_u24 v212, 1026, v212
    v_add_u32 v212, 512, v212
    s_and_b32 s56, s41, 2
    s_add_u32 s56, s56, 1
    s_lshl_b32 s56, s56, 7
    v_add_u32 v213, s56, v17
    v_mul_u32_u24 v213, 1026, v213
    v_add_u32 v213, 512, v213
    v_lshl_add_u32 v20, v2, 2, 0
    v_mul_u32_u24 v19, v1, v20
    v_cvt_f32_u32 v30, v19
    v_mul_f32 v30, 0x3d800000, v30
    v_fract_f32 v30, v30
    v_cos_f32 v17, v30
    v_sin_f32 v18, v30
    v_mul_f32 v17, 0x3f910000, v17
    v_mul_f32 v18, 0x3f910000, v18
    v_cvt_pk_bf16_f32 v29, v17, v18
    v_accvgpr_write_b32 a176, v29
    v_cvt_pk_bf16_f32 v29, -v18, v17
    v_accvgpr_write_b32 a180, v29
    v_cvt_pk_bf16_f32 v29, v17, -v18
    v_accvgpr_write_b32 a184, v29
    v_cvt_pk_bf16_f32 v29, v18, v17
    v_accvgpr_write_b32 a188, v29
    v_lshl_add_u32 v21, v19, 1, v1
    v_cvt_f32_u32 v30, v21
    v_mul_f32 v30, 0x3d000000, v30
    v_fract_f32 v30, v30
    v_cos_f32 v17, v30
    v_sin_f32 v18, v30
    v_mul_f32 v17, 0x3f910000, v17
    v_mul_f32 v18, 0x3f910000, v18
    v_cvt_pk_bf16_f32 v29, v17, v18
    v_accvgpr_write_b32 a192, v29
    v_cvt_pk_bf16_f32 v29, -v18, v17
    v_accvgpr_write_b32 a196, v29
    v_cvt_pk_bf16_f32 v29, -v17, -v18
    v_accvgpr_write_b32 a200, v29
    v_cvt_pk_bf16_f32 v29, v18, -v17
    v_accvgpr_write_b32 a204, v29
    v_lshl_add_u32 v20, v2, 2, 1
    v_mul_u32_u24 v19, v1, v20
    v_cvt_f32_u32 v30, v19
    v_mul_f32 v30, 0x3d800000, v30
    v_fract_f32 v30, v30
    v_cos_f32 v17, v30
    v_sin_f32_e64 v18, v30
    v_mul_f32 v17, 0x3f910000, v17
    v_mul_f32 v18, 0x3f910000, v18
    v_cvt_pk_bf16_f32 v29, v17, v18
    v_accvgpr_write_b32 a177, v29
    v_cvt_pk_bf16_f32 v29, -v18, v17
    v_accvgpr_write_b32 a181, v29
    v_cvt_pk_bf16_f32 v29, v17, -v18
    v_accvgpr_write_b32 a185, v29
    v_cvt_pk_bf16_f32 v29, v18, v17
    v_accvgpr_write_b32 a189, v29
    v_lshl_add_u32 v21, v19, 1, v1
    v_cvt_f32_u32 v30, v21
    v_mul_f32 v30, 0x3d000000, v30
    v_fract_f32 v30, v30
    v_cos_f32 v17, v30
    v_sin_f32 v18, v30
    v_mul_f32 v17, 0x3f910000, v17
    v_mul_f32 v18, 0x3f910000, v18
    v_cvt_pk_bf16_f32 v29, v17, v18
    v_accvgpr_write_b32 a193, v29
    v_cvt_pk_bf16_f32 v29, -v18, v17
    v_accvgpr_write_b32 a197, v29
    v_cvt_pk_bf16_f32 v29, -v17, -v18
    v_accvgpr_write_b32 a201, v29
    v_cvt_pk_bf16_f32 v29, v18, -v17
    v_accvgpr_write_b32 a205, v29
    v_lshl_add_u32 v20, v2, 2, 2
    v_mul_u32_u24 v19, v1, v20
    v_cvt_f32_u32 v30, v19
    v_mul_f32 v30, 0x3d800000, v30
    v_fract_f32 v30, v30
    v_cos_f32 v17, v30
    v_sin_f32_e64 v18, v30
    v_mul_f32 v17, 0x3f910000, v17
    v_mul_f32 v18, 0x3f910000, v18
    v_cvt_pk_bf16_f32 v29, v17, v18
    v_accvgpr_write_b32 a178, v29
    v_cvt_pk_bf16_f32 v29, -v18, v17
    v_accvgpr_write_b32 a182, v29
    v_cvt_pk_bf16_f32 v29, v17, -v18
    v_accvgpr_write_b32 a186, v29
    v_cvt_pk_bf16_f32 v29, v18, v17
    v_accvgpr_write_b32 a190, v29
    v_lshl_add_u32 v21, v19, 1, v1
    v_cvt_f32_u32 v30, v21
    v_mul_f32 v30, 0x3d000000, v30
    v_fract_f32 v30, v30
    v_cos_f32 v17, v30
    v_sin_f32 v18, v30
    v_mul_f32 v17, 0x3f910000, v17
    v_mul_f32 v18, 0x3f910000, v18
    v_cvt_pk_bf16_f32 v29, v17, v18
    v_accvgpr_write_b32 a194, v29
    v_cvt_pk_bf16_f32 v29, -v18, v17
    v_accvgpr_write_b32 a198, v29
    v_cvt_pk_bf16_f32 v29, -v17, -v18
    v_accvgpr_write_b32 a202, v29
    v_cvt_pk_bf16_f32 v29, v18, -v17
    v_accvgpr_write_b32 a206, v29
    v_lshl_add_u32 v20, v2, 2, 3
    v_mul_u32_u24 v19, v1, v20
    v_cvt_f32_u32 v30, v19
    v_mul_f32 v30, 0x3d800000, v30
    v_fract_f32 v30, v30
    v_cos_f32 v17, v30
    v_sin_f32_e64 v18, v30
    v_mul_f32 v17, 0x3f910000, v17
    v_mul_f32 v18, 0x3f910000, v18
    v_cvt_pk_bf16_f32 v29, v17, v18
    v_accvgpr_write_b32 a179, v29
    v_cvt_pk_bf16_f32 v29, -v18, v17
    v_accvgpr_write_b32 a183, v29
    v_cvt_pk_bf16_f32 v29, v17, -v18
    v_accvgpr_write_b32 a187, v29
    v_cvt_pk_bf16_f32 v29, v18, v17
    v_accvgpr_write_b32 a191, v29
    v_lshl_add_u32 v21, v19, 1, v1
    v_cvt_f32_u32 v30, v21
    v_mul_f32 v30, 0x3d000000, v30
    v_fract_f32 v30, v30
    v_cos_f32 v17, v30
    v_sin_f32 v18, v30
    v_mul_f32 v17, 0x3f910000, v17
    v_mul_f32 v18, 0x3f910000, v18
    v_cvt_pk_bf16_f32 v29, v17, v18
    v_accvgpr_write_b32 a195, v29
    v_cvt_pk_bf16_f32 v29, -v18, v17
    v_accvgpr_write_b32 a199, v29
    v_cvt_pk_bf16_f32 v29, -v17, -v18
    v_accvgpr_write_b32 a203, v29
    v_cvt_pk_bf16_f32 v29, v18, -v17
    v_accvgpr_write_b32 a207, v29
    v_and_b32 v22, 1, v1
    v_cvt_f32_u32 v23, v22
    v_mul_f32 v23, 0x3e800000, v23
    v_lshrrev_b32 v24, 1, v1
    v_lshl_add_u32 v20, v2, 1, 0
    v_lshlrev_b32 v19, 8, v20
    v_add_u32 v19, s40, v19
    v_mul_u32_u24 v19, v19, v24
    v_cvt_f32_u32 v30, v19
    v_mul_f32 v30, 0x3a000000, v30
    v_add_f32 v30, v23, v30
    v_fract_f32 v30, v30
    v_cos_f32 v17, v30
    v_sin_f32 v18, v30
    s_nop 0
    v_cvt_pk_bf16_f32 v29, v17, v18
    v_accvgpr_write_b32 a224, v29
    v_cvt_pk_bf16_f32 v29, v17, -v18
    v_accvgpr_write_b32 a226, v29
    v_lshl_add_u32 v20, v2, 1, 1
    v_lshlrev_b32 v19, 8, v20
    v_add_u32 v19, s40, v19
    v_mul_u32_u24 v19, v19, v24
    v_cvt_f32_u32 v30, v19
    v_mul_f32 v30, 0x3a000000, v30
    v_add_f32 v30, v23, v30
    v_fract_f32 v30, v30
    v_cos_f32 v17, v30
    v_sin_f32_e64 v18, v30
    s_nop 0
    v_cvt_pk_bf16_f32 v29, v17, v18
    v_accvgpr_write_b32 a225, v29
    v_cvt_pk_bf16_f32 v29, v17, -v18
    v_accvgpr_write_b32 a227, v29
    v_mov_b32 v254, 0
L_layer:
    v_lshlrev_b32 v240, 3, v1
    v_lshl_add_u32 v240, v2, 9, v240
    v_lshl_add_u32 v17, v2, 3, 0
    v_mul_u32_u24 v17, v17, v1
    v_cvt_f32_u32 v30, v17
    v_mul_f32 v30, 0x3b000000, v30
    v_fract_f32 v30, v30
    v_cos_f32 v96, v30
    v_sin_f32 v100, v30
    v_lshl_add_u32 v17, v2, 3, 2
    v_mul_u32_u24 v17, v17, v1
    v_cvt_f32_u32 v30, v17
    v_mul_f32 v30, 0x3b000000, v30
    v_fract_f32 v30, v30
    v_cos_f32 v97, v30
    v_sin_f32 v101, v30
    v_lshl_add_u32 v17, v2, 3, 4
    v_mul_u32_u24 v17, v17, v1
    v_cvt_f32_u32 v30, v17
    v_mul_f32 v30, 0x3b000000, v30
    v_fract_f32 v30, v30
    v_cos_f32 v98, v30
    v_sin_f32 v102, v30
    v_lshl_add_u32 v17, v2, 3, 6
    v_mul_u32_u24 v17, v17, v1
    v_cvt_f32_u32 v30, v17
    v_mul_f32 v30, 0x3b000000, v30
    v_fract_f32 v30, v30
    v_cos_f32 v99, v30
    v_sin_f32 v103, v30
    v_lshl_add_u32 v17, v2, 3, 1
    v_mul_u32_u24 v17, v17, v1
    v_cvt_f32_u32 v30, v17
    v_mul_f32 v30, 0x3b000000, v30
    v_fract_f32 v30, v30
    v_cos_f32 v104, v30
    v_sin_f32 v108, v30
    v_lshl_add_u32 v17, v2, 3, 3
    v_mul_u32_u24 v17, v17, v1
    v_cvt_f32_u32 v30, v17
    v_mul_f32 v30, 0x3b000000, v30
    v_fract_f32 v30, v30
    v_cos_f32 v105, v30
    v_sin_f32 v109, v30
    v_lshl_add_u32 v17, v2, 3, 5
    v_mul_u32_u24 v17, v17, v1
    v_cvt_f32_u32 v30, v17
    v_mul_f32 v30, 0x3b000000, v30
    v_fract_f32 v30, v30
    v_cos_f32 v106, v30
    v_sin_f32 v110, v30
    v_lshl_add_u32 v17, v2, 3, 7
    v_mul_u32_u24 v17, v17, v1
    v_cvt_f32_u32 v30, v17
    v_mul_f32 v30, 0x3b000000, v30
    v_fract_f32 v30, v30
    v_cos_f32 v107, v30
    v_sin_f32 v111, v30
    s_lshl_b32 s56, s41, 9
    v_lshlrev_b32 v243, 12, v2
    v_add_u32 v243, 0x10000, v243
    v_lshl_add_u32 v244, v1, 4, s56
    v_add_u32 v241, v243, v244
    v_sub_u32 v242, v243, v244
    v_add_u32 v242, 3832, v242
    v_cmp_eq_u32 vcc, 0, v244
    v_add_u32 v243, 1784, v243
    s_nop 0
    v_cndmask_b32 v243, v242, v243, vcc
    v_lshlrev_b32 v244, 3, v1
    v_lshl_add_u32 v244, v2, 9, v244
    s_add_u32 s56, s53, 0x10000
    v_add_u32 v244, s56, v244
    v_cmp_eq_u32 vcc, 0, v1
    s_nop 1
    v_cndmask_b32 v245, 0, 1.0, vcc
    v_lshlrev_b32 v246, 12, v2
    v_lshl_add_u32 v246, v1, 4, v246
    s_cmp_lg_u32 s42, 0
    s_cbranch_scc1 L_p1b
    s_waitcnt vmcnt(2)
    s_cmp_ge_u32 s54, 4
    s_cbranch_scc1 L_interlea_rep2
    s_barrier
    s_cmp_lg_u32 s41, 0
    s_cbranch_scc1 L_interlea_rep2
    s_lshl_b32 s56, s54, 6
    v_mov_b32 v18, 1
    v_lshl_add_u32 v17, v0, 2, s56
    s_mov_b32 exec_lo, 0xffff
    s_mov_b32 exec_hi, 0x0
    global_store_dword v17, v18, s[76:77] sc1
    s_mov_b64 exec, -1
L_interlea_rep2:
    v_swap_b32 v33, v36
    v_swap_b32 v35, v38
    v_swap_b32 v41, v44
    v_swap_b32 v43, v46
    v_mfma_f32_16x16x32_bf16 v[64:67], v[32:35], a[176:179], 0
    v_mfma_f32_16x16x32_bf16 v[68:71], v[32:35], a[180:183], 0
    v_mfma_f32_16x16x32_bf16 v[72:75], v[36:39], a[176:179], 0
    v_mfma_f32_16x16x32_bf16 v[76:79], v[36:39], a[180:183], 0
    v_mfma_f32_16x16x32_bf16 v[80:83], v[40:43], a[176:179], 0
    v_mfma_f32_16x16x32_bf16 v[84:87], v[40:43], a[180:183], 0
    v_mfma_f32_16x16x32_bf16 v[88:91], v[44:47], a[176:179], 0
    v_mfma_f32_16x16x32_bf16 v[92:95], v[44:47], a[180:183], 0
    s_add_u32 m0, s53, 0x20000
    s_nop 0
    buffer_load_dwordx4 v208, s[32:35], s80 offen lds
    s_add_u32 m0, s53, 0x20400
    s_nop 0
    buffer_load_dwordx4 v209, s[32:35], s80 offen lds
    s_branch L_p1
L_last:
    v_lshlrev_b32 v240, 3, v1
    v_lshl_add_u32 v240, v2, 9, v240
    v_lshlrev_b32 v64, 16, v32
    v_and_b32 v68, 0xffff0000, v32
    v_lshlrev_b32 v65, 16, v33
    v_and_b32 v69, 0xffff0000, v33
    v_lshlrev_b32 v66, 16, v34
    v_and_b32 v70, 0xffff0000, v34
    v_lshlrev_b32 v67, 16, v35
    v_and_b32 v71, 0xffff0000, v35
    v_lshlrev_b32 v72, 16, v36
    v_and_b32 v76, 0xffff0000, v36
    v_lshlrev_b32 v73, 16, v37
    v_and_b32 v77, 0xffff0000, v37
    v_lshlrev_b32 v74, 16, v38
    v_and_b32 v78, 0xffff0000, v38
    v_lshlrev_b32 v75, 16, v39
    v_and_b32 v79, 0xffff0000, v39
    v_lshlrev_b32 v80, 16, v40
    v_and_b32 v84, 0xffff0000, v40
    v_lshlrev_b32 v81, 16, v41
    v_and_b32 v85, 0xffff0000, v41
    v_lshlrev_b32 v82, 16, v42
    v_and_b32 v86, 0xffff0000, v42
    v_lshlrev_b32 v83, 16, v43
    v_and_b32 v87, 0xffff0000, v43
    v_lshlrev_b32 v88, 16, v44
    v_and_b32 v92, 0xffff0000, v44
    v_lshlrev_b32 v89, 16, v45
    v_and_b32 v93, 0xffff0000, v45
    v_lshlrev_b32 v90, 16, v46
    v_and_b32 v94, 0xffff0000, v46
    v_lshlrev_b32 v91, 16, v47
    v_and_b32 v95, 0xffff0000, v47
    v_add_f32 v64, s94, v64
    v_add_f32 v65, s94, v65
    v_add_f32 v66, s94, v66
    v_add_f32 v67, s94, v67
    v_add_f32 v68, s94, v68
    v_add_f32 v69, s94, v69
    v_add_f32 v70, s94, v70
    v_add_f32 v71, s94, v71
    v_add_f32 v72, s94, v72
    v_add_f32 v73, s94, v73
    v_add_f32 v74, s94, v74
    v_add_f32 v75, s94, v75
    v_add_f32 v76, s94, v76
    v_add_f32 v77, s94, v77
    v_add_f32 v78, s94, v78
    v_add_f32 v79, s94, v79
    v_add_f32 v80, s95, v80
    v_add_f32 v81, s95, v81
    v_add_f32 v82, s95, v82
    v_add_f32 v83, s95, v83
    v_add_f32 v84, s95, v84
    v_add_f32 v85, s95, v85
    v_add_f32 v86, s95, v86
    v_add_f32 v87, s95, v87
    v_add_f32 v88, s95, v88
    v_add_f32 v89, s95, v89
    v_add_f32 v90, s95, v90
    v_add_f32 v91, s95, v91
    v_add_f32 v92, s95, v92
    v_add_f32 v93, s95, v93
    v_add_f32 v94, s95, v94
    v_add_f32_e64 v95, s95, v95
    s_branch L_p1c
L_p1b:
    v_mfma_f32_16x16x32_bf16 v[64:67], v[32:35], a[176:179], 0
    v_mfma_f32_16x16x32_bf16 v[68:71], v[32:35], a[180:183], 0
    v_mfma_f32_16x16x32_bf16 v[72:75], v[36:39], a[176:179], 0
    v_mfma_f32_16x16x32_bf16 v[76:79], v[36:39], a[180:183], 0
    v_mfma_f32_16x16x32_bf16 v[80:83], v[40:43], a[176:179], 0
    v_mfma_f32_16x16x32_bf16 v[84:87], v[40:43], a[180:183], 0
    v_mfma_f32_16x16x32_bf16 v[88:91], v[44:47], a[176:179], 0
    v_mfma_f32_16x16x32_bf16 v[92:95], v[44:47], a[180:183], 0
L_p1c:
    v_lshrrev_b32 v247, 2, v1
    v_lshl_add_u32 v247, v2, 3, v247
    v_lshlrev_b32 v247, 10, v247
    v_and_b32 v17, 3, v0
    v_lshl_add_u32 v247, v17, 4, v247
    s_lshr_b32 s56, s40, 1
    s_lshl_b32 s56, s56, 15
    s_and_b32 s57, s40, 1
    s_lshl_b32 s57, s57, 9
    s_add_u32 s56, s56, s57
    s_lshl_b32 s57, s41, 7
    s_add_u32 s84, s56, s57
    s_add_u32 s85, s84, 4096
    s_add_u32 s86, s84, 0x400000
    s_add_u32 s87, s84, 0x401000
    s_lshr_b32 s57, s40, 4
    s_add_u32 s56, s48, 0xffff8000
    s_lshl_b32 s57, s57, 11
    s_add_u32 s56, s56, s57
    s_and_b32 s57, s40, 3
    s_mul_i32 s39, s57, 256
    s_add_u32 s39, s39, s56
    s_mov_b32 s57, s45
    s_add_u32 s56, s48, 0xffff8000
    s_lshl_b32 s57, s57, 11
    s_add_u32 s56, s56, s57
    s_lshl_b32 s59, s47, 7
    s_add_u32 s59, s59, s56
    v_mul_u32_u24 v17, 2, v16
    v_mov_b32 v18, 1
    s_cmp_eq_u32 s41, 0
    s_cselect_b32 s58, 0, 0x80000000
    v_or_b32 v17, s58, v17
    s_mov_b32 exec_lo, 0xf
    s_mov_b32 exec_hi, 0x0
    s_waitcnt vmcnt(0)
    s_barrier
    buffer_atomic_add v18, v17, s[28:31], s59 offen sc1
    s_mov_b64 exec, -1
    s_cmp_lg_u32 s41, 0
    s_cbranch_scc1 L_interlea_oth3
    s_mov_b32 s58, 0
    s_mov_b32 exec_lo, 0x3
    s_mov_b32 exec_hi, 0x0
L_interlea_pa4:
    v_mov_b32 v28, 0
    buffer_atomic_add v28, v16, s[28:31], s39 offen sc0 sc1
    s_add_u32 s58, s58, 1
    s_waitcnt vmcnt(0)
    v_cmp_ne_u32 vcc, 8, v28
    s_cmp_ge_u32 s58, 0x40000
    s_cbranch_scc1 L_interlea_pb5
    s_bitcmp1_b32 vcc_lo, 0
    s_cbranch_scc1 L_interlea_pa4
L_interlea_pb5:
    s_barrier
    s_cbranch_vccz L_interlea_pd7
L_interlea_pc6:
    v_mov_b32_e64 v28, 0
    buffer_atomic_add v28, v16, s[28:31], s39 offen sc0 sc1
    s_add_u32 s58, s58, 1
    s_waitcnt vmcnt(0)
    v_cmp_ne_u32 vcc, 8, v28
    s_cmp_ge_u32 s58, 0x40000
    s_cbranch_scc1 L_interlea_pd7
    s_cbranch_vccnz L_interlea_pc6
L_interlea_pd7:
    s_barrier
    s_mov_b64 exec, -1
    buffer_load_dwordx4 v[48:51], v247, s[8:11], s84 offen offset:0
    buffer_load_dwordx4 v[52:55], v247, s[8:11], s85 offen offset:0
    buffer_load_dwordx4 v[56:59], v247, s[8:11], s84 offen offset:64
    buffer_load_dwordx4 v[60:63], v247, s[8:11], s85 offen offset:64
    s_branch L_interlea_pj8
L_interlea_oth3:
    s_barrier
    buffer_load_dwordx4 v[48:51], v247, s[8:11], s84 offen offset:0
    buffer_load_dwordx4 v[52:55], v247, s[8:11], s85 offen offset:0
    buffer_load_dwordx4 v[56:59], v247, s[8:11], s84 offen offset:64
    buffer_load_dwordx4 v[60:63], v247, s[8:11], s85 offen offset:64
    s_barrier
L_interlea_pj8:
    buffer_load_dwordx4 v[208:211], v247, s[8:11], s86 offen offset:0
    buffer_load_dwordx4 v[212:215], v247, s[8:11], s87 offen offset:0
    buffer_load_dwordx4 v[216:219], v247, s[8:11], s86 offen offset:64
    buffer_load_dwordx4 v[220:223], v247, s[8:11], s87 offen offset:64
    s_cmp_eq_u32 s42, 2
    s_cbranch_scc1 L_final
    s_waitcnt vmcnt(4)
    v_swap_b32 v49, v52
    v_swap_b32 v51, v54
    v_swap_b32 v57, v60
    v_swap_b32 v59, v62
    v_mfma_f32_16x16x32_bf16 v[160:163], v[48:51], a[176:179], 0
    v_mfma_f32_16x16x32_bf16 v[164:167], v[48:51], a[180:183], 0
    v_mfma_f32_16x16x32_bf16 v[168:171], v[52:55], a[176:179], 0
    v_mfma_f32_16x16x32_bf16 v[172:175], v[52:55], a[180:183], 0
    v_mfma_f32_16x16x32_bf16 v[176:179], v[56:59], a[176:179], 0
    v_mfma_f32_16x16x32_bf16 v[180:183], v[56:59], a[180:183], 0
    v_mfma_f32_16x16x32_bf16 v[184:187], v[60:63], a[176:179], 0
    v_mfma_f32_16x16x32_bf16 v[188:191], v[60:63], a[180:183], 0
    s_waitcnt vmcnt(2)
    v_swap_b32 v209, v212
    v_swap_b32 v211, v214
    s_nop 1
    v_mfma_f32_16x16x32_bf16 v[160:163], v[208:211], a[176:179], v[160:163]
    v_mfma_f32_16x16x32_bf16 v[164:167], v[208:211], a[180:183], v[164:167]
    v_mfma_f32_16x16x32_bf16 v[168:171], v[212:215], a[176:179], v[168:171]
    v_mfma_f32_16x16x32_bf16 v[172:175], v[212:215], a[180:183], v[172:175]
    s_waitcnt vmcnt(0)
    v_swap_b32 v217, v220
    v_swap_b32 v219, v222
    s_nop 1
    v_mfma_f32_16x16x32_bf16 v[176:179], v[216:219], a[176:179], v[176:179]
    v_mfma_f32_16x16x32_bf16 v[180:183], v[216:219], a[180:183], v[180:183]
    v_mfma_f32_16x16x32_bf16 v[184:187], v[220:223], a[176:179], v[184:187]
    v_mfma_f32_16x16x32_bf16 v[188:191], v[220:223], a[180:183], v[188:191]
    v_pk_fma_f32 v[64:65], v[160:161], s[92:93], v[64:65] op_sel:[0,0,0] op_sel_hi:[1,0,1]
    v_pk_fma_f32 v[66:67], v[162:163], s[92:93], v[66:67] op_sel:[0,0,0] op_sel_hi:[1,0,1]
    v_pk_fma_f32 v[68:69], v[164:165], s[92:93], v[68:69] op_sel:[0,0,0] op_sel_hi:[1,0,1]
    v_pk_fma_f32 v[70:71], v[166:167], s[92:93], v[70:71] op_sel:[0,0,0] op_sel_hi:[1,0,1]
    v_pk_fma_f32 v[72:73], v[168:169], s[92:93], v[72:73] op_sel:[0,0,0] op_sel_hi:[1,0,1]
    v_pk_fma_f32 v[74:75], v[170:171], s[92:93], v[74:75] op_sel:[0,0,0] op_sel_hi:[1,0,1]
    v_pk_fma_f32 v[76:77], v[172:173], s[92:93], v[76:77] op_sel:[0,0,0] op_sel_hi:[1,0,1]
    v_pk_fma_f32 v[78:79], v[174:175], s[92:93], v[78:79] op_sel:[0,0,0] op_sel_hi:[1,0,1]
    v_pk_fma_f32 v[80:81], v[176:177], s[92:93], v[80:81] op_sel:[0,1,0] op_sel_hi:[1,1,1]
    v_pk_fma_f32 v[82:83], v[178:179], s[92:93], v[82:83] op_sel:[0,1,0] op_sel_hi:[1,1,1]
    v_pk_fma_f32 v[84:85], v[180:181], s[92:93], v[84:85] op_sel:[0,1,0] op_sel_hi:[1,1,1]
    v_pk_fma_f32 v[86:87], v[182:183], s[92:93], v[86:87] op_sel:[0,1,0] op_sel_hi:[1,1,1]
    v_pk_fma_f32 v[88:89], v[184:185], s[92:93], v[88:89] op_sel:[0,1,0] op_sel_hi:[1,1,1]
    v_pk_fma_f32 v[90:91], v[186:187], s[92:93], v[90:91] op_sel:[0,1,0] op_sel_hi:[1,1,1]
    v_pk_fma_f32 v[92:93], v[188:189], s[92:93], v[92:93] op_sel:[0,1,0] op_sel_hi:[1,1,1]
    v_pk_fma_f32 v[94:95], v[190:191], s[92:93], v[94:95] op_sel:[0,1,0] op_sel_hi:[1,1,1]
L_p1:
    v_pk_mul_f32 v[148:149], v[64:65], v[64:65]
    v_pk_mul_f32 v[150:151], v[80:81], v[80:81]
    v_pk_fma_f32 v[148:149], v[66:67], v[66:67], v[148:149]
    v_pk_add_f32 v[144:145], v[64:65], v[66:67]
    v_pk_fma_f32 v[150:151], v[82:83], v[82:83], v[150:151]
    v_pk_add_f32 v[146:147], v[80:81], v[82:83]
    v_pk_fma_f32 v[148:149], v[68:69], v[68:69], v[148:149]
    v_pk_add_f32 v[144:145], v[144:145], v[68:69]
    v_pk_fma_f32 v[150:151], v[84:85], v[84:85], v[150:151]
    v_pk_add_f32 v[146:147], v[146:147], v[84:85]
    v_pk_fma_f32 v[148:149], v[70:71], v[70:71], v[148:149]
    v_pk_add_f32 v[144:145], v[144:145], v[70:71]
    v_pk_fma_f32 v[150:151], v[86:87], v[86:87], v[150:151]
    v_pk_add_f32 v[146:147], v[146:147], v[86:87]
    v_pk_fma_f32 v[148:149], v[72:73], v[72:73], v[148:149]
    v_pk_add_f32 v[144:145], v[144:145], v[72:73]
    v_pk_fma_f32 v[150:151], v[88:89], v[88:89], v[150:151]
    v_pk_add_f32 v[146:147], v[146:147], v[88:89]
    v_pk_fma_f32 v[148:149], v[74:75], v[74:75], v[148:149]
    v_pk_add_f32 v[144:145], v[144:145], v[74:75]
    v_pk_fma_f32 v[150:151], v[90:91], v[90:91], v[150:151]
    v_pk_add_f32 v[146:147], v[146:147], v[90:91]
    v_pk_fma_f32 v[148:149], v[76:77], v[76:77], v[148:149]
    v_pk_add_f32 v[144:145], v[144:145], v[76:77]
    v_pk_fma_f32 v[150:151], v[92:93], v[92:93], v[150:151]
    v_pk_add_f32 v[146:147], v[146:147], v[92:93]
    v_pk_fma_f32 v[148:149], v[78:79], v[78:79], v[148:149]
    v_pk_add_f32 v[144:145], v[144:145], v[78:79]
    v_pk_fma_f32 v[150:151], v[94:95], v[94:95], v[150:151]
    v_pk_add_f32 v[146:147], v[146:147], v[94:95]
    v_add_f32 v144, v144, v145
    v_add_f32 v146, v146, v147
    v_add_f32 v148, v148, v149
    v_add_f32 v150, v150, v151
    v_mul_f32 v144, v245, v144
    v_mul_f32 v146, v245, v146
    v_pk_mul_f32 v[160:161], v[64:65], v[96:97]
    v_pk_mul_f32 v[164:165], v[68:69], v[96:97]
    v_permlane16_swap_b32 v144, v146
    v_pk_mul_f32 v[162:163], v[66:67], v[98:99]
    v_pk_mul_f32 v[166:167], v[70:71], v[98:99]
    v_permlane16_swap_b32 v148, v150
    v_add_f32 v144, v144, v146
    v_add_f32 v148, v148, v150
    v_pk_fma_f32 v[160:161], v[68:69], v[100:101], v[160:161]
    v_pk_fma_f32 v[164:165], v[64:65], v[100:101], v[164:165] neg_lo:[1,0,0] neg_hi:[1,0,0]
    v_permlane32_swap_b32 v144, v148
    v_add_f32 v148, v144, v148
    v_pk_fma_f32 v[162:163], v[70:71], v[102:103], v[162:163]
    v_pk_fma_f32 v[166:167], v[66:67], v[102:103], v[166:167] neg_lo:[1,0,0] neg_hi:[1,0,0]
    v_add_f32_dpp v148, v148, v148 row_ror:8 row_mask:0xf bank_mask:0xf
    v_pk_mul_f32 v[176:177], v[80:81], v[96:97]
    v_pk_mul_f32 v[180:181], v[84:85], v[96:97]
    v_add_f32_dpp v148, v148, v148 row_ror:4 row_mask:0xf bank_mask:0xf
    v_pk_mul_f32 v[178:179], v[82:83], v[98:99]
    v_pk_mul_f32 v[182:183], v[86:87], v[98:99]
    v_add_f32_dpp v148, v148, v148 row_ror:2 row_mask:0xf bank_mask:0xf
    v_pk_fma_f32 v[176:177], v[84:85], v[100:101], v[176:177]
    v_pk_fma_f32 v[180:181], v[80:81], v[100:101], v[180:181] neg_lo:[1,0,0] neg_hi:[1,0,0]
    v_add_f32_dpp v148, v148, v148 row_ror:1 row_mask:0xf bank_mask:0xf
    v_mov_b32 v144, v148
    v_pk_fma_f32 v[178:179], v[86:87], v[102:103], v[178:179]
    v_pk_fma_f32 v[182:183], v[82:83], v[102:103], v[182:183] neg_lo:[1,0,0] neg_hi:[1,0,0]
    v_permlane32_swap_b32 v144, v148
    v_mul_f32 v144, 0x3a61fc78, v144
    v_mul_f32 v148, 0x38477dc4, v148
    v_fma_f32 v148, -v144, v144, v148
    v_max_f32 v148, 0, v148
    v_add_f32 v148, 0x3727c5ac, v148
    v_rsq_f32 v148, v148
    v_mov_b32 v252, v144
    v_mul_f32 v144, 0xc1910000, v144
    v_mul_f32 v144, v144, v148
    v_pk_mul_f32 v[168:169], v[72:73], v[104:105]
    v_pk_mul_f32 v[172:173], v[76:77], v[104:105]
    v_readlane_b32 s84, v148, 0
    v_readlane_b32 s85, v144, 0
    v_readlane_b32 s86, v148, 16
    v_readlane_b32 s87, v144, 16
    v_pk_mul_f32 v[170:171], v[74:75], v[106:107]
    v_pk_mul_f32 v[174:175], v[78:79], v[106:107]
    v_mul_f32 v248, s85, v245
    v_mul_f32 v250, s87, v245
    v_pk_fma_f32 v[168:169], v[76:77], v[108:109], v[168:169]
    v_pk_fma_f32 v[172:173], v[72:73], v[108:109], v[172:173] neg_lo:[1,0,0] neg_hi:[1,0,0]
    v_pk_fma_f32 v[170:171], v[78:79], v[110:111], v[170:171]
    v_pk_fma_f32 v[174:175], v[74:75], v[110:111], v[174:175] neg_lo:[1,0,0] neg_hi:[1,0,0]
    v_pk_mul_f32 v[184:185], v[88:89], v[104:105]
    v_pk_mul_f32 v[188:189], v[92:93], v[104:105]
    v_pk_mul_f32 v[186:187], v[90:91], v[106:107]
    v_pk_mul_f32 v[190:191], v[94:95], v[106:107]
    v_pk_fma_f32 v[184:185], v[92:93], v[108:109], v[184:185]
    v_pk_fma_f32 v[188:189], v[88:89], v[108:109], v[188:189] neg_lo:[1,0,0] neg_hi:[1,0,0]
    v_pk_fma_f32 v[186:187], v[94:95], v[110:111], v[186:187]
    v_pk_fma_f32 v[190:191], v[90:91], v[110:111], v[190:191] neg_lo:[1,0,0] neg_hi:[1,0,0]
    v_pk_fma_f32 v[160:161], v[160:161], s[84:85], v[248:249] op_sel_hi:[1,0,0]
    v_pk_fma_f32 v[162:163], v[162:163], s[84:85], v[248:249] op_sel_hi:[1,0,0]
    v_pk_fma_f32 v[164:165], v[164:165], s[84:85], v[248:249] op_sel_hi:[1,0,0]
    v_pk_fma_f32 v[166:167], v[166:167], s[84:85], v[248:249] op_sel_hi:[1,0,0]
    v_pk_fma_f32 v[176:177], v[176:177], s[86:87], v[250:251] op_sel_hi:[1,0,0]
    v_pk_fma_f32 v[178:179], v[178:179], s[86:87], v[250:251] op_sel_hi:[1,0,0]
    v_pk_fma_f32 v[180:181], v[180:181], s[86:87], v[250:251] op_sel_hi:[1,0,0]
    v_pk_fma_f32 v[182:183], v[182:183], s[86:87], v[250:251] op_sel_hi:[1,0,0]
    v_pk_fma_f32 v[168:169], v[168:169], s[84:85], v[248:249] op_sel_hi:[1,0,0]
    v_pk_fma_f32 v[170:171], v[170:171], s[84:85], v[248:249] op_sel_hi:[1,0,0]
    v_pk_fma_f32 v[172:173], v[172:173], s[84:85], v[248:249] op_sel_hi:[1,0,0]
    v_pk_fma_f32 v[174:175], v[174:175], s[84:85], v[248:249] op_sel_hi:[1,0,0]
    v_pk_fma_f32 v[184:185], v[184:185], s[86:87], v[250:251] op_sel_hi:[1,0,0]
    v_pk_fma_f32 v[186:187], v[186:187], s[86:87], v[250:251] op_sel_hi:[1,0,0]
    v_pk_fma_f32 v[188:189], v[188:189], s[86:87], v[250:251] op_sel_hi:[1,0,0]
    v_pk_fma_f32 v[190:191], v[190:191], s[86:87], v[250:251] op_sel_hi:[1,0,0]
    v_cvt_pk_bf16_f32 v112, v160, v164
    v_cvt_pk_bf16_f32 v113, v161, v165
    v_cvt_pk_bf16_f32 v114, v162, v166
    v_cvt_pk_bf16_f32 v115, v163, v167
    v_cvt_pk_bf16_f32 v120, v176, v180
    v_cvt_pk_bf16_f32 v121, v177, v181
    v_mfma_f32_16x16x32_bf16 v[64:67], a[176:179], v[112:115], 0
    v_cvt_pk_bf16_f32 v122, v178, v182
    v_cvt_pk_bf16_f32 v123, v179, v183
    v_mfma_f32_16x16x32_bf16 v[68:71], a[180:183], v[112:115], 0
    v_cvt_pk_bf16_f32 v116, v168, v172
    v_cvt_pk_bf16_f32 v117, v169, v173
    v_mfma_f32_16x16x32_bf16 v[80:83], a[176:179], v[120:123], 0
    v_cvt_pk_bf16_f32 v118, v170, v174
    v_cvt_pk_bf16_f32 v119, v171, v175
    v_mfma_f32_16x16x32_bf16 v[84:87], a[180:183], v[120:123], 0
    v_cvt_pk_bf16_f32 v124, v184, v188
    v_cvt_pk_bf16_f32 v125, v185, v189
    v_mfma_f32_16x16x32_bf16 v[72:75], a[200:203], v[116:119], v[64:67]
    v_cvt_pk_bf16_f32 v126, v186, v190
    v_cvt_pk_bf16_f32 v127, v187, v191
    v_mfma_f32_16x16x32_bf16 v[76:79], a[204:207], v[116:119], v[68:71]
    s_nop 0
    v_mfma_f32_16x16x32_bf16 v[88:91], a[200:203], v[124:127], v[80:83]
    v_mfma_f32_16x16x32_bf16 v[92:95], a[204:207], v[124:127], v[84:87]
    v_mfma_f32_16x16x32_bf16 v[64:67], a[192:195], v[116:119], v[64:67]
    v_mfma_f32_16x16x32_bf16 v[68:71], a[196:199], v[116:119], v[68:71]
    v_mfma_f32_16x16x32_bf16 v[80:83], a[192:195], v[124:127], v[80:83]
    v_mfma_f32_16x16x32_bf16 v[84:87], a[196:199], v[124:127], v[84:87]
    s_nop 0
    v_cvt_pk_bf16_f32 v200, v72, v76
    v_cvt_pk_bf16_f32 v202, v73, v77
    v_cvt_pk_bf16_f32 v204, v74, v78
    v_cvt_pk_bf16_f32 v206, v75, v79
    v_cvt_pk_bf16_f32 v201, v88, v92
    ds_write_b64 v244, v[200:201] offset:2048
    v_cvt_pk_bf16_f32 v203, v89, v93
    ds_write_b64 v244, v[202:203] offset:2176
    v_cvt_pk_bf16_f32 v205, v90, v94
    ds_write_b64 v244, v[204:205] offset:2304
    v_cvt_pk_bf16_f32 v207, v91, v95
    ds_write_b64 v244, v[206:207] offset:2432
    v_cvt_pk_bf16_f32 v192, v64, v68
    v_cvt_pk_bf16_f32 v194, v65, v69
    v_cvt_pk_bf16_f32 v196, v66, v70
    v_cvt_pk_bf16_f32 v198, v67, v71
    v_cvt_pk_bf16_f32 v193, v80, v84
    ds_write_b64 v244, v[192:193] offset:0
    v_cvt_pk_bf16_f32 v195, v81, v85
    ds_write_b64 v244, v[194:195] offset:128
    v_cvt_pk_bf16_f32 v197, v82, v86
    ds_write_b64 v244, v[196:197] offset:256
    v_cvt_pk_bf16_f32 v199, v83, v87
    ds_write_b64 v244, v[198:199] offset:384
    s_waitcnt lgkmcnt(0)
    s_barrier
    ds_read_b128 v[144:147], v241 offset:0
    ds_read_b64 v[148:149], v243 offset:264
    ds_read_b64 v[150:151], v242 offset:256
    ds_read_b128 v[152:155], v241 offset:256
    ds_read_b64 v[156:157], v242 offset:8
    ds_read_b64 v[158:159], v242 offset:0
    s_lshl_b32 s56, s40, 14
    s_lshl_b32 s57, s41, 9
    s_add_u32 s56, s56, s57
    s_waitcnt lgkmcnt(5)
    v_mfma_f32_16x16x16_bf16 v[64:67], a[224:225], v[144:145], 0
    v_mfma_f32_16x16x16_bf16 v[68:71], a[224:225], v[146:147], 0
    s_waitcnt lgkmcnt(4)
    v_mfma_f32_16x16x16_bf16 v[72:75], a[226:227], v[148:149], 0
    s_waitcnt lgkmcnt(3)
    v_mfma_f32_16x16x16_bf16 v[76:79], a[226:227], v[150:151], 0
    s_waitcnt lgkmcnt(2)
    v_mfma_f32_16x16x16_bf16 v[80:83], a[224:225], v[152:153], 0
    s_nop 0
    v_cvt_pk_bf16_f32 v192, v64, v65
    v_cvt_pk_bf16_f32 v196, v66, v67
    v_mfma_f32_16x16x16_bf16 v[84:87], a[224:225], v[154:155], 0
    v_cvt_pk_bf16_f32 v193, v68, v69
    v_cvt_pk_bf16_f32 v197, v70, v71
    s_waitcnt lgkmcnt(1)
    v_mfma_f32_16x16x16_bf16 v[88:91], a[226:227], v[156:157], 0
    v_cvt_pk_bf16_f32 v194, v72, v73
    v_cvt_pk_bf16_f32 v198, v74, v75
    s_waitcnt lgkmcnt(0)
    v_mfma_f32_16x16x16_bf16 v[92:95], a[226:227], v[158:159], 0
    v_cvt_pk_bf16_f32 v195, v76, v77
    v_cvt_pk_bf16_f32 v199, v78, v79
    buffer_store_dwordx4 v[192:195], v246, s[4:7], s56 offen offset:0 sc1
    buffer_store_dwordx4 v[196:199], v246, s[4:7], s56 offen offset:2048 sc1
    v_cvt_pk_bf16_f32 v200, v80, v81
    v_cvt_pk_bf16_f32 v204, v82, v83
    v_cvt_pk_bf16_f32 v201, v84, v85
    v_cvt_pk_bf16_f32 v205, v86, v87
    v_cvt_pk_bf16_f32 v202, v88, v89
    v_cvt_pk_bf16_f32 v206, v90, v91
    v_cvt_pk_bf16_f32 v203, v92, v93
    v_cvt_pk_bf16_f32 v207, v94, v95
    buffer_store_dwordx4 v[200:203], v246, s[4:7], s56 offen offset:256 sc1
    buffer_store_dwordx4 v[204:207], v246, s[4:7], s56 offen offset:2304 sc1
    s_or_b32 s54, s42, s41
    s_cmp_lg_u32 s54, 0
    s_cbranch_scc1 L_interlea_clr111
    v_lshlrev_b32 v14, 2, v0
    global_load_dword v13, v14, s[76:77] sc1
L_interlea_clr111:
    v_lshl_add_u32 v17, v2, 2, 0
    v_mul_u32_u24 v17, v17, v1
    v_cvt_f32_u32 v30, v17
    v_mul_f32 v30, 0x3b800000, v30
    v_fract_f32 v30, v30
    v_cos_f32 v64, v30
    v_sin_f32 v68, v30
    v_lshl_add_u32 v17, v2, 2, 1
    v_mul_u32_u24 v17, v17, v1
    v_cvt_f32_u32 v30, v17
    v_mul_f32 v30, 0x3b800000, v30
    v_fract_f32 v30, v30
    v_cos_f32 v65, v30
    v_sin_f32 v69, v30
    v_lshl_add_u32 v17, v2, 2, 2
    v_mul_u32_u24 v17, v17, v1
    v_cvt_f32_u32 v30, v17
    v_mul_f32 v30, 0x3b800000, v30
    v_fract_f32 v30, v30
    v_cos_f32 v66, v30
    v_sin_f32 v70, v30
    v_lshl_add_u32 v17, v2, 2, 3
    v_mul_u32_u24 v17, v17, v1
    v_cvt_f32_u32 v30, v17
    v_mul_f32 v30, 0x3b800000, v30
    v_fract_f32 v30, v30
    v_cos_f32 v67, v30
    v_sin_f32 v71, v30
    v_lshl_add_u32 v241, v2, 6, v1
    v_lshrrev_b32 v245, 2, v1
    v_xor_b32 v245, s41, v245
    v_lshlrev_b32 v245, 4, v245
    v_lshl_add_u32 v245, v241, 6, v245
    v_add_u32 v245, 0x14000, v245
    v_and_b32 v240, 3, v0
    v_xor_b32 v240, v240, v2
    v_lshlrev_b32 v240, 4, v240
    v_lshrrev_b32 v242, 2, v0
    v_lshl_add_u32 v240, v242, 14, v240
    v_bfe_u32 v242, v0, 1, 2
    v_xor_b32 v242, s41, v242
    v_lshlrev_b32 v242, 4, v242
    v_lshl_add_u32 v241, v241, 6, v242
    v_add_u32 v241, 0x1c000, v241
    v_bfe_u32 v242, v0, 3, 2
    v_xor_b32 v242, v0, v242
    v_lshlrev_b32 v242, 4, v242
    s_add_u32 s56, s53, 0x1c000
    v_add_u32 v242, s56, v242
    s_lshl_b32 s56, s40, 6
    s_lshl_b32 s57, s41, 20
    s_add_u32 s84, s56, s57
    s_cmp_lg_u32 s54, 0
    s_cbranch_scc1 L_interlea_clr9
L_interlea_clrp10:
    s_waitcnt vmcnt(0)
    v_cmp_ne_u32 vcc, 1, v13
    s_cbranch_vccz L_interlea_clr9
    v_lshlrev_b32 v14, 2, v0
    global_load_dword v13, v14, s[76:77] sc1
    s_add_u32 s54, s54, 1
    s_cmp_lt_u32 s54, 0x40000
    s_cbranch_scc1 L_interlea_clrp10
L_interlea_clr9:
    s_add_u32 s56, s48, 0x0
    s_and_b32 s57, s2, 31
    s_mul_i32 s39, s57, 1024
    s_add_u32 s39, s39, s56
    s_lshr_b32 s57, s2, 5
    s_lshl_b32 s59, s57, 7
    s_add_u32 s59, s59, s56
    v_mul_u32_u24 v17, 8, v16
    v_mov_b32 v18, 1
    s_cmp_eq_u32 s41, 0
    s_cselect_b32 s58, 0, 0x80000000
    v_or_b32 v17, s58, v17
    s_mov_b32 exec_lo, 0xffffffff
    s_mov_b32 exec_hi, 0x0
    s_waitcnt vmcnt(0)
    s_barrier
    buffer_atomic_add v18, v17, s[28:31], s59 offen sc1
    s_mov_b64 exec, -1
    s_cmp_lg_u32 s42, 0
    s_cbranch_scc1 L_interlea_once12
    s_add_u32 m0, s53, 0x20800
    s_nop 0
    buffer_load_dwordx4 v210, s[32:35], s80 offen lds
    s_add_u32 m0, s53, 0x20c00
    s_nop 0
    buffer_load_dwordx4 v211, s[32:35], s80 offen lds
    s_cmp_ge_u32 s2, 8
    s_cbranch_scc1 L_interlea_nsp13
    s_lshl_b32 s56, s41, 9
    s_add_u32 m0, s56, 0x18000
    s_nop 0
    buffer_load_ushort v212, s[32:35], 0 offen lds
    s_add_u32 m0, s56, 0x18100
    s_nop 0
    buffer_load_ushort v213, s[32:35], 0 offen lds
L_interlea_nsp13:
    v_lshlrev_b32 v17, 4, v0
    v_add_u32 v4, s53, v17
    v_lshrrev_b32 v17, 5, v0
    v_lshlrev_b32_e64 v17, 12, v17
    v_bfe_u32 v18, v0, 4, 1
    v_mul_u32_u24 v18, 1152, v18
    v_bfe_u32 v19, v0, 2, 2
    v_mul_u32_u24 v19, 224, v19
    v_and_b32 v20, 3, v0
    v_lshlrev_b32 v20, 3, v20
    v_add3_u32 v18, v17, v18, v19
    v_add_u32 v3, v18, v20
    s_lshl_b32 s56, s41, 3
    s_add_u32 s56, s56, 0
    s_mul_i32 s56, s56, 7168
    s_mul_i32 s57, s44, 224
    s_add_u32 s56, s56, s57
    v_subrev_u32 v21, 0, v0
    v_mul_u32_u24 v22, 4682, v21
    v_lshrrev_b32 v22, 16, v22
    v_mul_u32_u24 v23, 14, v22
    v_sub_u32 v23, v21, v23
    v_mul_u32_u24 v22, 7168, v22
    v_lshl_add_u32 v22, v23, 4, v22
    v_add_u32 v22, s56, v22
    v_cmp_gt_u32 vcc, 56, v21
    v_mov_b32 v23, 0x80000000
    s_nop 0
    v_cndmask_b32 v5, v23, v22, vcc
    s_lshl_b32 s56, s41, 3
    s_add_u32 s56, s56, 4
    s_mul_i32 s56, s56, 7168
    s_mul_i32 s57, s44, 224
    s_add_u32 s56, s56, s57
    s_sub_u32 s56, s56, 1024
    v_subrev_u32 v21, 8, v0
    v_mul_u32_u24 v22, 4682, v21
    v_lshrrev_b32 v22, 16, v22
    v_mul_u32_u24 v23, 14, v22
    v_sub_u32 v23, v21, v23
    v_mul_u32_u24 v22, 7168, v22
    v_lshl_add_u32 v22, v23, 4, v22
    v_add_u32 v22, s56, v22
    v_cmp_gt_u32 vcc, 56, v21
    v_mov_b32 v23, 0x80000000
    s_nop 0
    v_cndmask_b32 v6, v23, v22, vcc
    v_lshlrev_b32 v21, 4, v1
    v_lshl_add_u32 v15, v2, 9, v21
    v_bfe_u32 v21, v0, 2, 3
    v_lshrrev_b32 v22, 1, v21
    v_lshl_add_u32 v21, v21, 7, v17
    v_add_u32 v21, v21, v20
    s_lshr_b32 s56, s41, 1
    s_lshl_b32 s56, s56, 14
    s_add_u32 s56, s56, 0x10000
    v_add_u32 v21, s56, v21
    v_xor_b32 v23, 0, v22
    v_lshl_add_u32 v7, v23, 5, v21
    v_xor_b32 v23, 1, v22
    v_lshl_add_u32 v8, v23, 5, v21
    v_xor_b32 v23, 2, v22
    v_lshl_add_u32 v9, v23, 5, v21
    v_xor_b32 v23, 3, v22
    v_lshl_add_u32 v10, v23, 5, v21
    s_lshr_b32 s56, s41, 1
    s_lshl_b32 s56, s56, 13
    s_lshr_b32 s57, s46, 1
    s_lshl_b32 s57, s57, 9
    s_add_u32 s56, s56, s57
    s_and_b32 s57, s46, 1
    s_lshl_b32 s57, s57, 7
    s_add_u32 s56, s56, s57
    v_lshrrev_b32 v21, 5, v0
    v_bfe_u32 v22, v0, 3, 2
    v_lshl_add_u32 v21, v21, 3, v22
    v_lshlrev_b32 v21, 11, v21
    v_bfe_u32 v22, v0, 1, 2
    v_xor_b32 v22, v22, v2
    v_lshl_add_u32 v21, v22, 5, v21
    v_and_b32 v22, 1, v0
    v_lshl_add_u32 v21, v22, 4, v21
    v_add_u32_e64 v21, s56, v21
    v_add_u32 v11, 0xc00, v21
    v_add_u32 v12, 0x900, v21
    s_mul_i32 s56, s47, 3670016
    s_and_b32 s57, s41, 1
    s_mul_i32 s36, s57, 32768
    s_add_u32 s36, s36, s56
    s_mul_i32 s37, s57, 229376
    s_add_u32 s37, s37, s56
    v_and_b32 v60, 0xffff0000, v44
    v_and_b32 v61, 0xffff0000, v45
    v_and_b32 v62, 0xffff0000, v46
    v_and_b32 v63, 0xffff0000, v47
    v_lshlrev_b32 v56, 16, v44
    v_lshlrev_b32 v57, 16, v45
    v_lshlrev_b32 v58, 16, v46
    v_lshlrev_b32 v59, 16, v47
    v_and_b32 v52, 0xffff0000, v40
    v_and_b32 v53, 0xffff0000, v41
    v_and_b32 v54, 0xffff0000, v42
    v_and_b32 v55, 0xffff0000, v43
    v_lshlrev_b32 v48, 16, v40
    v_lshlrev_b32 v49, 16, v41
    v_lshlrev_b32 v50, 16, v42
    v_lshlrev_b32 v51, 16, v43
    v_and_b32 v44, 0xffff0000, v36
    v_and_b32 v45, 0xffff0000, v37
    v_and_b32 v46, 0xffff0000, v38
    v_and_b32 v47, 0xffff0000, v39
    v_lshlrev_b32 v40, 16, v36
    v_lshlrev_b32 v41, 16, v37
    v_lshlrev_b32 v42, 16, v38
    v_lshlrev_b32 v43, 16, v39
    v_and_b32 v36, 0xffff0000, v32
    v_and_b32 v37, 0xffff0000, v33
    v_and_b32 v38, 0xffff0000, v34
    v_and_b32 v39, 0xffff0000, v35
    v_lshlrev_b32 v32, 16, v32
    v_lshlrev_b32 v33, 16, v33
    v_lshlrev_b32 v34, 16, v34
    v_lshlrev_b32 v35, 16, v35
    v_readlane_b32 s88, v252, 0
    v_readlane_b32 s89, v252, 16
    v_add_f32 v254, v254, v252
    s_nop 0
    v_pk_add_f32 v[32:33], v[32:33], s[88:89] op_sel:[0,0] op_sel_hi:[1,0] neg_lo:[0,1] neg_hi:[0,1]
    v_pk_add_f32 v[34:35], v[34:35], s[88:89] op_sel:[0,0] op_sel_hi:[1,0] neg_lo:[0,1] neg_hi:[0,1]
    v_pk_add_f32 v[36:37], v[36:37], s[88:89] op_sel:[0,0] op_sel_hi:[1,0] neg_lo:[0,1] neg_hi:[0,1]
    v_pk_add_f32 v[38:39], v[38:39], s[88:89] op_sel:[0,0] op_sel_hi:[1,0] neg_lo:[0,1] neg_hi:[0,1]
    v_pk_add_f32 v[40:41], v[40:41], s[88:89] op_sel:[0,0] op_sel_hi:[1,0] neg_lo:[0,1] neg_hi:[0,1]
    v_pk_add_f32 v[42:43], v[42:43], s[88:89] op_sel:[0,0] op_sel_hi:[1,0] neg_lo:[0,1] neg_hi:[0,1]
    v_pk_add_f32 v[44:45], v[44:45], s[88:89] op_sel:[0,0] op_sel_hi:[1,0] neg_lo:[0,1] neg_hi:[0,1]
    v_pk_add_f32 v[46:47], v[46:47], s[88:89] op_sel:[0,0] op_sel_hi:[1,0] neg_lo:[0,1] neg_hi:[0,1]
    v_pk_add_f32 v[48:49], v[48:49], s[88:89] op_sel:[0,1] op_sel_hi:[1,1] neg_lo:[0,1] neg_hi:[0,1]
    v_pk_add_f32 v[50:51], v[50:51], s[88:89] op_sel:[0,1] op_sel_hi:[1,1] neg_lo:[0,1] neg_hi:[0,1]
    v_pk_add_f32 v[52:53], v[52:53], s[88:89] op_sel:[0,1] op_sel_hi:[1,1] neg_lo:[0,1] neg_hi:[0,1]
    v_pk_add_f32 v[54:55], v[54:55], s[88:89] op_sel:[0,1] op_sel_hi:[1,1] neg_lo:[0,1] neg_hi:[0,1]
    v_pk_add_f32 v[56:57], v[56:57], s[88:89] op_sel:[0,1] op_sel_hi:[1,1] neg_lo:[0,1] neg_hi:[0,1]
    v_pk_add_f32 v[58:59], v[58:59], s[88:89] op_sel:[0,1] op_sel_hi:[1,1] neg_lo:[0,1] neg_hi:[0,1]
    v_pk_add_f32 v[60:61], v[60:61], s[88:89] op_sel:[0,1] op_sel_hi:[1,1] neg_lo:[0,1] neg_hi:[0,1]
    v_pk_add_f32 v[62:63], v[62:63], s[88:89] op_sel:[0,1] op_sel_hi:[1,1] neg_lo:[0,1] neg_hi:[0,1]
    s_cmp_eq_u32 s41, 0
    s_cbranch_scc1 L_interlea_both14
    s_waitcnt vmcnt(0)
    s_branch L_interlea_both14
L_interlea_once12:
    v_and_b32 v204, 0xffff0000, v44
    v_and_b32 v205, 0xffff0000, v45
    v_and_b32 v206, 0xffff0000, v46
    v_and_b32 v207, 0xffff0000, v47
    v_lshlrev_b32 v200, 16, v44
    v_lshlrev_b32 v201, 16, v45
    v_lshlrev_b32 v202, 16, v46
    v_lshlrev_b32 v203, 16, v47
    v_and_b32 v196, 0xffff0000, v40
    v_and_b32 v197, 0xffff0000, v41
    v_and_b32 v198, 0xffff0000, v42
    v_and_b32 v199, 0xffff0000, v43
    v_lshlrev_b32 v192, 16, v40
    v_lshlrev_b32 v193, 16, v41
    v_lshlrev_b32 v194, 16, v42
    v_lshlrev_b32 v195, 16, v43
    v_and_b32 v188, 0xffff0000, v36
    v_and_b32 v189, 0xffff0000, v37
    v_and_b32 v190, 0xffff0000, v38
    v_and_b32 v191, 0xffff0000, v39
    v_lshlrev_b32 v184, 16, v36
    v_lshlrev_b32 v185, 16, v37
    v_lshlrev_b32 v186, 16, v38
    v_lshlrev_b32 v187, 16, v39
    v_and_b32 v180, 0xffff0000, v32
    v_and_b32 v181, 0xffff0000, v33
    v_and_b32 v182, 0xffff0000, v34
    v_and_b32 v183, 0xffff0000, v35
    v_lshlrev_b32 v176, 16, v32
    v_lshlrev_b32 v177, 16, v33
    v_lshlrev_b32 v178, 16, v34
    v_lshlrev_b32 v179, 16, v35
    v_readlane_b32 s88, v252, 0
    v_readlane_b32 s89, v252, 16
    v_add_f32 v254, v254, v252
    s_nop 0
    v_pk_add_f32 v[176:177], v[176:177], s[88:89] op_sel:[0,0] op_sel_hi:[1,0] neg_lo:[0,1] neg_hi:[0,1]
    v_pk_add_f32 v[178:179], v[178:179], s[88:89] op_sel:[0,0] op_sel_hi:[1,0] neg_lo:[0,1] neg_hi:[0,1]
    v_pk_add_f32 v[180:181], v[180:181], s[88:89] op_sel:[0,0] op_sel_hi:[1,0] neg_lo:[0,1] neg_hi:[0,1]
    v_pk_add_f32 v[182:183], v[182:183], s[88:89] op_sel:[0,0] op_sel_hi:[1,0] neg_lo:[0,1] neg_hi:[0,1]
    v_pk_add_f32 v[184:185], v[184:185], s[88:89] op_sel:[0,0] op_sel_hi:[1,0] neg_lo:[0,1] neg_hi:[0,1]
    v_pk_add_f32 v[186:187], v[186:187], s[88:89] op_sel:[0,0] op_sel_hi:[1,0] neg_lo:[0,1] neg_hi:[0,1]
    v_pk_add_f32 v[188:189], v[188:189], s[88:89] op_sel:[0,0] op_sel_hi:[1,0] neg_lo:[0,1] neg_hi:[0,1]
    v_pk_add_f32 v[190:191], v[190:191], s[88:89] op_sel:[0,0] op_sel_hi:[1,0] neg_lo:[0,1] neg_hi:[0,1]
    v_pk_add_f32 v[192:193], v[192:193], s[88:89] op_sel:[0,1] op_sel_hi:[1,1] neg_lo:[0,1] neg_hi:[0,1]
    v_pk_add_f32 v[194:195], v[194:195], s[88:89] op_sel:[0,1] op_sel_hi:[1,1] neg_lo:[0,1] neg_hi:[0,1]
    v_pk_add_f32 v[196:197], v[196:197], s[88:89] op_sel:[0,1] op_sel_hi:[1,1] neg_lo:[0,1] neg_hi:[0,1]
    v_pk_add_f32 v[198:199], v[198:199], s[88:89] op_sel:[0,1] op_sel_hi:[1,1] neg_lo:[0,1] neg_hi:[0,1]
    v_pk_add_f32 v[200:201], v[200:201], s[88:89] op_sel:[0,1] op_sel_hi:[1,1] neg_lo:[0,1] neg_hi:[0,1]
    v_pk_add_f32 v[202:203], v[202:203], s[88:89] op_sel:[0,1] op_sel_hi:[1,1] neg_lo:[0,1] neg_hi:[0,1]
    v_pk_add_f32 v[204:205], v[204:205], s[88:89] op_sel:[0,1] op_sel_hi:[1,1] neg_lo:[0,1] neg_hi:[0,1]
    v_pk_add_f32 v[206:207], v[206:207], s[88:89] op_sel:[0,1] op_sel_hi:[1,1] neg_lo:[0,1] neg_hi:[0,1]
    v_lshlrev_b32 v152, 16, v48
    v_and_b32 v156, 0xffff0000, v48
    v_lshlrev_b32 v153, 16, v49
    v_and_b32 v157, 0xffff0000, v49
    v_lshlrev_b32 v154, 16, v50
    v_and_b32 v158, 0xffff0000, v50
    v_lshlrev_b32 v155, 16, v51
    v_and_b32 v159, 0xffff0000, v51
    v_pk_fma_f32 v[176:177], v[152:153], s[92:93], v[176:177] op_sel:[0,0,0] op_sel_hi:[1,0,1]
    v_pk_fma_f32 v[178:179], v[154:155], s[92:93], v[178:179] op_sel:[0,0,0] op_sel_hi:[1,0,1]
    v_pk_fma_f32 v[180:181], v[156:157], s[92:93], v[180:181] op_sel:[0,0,0] op_sel_hi:[1,0,1]
    v_pk_fma_f32 v[182:183], v[158:159], s[92:93], v[182:183] op_sel:[0,0,0] op_sel_hi:[1,0,1]
    v_lshlrev_b32 v152, 16, v52
    v_and_b32 v156, 0xffff0000, v52
    v_lshlrev_b32 v153, 16, v53
    v_and_b32 v157, 0xffff0000, v53
    v_lshlrev_b32 v154, 16, v54
    v_and_b32 v158, 0xffff0000, v54
    v_lshlrev_b32 v155, 16, v55
    v_and_b32 v159, 0xffff0000, v55
    v_pk_fma_f32 v[184:185], v[152:153], s[92:93], v[184:185] op_sel:[0,0,0] op_sel_hi:[1,0,1]
    v_pk_fma_f32 v[186:187], v[154:155], s[92:93], v[186:187] op_sel:[0,0,0] op_sel_hi:[1,0,1]
    v_pk_fma_f32 v[188:189], v[156:157], s[92:93], v[188:189] op_sel:[0,0,0] op_sel_hi:[1,0,1]
    v_pk_fma_f32 v[190:191], v[158:159], s[92:93], v[190:191] op_sel:[0,0,0] op_sel_hi:[1,0,1]
    v_lshlrev_b32 v152, 16, v56
    v_and_b32 v156, 0xffff0000, v56
    v_lshlrev_b32 v153, 16, v57
    v_and_b32 v157, 0xffff0000, v57
    v_lshlrev_b32 v154, 16, v58
    v_and_b32 v158, 0xffff0000, v58
    v_lshlrev_b32 v155, 16, v59
    v_and_b32 v159, 0xffff0000, v59
    v_pk_fma_f32 v[192:193], v[152:153], s[92:93], v[192:193] op_sel:[0,1,0] op_sel_hi:[1,1,1]
    v_pk_fma_f32 v[194:195], v[154:155], s[92:93], v[194:195] op_sel:[0,1,0] op_sel_hi:[1,1,1]
    v_pk_fma_f32 v[196:197], v[156:157], s[92:93], v[196:197] op_sel:[0,1,0] op_sel_hi:[1,1,1]
    v_pk_fma_f32 v[198:199], v[158:159], s[92:93], v[198:199] op_sel:[0,1,0] op_sel_hi:[1,1,1]
    v_lshlrev_b32 v152, 16, v60
    v_and_b32 v156, 0xffff0000, v60
    v_lshlrev_b32 v153, 16, v61
    v_and_b32 v157, 0xffff0000, v61
    v_lshlrev_b32 v154, 16, v62
    v_and_b32 v158, 0xffff0000, v62
    v_lshlrev_b32 v155, 16, v63
    v_and_b32 v159, 0xffff0000, v63
    v_pk_fma_f32 v[200:201], v[152:153], s[92:93], v[200:201] op_sel:[0,1,0] op_sel_hi:[1,1,1]
    v_pk_fma_f32 v[202:203], v[154:155], s[92:93], v[202:203] op_sel:[0,1,0] op_sel_hi:[1,1,1]
    v_pk_fma_f32 v[204:205], v[156:157], s[92:93], v[204:205] op_sel:[0,1,0] op_sel_hi:[1,1,1]
    v_pk_fma_f32 v[206:207], v[158:159], s[92:93], v[206:207] op_sel:[0,1,0] op_sel_hi:[1,1,1]
    v_lshlrev_b32 v152, 16, v208
    v_and_b32 v156, 0xffff0000, v208
    v_lshlrev_b32 v153, 16, v209
    v_and_b32 v157, 0xffff0000, v209
    v_lshlrev_b32 v154, 16, v210
    v_and_b32 v158, 0xffff0000, v210
    v_lshlrev_b32 v155, 16, v211
    v_and_b32 v159, 0xffff0000, v211
    v_pk_fma_f32 v[32:33], v[152:153], s[92:93], v[176:177] op_sel:[0,0,0] op_sel_hi:[1,0,1]
    v_pk_fma_f32 v[34:35], v[154:155], s[92:93], v[178:179] op_sel:[0,0,0] op_sel_hi:[1,0,1]
    v_pk_fma_f32 v[36:37], v[156:157], s[92:93], v[180:181] op_sel:[0,0,0] op_sel_hi:[1,0,1]
    v_pk_fma_f32 v[38:39], v[158:159], s[92:93], v[182:183] op_sel:[0,0,0] op_sel_hi:[1,0,1]
    v_lshlrev_b32 v152, 16, v212
    v_and_b32 v156, 0xffff0000, v212
    v_lshlrev_b32 v153, 16, v213
    v_and_b32 v157, 0xffff0000, v213
    v_lshlrev_b32 v154, 16, v214
    v_and_b32 v158, 0xffff0000, v214
    v_lshlrev_b32 v155, 16, v215
    v_and_b32 v159, 0xffff0000, v215
    v_pk_fma_f32 v[40:41], v[152:153], s[92:93], v[184:185] op_sel:[0,0,0] op_sel_hi:[1,0,1]
    v_pk_fma_f32 v[42:43], v[154:155], s[92:93], v[186:187] op_sel:[0,0,0] op_sel_hi:[1,0,1]
    v_pk_fma_f32 v[44:45], v[156:157], s[92:93], v[188:189] op_sel:[0,0,0] op_sel_hi:[1,0,1]
    v_pk_fma_f32 v[46:47], v[158:159], s[92:93], v[190:191] op_sel:[0,0,0] op_sel_hi:[1,0,1]
    v_lshlrev_b32 v152, 16, v216
    v_and_b32 v156, 0xffff0000, v216
    v_lshlrev_b32 v153, 16, v217
    v_and_b32 v157, 0xffff0000, v217
    v_lshlrev_b32 v154, 16, v218
    v_and_b32 v158, 0xffff0000, v218
    v_lshlrev_b32 v155, 16, v219
    v_and_b32 v159, 0xffff0000, v219
    v_pk_fma_f32 v[48:49], v[152:153], s[92:93], v[192:193] op_sel:[0,1,0] op_sel_hi:[1,1,1]
    v_pk_fma_f32 v[50:51], v[154:155], s[92:93], v[194:195] op_sel:[0,1,0] op_sel_hi:[1,1,1]
    v_pk_fma_f32 v[52:53], v[156:157], s[92:93], v[196:197] op_sel:[0,1,0] op_sel_hi:[1,1,1]
    v_pk_fma_f32 v[54:55], v[158:159], s[92:93], v[198:199] op_sel:[0,1,0] op_sel_hi:[1,1,1]
    v_lshlrev_b32 v152, 16, v220
    v_and_b32 v156, 0xffff0000, v220
    v_lshlrev_b32 v153, 16, v221
    v_and_b32 v157, 0xffff0000, v221
    v_lshlrev_b32 v154, 16, v222
    v_and_b32 v158, 0xffff0000, v222
    v_lshlrev_b32 v155, 16, v223
    v_and_b32 v159, 0xffff0000, v223
    v_pk_fma_f32 v[56:57], v[152:153], s[92:93], v[200:201] op_sel:[0,1,0] op_sel_hi:[1,1,1]
    v_pk_fma_f32 v[58:59], v[154:155], s[92:93], v[202:203] op_sel:[0,1,0] op_sel_hi:[1,1,1]
    v_pk_fma_f32 v[60:61], v[156:157], s[92:93], v[204:205] op_sel:[0,1,0] op_sel_hi:[1,1,1]
    v_pk_fma_f32 v[62:63], v[158:159], s[92:93], v[206:207] op_sel:[0,1,0] op_sel_hi:[1,1,1]
L_interlea_both14:
    s_cmp_eq_u32 s41, 0
    s_cbranch_scc1 L_interlea_gp15
    s_mov_b32 s50, 0
    s_add_u32 m0, s53, 0x0
    s_nop 0
    buffer_load_dwordx4 v5, s[12:15], s50 offen offset:0 lds
    buffer_load_dwordx4 v6, s[12:15], s50 offen offset:1024 lds
    buffer_load_dwordx4 v5, s[16:19], s50 offen offset:2048 lds
    buffer_load_dwordx4 v6, s[16:19], s50 offen offset:3072 lds
    s_cmp_lg_u32 s41, 1
    s_cbranch_scc1 L_interlea_gq16
    s_mov_b32 m0, 0x0
    v_subrev_u32 v17, 57344, v5
    v_subrev_u32 v18, 57344, v6
    s_mov_b32 s50, 0
    buffer_load_dwordx4 v17, s[12:15], s50 offen offset:0 lds
    buffer_load_dwordx4 v18, s[12:15], s50 offen offset:1024 lds
    buffer_load_dwordx4 v17, s[16:19], s50 offen offset:2048 lds
    buffer_load_dwordx4 v18, s[16:19], s50 offen offset:3072 lds
L_interlea_gq16:
L_interlea_gp15:
    s_cmp_lg_u32 s41, 0
    s_cbranch_scc1 L_interlea_wdone17
    s_mov_b32 s58, 0
    s_mov_b32 exec_lo, 0xff
    s_mov_b32 exec_hi, 0x0
L_interlea_poll18:
    v_mov_b32 v28, 0
    buffer_atomic_add v28, v16, s[28:31], s39 offen sc0 sc1
    s_add_u32 s58, s58, 1
    s_cmp_ge_u32 s58, 0x40000
    s_cbranch_scc1 L_interlea_pollx19
    s_waitcnt vmcnt(0)
    v_cmp_ne_u32 vcc, 32, v28
    s_cbranch_vccnz L_interlea_poll18
L_interlea_pollx19:
L_interlea_wdone17:
    s_barrier
    s_mov_b64 exec, -1
    s_add_u32 m0, s53, 0x14000
    s_nop 0
    buffer_load_dwordx4 v240, s[4:7], s84 offen lds
    s_add_u32 s84, s84, 0x40000
    s_add_u32 m0, s53, 0x14400
    s_nop 0
    buffer_load_dwordx4 v240, s[4:7], s84 offen lds
    s_add_u32 s84, s84, 0x40000
    s_add_u32 m0, s53, 0x14800
    s_nop 0
    buffer_load_dwordx4 v240, s[4:7], s84 offen lds
    s_add_u32 s84, s84, 0x40000
    s_add_u32 m0, s53, 0x14c00
    s_nop 0
    buffer_load_dwordx4 v240, s[4:7], s84 offen lds
    s_lshr_b32 s56, s2, 3
    s_lshl_b32 s56, s56, 2
    s_add_u32 s56, s56, s41
    s_lshl_b32 s56, s56, 3
    s_lshr_b32 s57, s44, 2
    s_add_u32 s56, s56, s57
    s_mul_i32 s56, s56, 896
    v_mov_b32 v17, v16
    s_lshl_b64 exec, -1, 7
    v_add_u32 v17, 916608, v17
    s_cmp_lt_u32 s42, 1
    s_cselect_b64 exec, 0x3fff, 1
    s_add_u32 s57, s56, 0
    buffer_load_dword a255, v17, s[12:15], s57 offen
    s_add_u32 s57, s56, 2048
    buffer_load_dword a255, v17, s[16:19], s57 offen
    s_mov_b64 exec, -1
L_interlea_pf20:
    s_cmp_lg_u32 s42, 0
    s_cbranch_scc1 L_interlea_once21
    s_and_b32 s56, s40, 31
    s_or_b32 s56, s56, s41
    s_cmp_lg_u32 s56, 0
    s_cbranch_scc1 L_interlea_nsp22
    v_lshlrev_b32 v17, 4, v0
    v_add_u32 v17, 0x20000, v17
    v_lshlrev_b32 v18, 2, v0
    v_add_u32 v18, 0x18000, v18
    ds_read_b32 v152, v18 offset:0
    ds_read_b32 v156, v18 offset:512
    ds_read_b32 v153, v18 offset:256
    ds_read_b32 v157, v18 offset:768
    ds_read_b32 v154, v18 offset:1024
    ds_read_b32 v158, v18 offset:1536
    ds_read_b32 v155, v18 offset:1280
    ds_read_b32 v159, v18 offset:1792
    s_waitcnt lgkmcnt(0)
    s_nop 0
    ds_write_b16 v17, v152 offset:0
    ds_write_b16 v17, v156 offset:4096
    ds_write_b16 v17, v153 offset:1024
    ds_write_b16 v17, v157 offset:5120
    ds_write_b16 v17, v154 offset:2048
    ds_write_b16 v17, v158 offset:6144
    ds_write_b16 v17, v155 offset:3072
    ds_write_b16 v17, v159 offset:7168
L_interlea_nsp22:
    s_lshl_b32 s56, s41, 2
    s_nop 0
    s_add_u32 s57, s56, 0x20000
    s_sub_u32 s56, 0x2200c, s56
    v_lshl_add_u32 v243, v0, 4, s57
    v_lshl_add_u32 v244, v0, 4, s56
    ds_read_b32 a232, v243 offset:0
    ds_read_b32 a240, v244 offset:0
    ds_read_b32 a233, v243 offset:1024
    ds_read_b32 a241, v244 offset:1024
    ds_read_b32 a234, v243 offset:2048
    ds_read_b32 a242, v244 offset:2048
    ds_read_b32 a235, v243 offset:3072
    ds_read_b32 a243, v244 offset:3072
    ds_read_b32 a236, v243 offset:4096
    ds_read_b32 a244, v244 offset:4096
    ds_read_b32 a237, v243 offset:5120
    ds_read_b32 a245, v244 offset:5120
    ds_read_b32 a238, v243 offset:6144
    ds_read_b32 a246, v244 offset:6144
    ds_read_b32 a239, v243 offset:7168
    ds_read_b32 a247, v244 offset:7168
L_interlea_once21:
    s_and_b32 s56, s40, 31
    s_lshl_b32 s56, s56, 3
    s_lshl_b32 s57, s41, 1
    s_add_u32 s56, s56, s57
    s_add_u32 s57, s56, 1
    s_cmp_eq_u32 s56, 0
    s_cselect_b32 s56, 256, s56
    v_mov_b32 v17, s56
    v_cvt_f32_u32 v30, v17
    v_mul_f32 v30, 0x3a800000, v30
    v_fract_f32 v30, v30
    v_cos_f32 v18, v30
    v_sin_f32 v20, v30
    v_mul_f32_e64 v18, 0.5, v18
    v_fma_f32 v20, v20, -0.5, 0.5
    s_waitcnt lgkmcnt(0)
    v_accvgpr_read_b32 v136, a232
    v_accvgpr_read_b32 v137, a233
    v_accvgpr_read_b32 v138, a234
    v_accvgpr_read_b32 v139, a235
    v_accvgpr_read_b32 v140, a236
    v_accvgpr_read_b32 v141, a237
    v_accvgpr_read_b32 v142, a238
    v_accvgpr_read_b32 v143, a239
    v_accvgpr_read_b32 v144, a240
    v_accvgpr_read_b32 v145, a241
    v_accvgpr_read_b32 v146, a242
    v_accvgpr_read_b32 v147, a243
    v_accvgpr_read_b32 v148, a244
    v_accvgpr_read_b32 v149, a245
    v_accvgpr_read_b32 v150, a246
    v_accvgpr_read_b32 v151, a247
    v_lshlrev_b32 v120, 16, v136
    v_and_b32 v128, 0xffff0000, v144
    v_lshlrev_b32 v121, 16, v137
    v_and_b32 v129, 0xffff0000, v145
    v_lshlrev_b32 v122, 16, v138
    v_and_b32 v130, 0xffff0000, v146
    v_lshlrev_b32 v123, 16, v139
    v_and_b32 v131, 0xffff0000, v147
    v_lshlrev_b32 v124, 16, v140
    v_and_b32 v132, 0xffff0000, v148
    v_lshlrev_b32 v125, 16, v141
    v_and_b32 v133, 0xffff0000, v149
    v_lshlrev_b32 v126, 16, v142
    v_and_b32 v134, 0xffff0000, v150
    v_lshlrev_b32 v127, 16, v143
    v_and_b32 v135, 0xffff0000, v151
    v_mul_f32 v120, 0x34bccd37, v120
    v_mul_f32 v128, 0x34bccd37, v128
    v_mul_f32 v121, 0x34bccd37, v121
    v_mul_f32 v129, 0x34bccd37, v129
    v_mul_f32 v122, 0x34bccd37, v122
    v_mul_f32 v130, 0x34bccd37, v130
    v_mul_f32 v123, 0x34bccd37, v123
    v_mul_f32 v131, 0x34bccd37, v131
    v_mul_f32 v124, 0x34bccd37, v124
    v_mul_f32 v132, 0xb4bccd37, v132
    v_mul_f32 v125, 0x34bccd37, v125
    v_mul_f32 v133, 0xb4bccd37, v133
    v_mul_f32 v126, 0x34bccd37, v126
    v_mul_f32 v134, 0xb4bccd37, v134
    v_mul_f32 v127, 0x34bccd37, v127
    v_mul_f32 v135, 0xb4bccd37, v135
    v_pk_add_f32 v[88:89], v[120:121], v[128:129] neg_lo:[0,1] neg_hi:[0,1]
    v_pk_add_f32 v[90:91], v[122:123], v[130:131] neg_lo:[0,1] neg_hi:[0,1]
    v_pk_add_f32 v[92:93], v[124:125], v[132:133] neg_lo:[0,1] neg_hi:[0,1]
    v_pk_add_f32 v[94:95], v[126:127], v[134:135] neg_lo:[0,1] neg_hi:[0,1]
    v_pk_fma_f32 v[72:73], v[88:89], v[20:21], v[128:129] op_sel_hi:[1,0,1]
    v_pk_fma_f32 v[80:81], v[88:89], v[20:21], v[120:121] op_sel_hi:[1,0,1] neg_lo:[1,0,0] neg_hi:[1,0,0]
    v_pk_mul_f32 v[88:89], v[88:89], v[18:19] op_sel_hi:[1,0]
    v_pk_fma_f32 v[74:75], v[90:91], v[20:21], v[130:131] op_sel_hi:[1,0,1]
    v_pk_fma_f32 v[82:83], v[90:91], v[20:21], v[122:123] op_sel_hi:[1,0,1] neg_lo:[1,0,0] neg_hi:[1,0,0]
    v_pk_mul_f32 v[90:91], v[90:91], v[18:19] op_sel_hi:[1,0]
    v_pk_fma_f32 v[76:77], v[92:93], v[20:21], v[132:133] op_sel_hi:[1,0,1]
    v_pk_fma_f32 v[84:85], v[92:93], v[20:21], v[124:125] op_sel_hi:[1,0,1] neg_lo:[1,0,0] neg_hi:[1,0,0]
    v_pk_mul_f32 v[92:93], v[92:93], v[18:19] op_sel_hi:[1,0]
    v_pk_fma_f32 v[78:79], v[94:95], v[20:21], v[134:135] op_sel_hi:[1,0,1]
    v_pk_fma_f32 v[86:87], v[94:95], v[20:21], v[126:127] op_sel_hi:[1,0,1] neg_lo:[1,0,0] neg_hi:[1,0,0]
    v_pk_mul_f32 v[94:95], v[94:95], v[18:19] op_sel_hi:[1,0]
    v_mov_b32 v17, s57
    v_cvt_f32_u32 v30, v17
    v_mul_f32 v30, 0x3a800000, v30
    v_fract_f32 v30, v30
    v_cos_f32 v18, v30
    v_sin_f32 v20, v30
    v_mul_f32 v18, 0.5, v18
    v_fma_f32 v20, v20, -0.5, 0.5
    v_and_b32 v120, 0xffff0000, v136
    v_lshlrev_b32 v128, 16, v144
    v_and_b32 v121, 0xffff0000, v137
    v_lshlrev_b32 v129, 16, v145
    v_and_b32 v122, 0xffff0000, v138
    v_lshlrev_b32 v130, 16, v146
    v_and_b32 v123, 0xffff0000, v139
    v_lshlrev_b32 v131, 16, v147
    v_and_b32 v124, 0xffff0000, v140
    v_lshlrev_b32 v132, 16, v148
    v_and_b32 v125, 0xffff0000, v141
    v_lshlrev_b32 v133, 16, v149
    v_and_b32 v126, 0xffff0000, v142
    v_lshlrev_b32 v134, 16, v150
    v_and_b32 v127, 0xffff0000, v143
    v_lshlrev_b32 v135, 16, v151
    v_mul_f32 v120, 0x34bccd37, v120
    v_mul_f32 v128, 0x34bccd37, v128
    v_mul_f32 v121, 0x34bccd37, v121
    v_mul_f32 v129, 0x34bccd37, v129
    v_mul_f32 v122, 0x34bccd37, v122
    v_mul_f32 v130, 0x34bccd37, v130
    v_mul_f32 v123, 0x34bccd37, v123
    v_mul_f32 v131, 0x34bccd37, v131
    v_mul_f32 v124, 0x34bccd37, v124
    v_mul_f32 v132, 0xb4bccd37, v132
    v_mul_f32 v125, 0x34bccd37, v125
    v_mul_f32 v133, 0xb4bccd37, v133
    v_mul_f32 v126, 0x34bccd37, v126
    v_mul_f32 v134, 0xb4bccd37, v134
    v_mul_f32 v127, 0x34bccd37, v127
    v_mul_f32 v135, 0xb4bccd37, v135
    v_pk_add_f32 v[112:113], v[120:121], v[128:129] neg_lo:[0,1] neg_hi:[0,1]
    v_pk_add_f32 v[114:115], v[122:123], v[130:131] neg_lo:[0,1] neg_hi:[0,1]
    v_pk_add_f32 v[116:117], v[124:125], v[132:133] neg_lo:[0,1] neg_hi:[0,1]
    v_pk_add_f32 v[118:119], v[126:127], v[134:135] neg_lo:[0,1] neg_hi:[0,1]
    v_pk_fma_f32 v[96:97], v[112:113], v[20:21], v[128:129] op_sel_hi:[1,0,1]
    v_pk_fma_f32 v[104:105], v[112:113], v[20:21], v[120:121] op_sel_hi:[1,0,1] neg_lo:[1,0,0] neg_hi:[1,0,0]
    v_pk_mul_f32 v[112:113], v[112:113], v[18:19] op_sel_hi:[1,0]
    v_pk_fma_f32 v[98:99], v[114:115], v[20:21], v[130:131] op_sel_hi:[1,0,1]
    v_pk_fma_f32 v[106:107], v[114:115], v[20:21], v[122:123] op_sel_hi:[1,0,1] neg_lo:[1,0,0] neg_hi:[1,0,0]
    v_pk_mul_f32 v[114:115], v[114:115], v[18:19] op_sel_hi:[1,0]
    v_pk_fma_f32 v[100:101], v[116:117], v[20:21], v[132:133] op_sel_hi:[1,0,1]
    v_pk_fma_f32 v[108:109], v[116:117], v[20:21], v[124:125] op_sel_hi:[1,0,1] neg_lo:[1,0,0] neg_hi:[1,0,0]
    v_pk_mul_f32 v[116:117], v[116:117], v[18:19] op_sel_hi:[1,0]
    v_pk_fma_f32 v[102:103], v[118:119], v[20:21], v[134:135] op_sel_hi:[1,0,1]
    v_pk_fma_f32 v[110:111], v[118:119], v[20:21], v[126:127] op_sel_hi:[1,0,1] neg_lo:[1,0,0] neg_hi:[1,0,0]
    v_pk_mul_f32 v[118:119], v[118:119], v[18:19] op_sel_hi:[1,0]
    s_waitcnt vmcnt(2)
    s_barrier
    ds_read_b128 v[224:227], v245 offset:0
    ds_read_b128 v[228:231], v245 offset:1024
    ds_read_b128 v[232:235], v245 offset:2048
    ds_read_b128 v[236:239], v245 offset:3072
    s_waitcnt lgkmcnt(0)
    v_swap_b32 v225, v228
    v_swap_b32 v226, v232
    v_swap_b32 v227, v236
    v_swap_b32 v230, v233
    v_swap_b32 v231, v237
    v_mfma_f32_16x16x32_bf16 v[120:123], v[224:227], a[176:179], 0
    v_swap_b32 v235, v238
    v_mfma_f32_16x16x32_bf16 v[124:127], v[224:227], a[180:183], 0
    v_mfma_f32_16x16x32_bf16 v[128:131], v[228:231], a[176:179], 0
    v_mfma_f32_16x16x32_bf16 v[132:135], v[228:231], a[180:183], 0
    v_mfma_f32_16x16x32_bf16 v[136:139], v[232:235], a[176:179], 0
    v_mfma_f32_16x16x32_bf16 v[140:143], v[232:235], a[180:183], 0
    v_mfma_f32_16x16x32_bf16 v[144:147], v[236:239], a[176:179], 0
    v_mfma_f32_16x16x32_bf16 v[148:151], v[236:239], a[180:183], 0
    v_pk_mul_f32 v[168:169], v[120:121], v[64:65]
    s_nop 0
    v_pk_mul_f32 v[172:173], v[124:125], v[64:65]
    v_pk_mul_f32 v[170:171], v[122:123], v[66:67]
    v_pk_mul_f32 v[174:175], v[126:127], v[66:67]
    v_pk_fma_f32 v[168:169], v[124:125], v[68:69], v[168:169]
    v_pk_fma_f32 v[172:173], v[120:121], v[68:69], v[172:173] neg_lo:[1,0,0] neg_hi:[1,0,0]
    v_pk_fma_f32 v[170:171], v[126:127], v[70:71], v[170:171]
    v_pk_fma_f32 v[174:175], v[122:123], v[70:71], v[174:175] neg_lo:[1,0,0] neg_hi:[1,0,0]
    v_pk_mul_f32 v[184:185], v[136:137], v[64:65]
    v_pk_mul_f32 v[188:189], v[140:141], v[64:65]
    v_pk_mul_f32 v[186:187], v[138:139], v[66:67]
    v_pk_mul_f32 v[190:191], v[142:143], v[66:67]
    v_pk_fma_f32 v[184:185], v[140:141], v[68:69], v[184:185]
    v_pk_fma_f32 v[188:189], v[136:137], v[68:69], v[188:189] neg_lo:[1,0,0] neg_hi:[1,0,0]
    v_pk_fma_f32 v[186:187], v[142:143], v[70:71], v[186:187]
    v_pk_fma_f32 v[190:191], v[138:139], v[70:71], v[190:191] neg_lo:[1,0,0] neg_hi:[1,0,0]
    v_pk_mul_f32 v[176:177], v[128:129], v[64:65]
    v_pk_mul_f32 v[180:181], v[132:133], v[64:65]
    v_pk_mul_f32 v[178:179], v[130:131], v[66:67]
    v_pk_mul_f32 v[182:183], v[134:135], v[66:67]
    v_pk_fma_f32 v[176:177], v[132:133], v[68:69], v[176:177]
    v_pk_fma_f32 v[180:181], v[128:129], v[68:69], v[180:181] neg_lo:[1,0,0] neg_hi:[1,0,0]
    v_pk_fma_f32 v[178:179], v[134:135], v[70:71], v[178:179]
    v_pk_fma_f32 v[182:183], v[130:131], v[70:71], v[182:183] neg_lo:[1,0,0] neg_hi:[1,0,0]
    v_pk_mul_f32 v[192:193], v[144:145], v[64:65]
    v_pk_mul_f32 v[196:197], v[148:149], v[64:65]
    v_pk_mul_f32 v[194:195], v[146:147], v[66:67]
    v_pk_mul_f32 v[198:199], v[150:151], v[66:67]
    v_pk_fma_f32 v[192:193], v[148:149], v[68:69], v[192:193]
    v_pk_fma_f32 v[196:197], v[144:145], v[68:69], v[196:197] neg_lo:[1,0,0] neg_hi:[1,0,0]
    v_pk_fma_f32 v[194:195], v[150:151], v[70:71], v[194:195]
    v_pk_fma_f32 v[198:199], v[146:147], v[70:71], v[198:199] neg_lo:[1,0,0] neg_hi:[1,0,0]
    v_cvt_pk_bf16_f32 v152, v168, v172
    v_cvt_pk_bf16_f32 v153, v169, v173
    v_cvt_pk_bf16_f32 v154, v170, v174
    v_cvt_pk_bf16_f32 v155, v171, v175
    v_cvt_pk_bf16_f32 v160, v184, v188
    v_cvt_pk_bf16_f32 v161, v185, v189
    v_mfma_f32_16x16x32_bf16 v[120:123], a[176:179], v[152:155], 0
    v_cvt_pk_bf16_f32 v162, v186, v190
    v_cvt_pk_bf16_f32 v163, v187, v191
    v_mfma_f32_16x16x32_bf16 v[124:127], a[180:183], v[152:155], 0
    v_cvt_pk_bf16_f32 v156, v176, v180
    v_cvt_pk_bf16_f32 v157, v177, v181
    v_mfma_f32_16x16x32_bf16 v[136:139], a[176:179], v[160:163], 0
    v_cvt_pk_bf16_f32 v158, v178, v182
    v_cvt_pk_bf16_f32 v159, v179, v183
    v_mfma_f32_16x16x32_bf16 v[140:143], a[180:183], v[160:163], 0
    v_cvt_pk_bf16_f32 v164, v192, v196
    v_cvt_pk_bf16_f32 v165, v193, v197
    v_mfma_f32_16x16x32_bf16 v[128:131], a[176:179], v[156:159], 0
    v_cvt_pk_bf16_f32 v166, v194, v198
    v_cvt_pk_bf16_f32 v167, v195, v199
    v_mfma_f32_16x16x32_bf16 v[132:135], a[180:183], v[156:159], 0
    s_nop 0
    s_nop 0
    v_mfma_f32_16x16x32_bf16 v[144:147], a[176:179], v[164:167], 0
    v_mfma_f32_16x16x32_bf16 v[148:151], a[180:183], v[164:167], 0
    v_pk_mul_f32 v[168:169], v[72:73], v[120:121]
    v_pk_mul_f32 v[172:173], v[72:73], v[124:125]
    v_pk_mul_f32 v[184:185], v[80:81], v[136:137]
    v_pk_mul_f32 v[188:189], v[80:81], v[140:141]
    v_pk_mul_f32 v[170:171], v[74:75], v[122:123]
    v_pk_mul_f32 v[174:175], v[74:75], v[126:127]
    v_pk_mul_f32 v[186:187], v[82:83], v[138:139]
    v_pk_mul_f32 v[190:191], v[82:83], v[142:143]
    v_pk_fma_f32 v[168:169], v[76:77], v[124:125], v[168:169] neg_lo:[1,0,0] neg_hi:[1,0,0]
    v_pk_fma_f32 v[172:173], v[76:77], v[120:121], v[172:173]
    v_pk_fma_f32 v[184:185], v[84:85], v[140:141], v[184:185] neg_lo:[1,0,0] neg_hi:[1,0,0]
    v_pk_fma_f32 v[188:189], v[84:85], v[136:137], v[188:189]
    v_pk_fma_f32 v[170:171], v[78:79], v[126:127], v[170:171] neg_lo:[1,0,0] neg_hi:[1,0,0]
    v_pk_fma_f32 v[174:175], v[78:79], v[122:123], v[174:175]
    v_pk_fma_f32 v[186:187], v[86:87], v[142:143], v[186:187] neg_lo:[1,0,0] neg_hi:[1,0,0]
    v_pk_fma_f32 v[190:191], v[86:87], v[138:139], v[190:191]
    v_pk_fma_f32 v[168:169], v[92:93], v[136:137], v[168:169] neg_lo:[1,0,0] neg_hi:[1,0,0]
    v_pk_fma_f32 v[172:173], v[88:89], v[136:137], v[172:173]
    v_pk_fma_f32 v[184:185], v[92:93], v[120:121], v[184:185]
    v_pk_fma_f32 v[188:189], v[88:89], v[120:121], v[188:189] neg_lo:[1,0,0] neg_hi:[1,0,0]
    v_pk_fma_f32 v[170:171], v[94:95], v[138:139], v[170:171] neg_lo:[1,0,0] neg_hi:[1,0,0]
    v_pk_fma_f32 v[174:175], v[90:91], v[138:139], v[174:175]
    v_pk_fma_f32 v[186:187], v[94:95], v[122:123], v[186:187]
    v_pk_fma_f32 v[190:191], v[90:91], v[122:123], v[190:191] neg_lo:[1,0,0] neg_hi:[1,0,0]
    v_pk_fma_f32 v[168:169], v[88:89], v[140:141], v[168:169] neg_lo:[1,0,0] neg_hi:[1,0,0]
    v_pk_fma_f32 v[172:173], v[92:93], v[140:141], v[172:173] neg_lo:[1,0,0] neg_hi:[1,0,0]
    v_pk_fma_f32 v[184:185], v[88:89], v[124:125], v[184:185]
    v_pk_fma_f32 v[188:189], v[92:93], v[124:125], v[188:189]
    v_pk_fma_f32 v[170:171], v[90:91], v[142:143], v[170:171] neg_lo:[1,0,0] neg_hi:[1,0,0]
    v_pk_fma_f32 v[174:175], v[94:95], v[142:143], v[174:175] neg_lo:[1,0,0] neg_hi:[1,0,0]
    v_pk_fma_f32 v[186:187], v[90:91], v[126:127], v[186:187]
    v_pk_fma_f32 v[190:191], v[94:95], v[126:127], v[190:191]
    v_pk_mul_f32 v[176:177], v[96:97], v[128:129]
    v_pk_mul_f32 v[180:181], v[96:97], v[132:133]
    v_pk_mul_f32 v[192:193], v[104:105], v[144:145]
    v_pk_mul_f32 v[196:197], v[104:105], v[148:149]
    v_pk_mul_f32 v[178:179], v[98:99], v[130:131]
    v_pk_mul_f32 v[182:183], v[98:99], v[134:135]
    v_pk_mul_f32 v[194:195], v[106:107], v[146:147]
    v_pk_mul_f32 v[198:199], v[106:107], v[150:151]
    v_pk_fma_f32 v[176:177], v[100:101], v[132:133], v[176:177] neg_lo:[1,0,0] neg_hi:[1,0,0]
    v_pk_fma_f32 v[180:181], v[100:101], v[128:129], v[180:181]
    v_pk_fma_f32 v[192:193], v[108:109], v[148:149], v[192:193] neg_lo:[1,0,0] neg_hi:[1,0,0]
    v_pk_fma_f32 v[196:197], v[108:109], v[144:145], v[196:197]
    v_pk_fma_f32 v[178:179], v[102:103], v[134:135], v[178:179] neg_lo:[1,0,0] neg_hi:[1,0,0]
    v_pk_fma_f32 v[182:183], v[102:103], v[130:131], v[182:183]
    v_pk_fma_f32 v[194:195], v[110:111], v[150:151], v[194:195] neg_lo:[1,0,0] neg_hi:[1,0,0]
    v_pk_fma_f32 v[198:199], v[110:111], v[146:147], v[198:199]
    v_pk_fma_f32 v[176:177], v[116:117], v[144:145], v[176:177] neg_lo:[1,0,0] neg_hi:[1,0,0]
    v_pk_fma_f32 v[180:181], v[112:113], v[144:145], v[180:181]
    v_pk_fma_f32 v[192:193], v[116:117], v[128:129], v[192:193]
    v_pk_fma_f32 v[196:197], v[112:113], v[128:129], v[196:197] neg_lo:[1,0,0] neg_hi:[1,0,0]
    v_pk_fma_f32 v[178:179], v[118:119], v[146:147], v[178:179] neg_lo:[1,0,0] neg_hi:[1,0,0]
    v_pk_fma_f32 v[182:183], v[114:115], v[146:147], v[182:183]
    v_pk_fma_f32 v[194:195], v[118:119], v[130:131], v[194:195]
    v_pk_fma_f32 v[198:199], v[114:115], v[130:131], v[198:199] neg_lo:[1,0,0] neg_hi:[1,0,0]
    v_pk_fma_f32 v[176:177], v[112:113], v[148:149], v[176:177] neg_lo:[1,0,0] neg_hi:[1,0,0]
    v_pk_fma_f32 v[180:181], v[116:117], v[148:149], v[180:181] neg_lo:[1,0,0] neg_hi:[1,0,0]
    v_pk_fma_f32 v[192:193], v[112:113], v[132:133], v[192:193]
    v_pk_fma_f32 v[196:197], v[116:117], v[132:133], v[196:197]
    v_pk_fma_f32 v[178:179], v[114:115], v[150:151], v[178:179] neg_lo:[1,0,0] neg_hi:[1,0,0]
    v_pk_fma_f32 v[182:183], v[118:119], v[150:151], v[182:183] neg_lo:[1,0,0] neg_hi:[1,0,0]
    v_pk_fma_f32 v[194:195], v[114:115], v[134:135], v[194:195]
    v_pk_fma_f32 v[198:199], v[118:119], v[134:135], v[198:199]
    v_cvt_pk_bf16_f32 v152, v168, v172
    v_cvt_pk_bf16_f32 v153, v169, v173
    v_cvt_pk_bf16_f32 v154, v170, v174
    v_cvt_pk_bf16_f32 v155, v171, v175
    v_cvt_pk_bf16_f32 v160, v184, v188
    v_cvt_pk_bf16_f32 v161, v185, v189
    v_mfma_f32_16x16x32_bf16 v[120:123], v[152:155], a[184:187], 0
    v_cvt_pk_bf16_f32 v162, v186, v190
    v_cvt_pk_bf16_f32 v163, v187, v191
    v_mfma_f32_16x16x32_bf16 v[124:127], v[152:155], a[188:191], 0
    v_cvt_pk_bf16_f32 v156, v176, v180
    v_cvt_pk_bf16_f32 v157, v177, v181
    v_mfma_f32_16x16x32_bf16 v[136:139], v[160:163], a[184:187], 0
    v_cvt_pk_bf16_f32 v158, v178, v182
    v_cvt_pk_bf16_f32 v159, v179, v183
    v_mfma_f32_16x16x32_bf16 v[140:143], v[160:163], a[188:191], 0
    v_cvt_pk_bf16_f32 v164, v192, v196
    v_cvt_pk_bf16_f32 v165, v193, v197
    v_mfma_f32_16x16x32_bf16 v[128:131], v[156:159], a[184:187], 0
    v_cvt_pk_bf16_f32 v166, v194, v198
    v_cvt_pk_bf16_f32 v167, v195, v199
    v_mfma_f32_16x16x32_bf16 v[132:135], v[156:159], a[188:191], 0
    s_nop 0
    s_nop 0
    v_mfma_f32_16x16x32_bf16 v[144:147], v[164:167], a[184:187], 0
    v_mfma_f32_16x16x32_bf16 v[148:151], v[164:167], a[188:191], 0
    v_pk_mul_f32 v[168:169], v[120:121], v[64:65]
    v_pk_mul_f32 v[172:173], v[124:125], v[64:65]
    v_pk_mul_f32 v[170:171], v[122:123], v[66:67]
    v_pk_mul_f32 v[174:175], v[126:127], v[66:67]
    v_pk_fma_f32 v[168:169], v[124:125], v[68:69], v[168:169] neg_lo:[1,0,0] neg_hi:[1,0,0]
    v_pk_fma_f32 v[172:173], v[120:121], v[68:69], v[172:173]
    v_pk_fma_f32 v[170:171], v[126:127], v[70:71], v[170:171] neg_lo:[1,0,0] neg_hi:[1,0,0]
    v_pk_fma_f32 v[174:175], v[122:123], v[70:71], v[174:175]
    v_pk_mul_f32 v[184:185], v[136:137], v[64:65]
    v_pk_mul_f32 v[188:189], v[140:141], v[64:65]
    v_pk_mul_f32 v[186:187], v[138:139], v[66:67]
    v_pk_mul_f32 v[190:191], v[142:143], v[66:67]
    v_pk_fma_f32 v[184:185], v[140:141], v[68:69], v[184:185] neg_lo:[1,0,0] neg_hi:[1,0,0]
    v_pk_fma_f32 v[188:189], v[136:137], v[68:69], v[188:189]
    v_pk_fma_f32 v[186:187], v[142:143], v[70:71], v[186:187] neg_lo:[1,0,0] neg_hi:[1,0,0]
    v_pk_fma_f32 v[190:191], v[138:139], v[70:71], v[190:191]
    v_pk_mul_f32 v[176:177], v[128:129], v[64:65]
    v_pk_mul_f32 v[180:181], v[132:133], v[64:65]
    v_pk_mul_f32 v[178:179], v[130:131], v[66:67]
    v_pk_mul_f32 v[182:183], v[134:135], v[66:67]
    v_pk_fma_f32 v[176:177], v[132:133], v[68:69], v[176:177] neg_lo:[1,0,0] neg_hi:[1,0,0]
    v_pk_fma_f32 v[180:181], v[128:129], v[68:69], v[180:181]
    v_pk_fma_f32 v[178:179], v[134:135], v[70:71], v[178:179] neg_lo:[1,0,0] neg_hi:[1,0,0]
    v_pk_fma_f32 v[182:183], v[130:131], v[70:71], v[182:183]
    v_pk_mul_f32 v[192:193], v[144:145], v[64:65]
    v_pk_mul_f32 v[196:197], v[148:149], v[64:65]
    v_pk_mul_f32 v[194:195], v[146:147], v[66:67]
    v_pk_mul_f32 v[198:199], v[150:151], v[66:67]
    v_pk_fma_f32 v[192:193], v[148:149], v[68:69], v[192:193] neg_lo:[1,0,0] neg_hi:[1,0,0]
    v_pk_fma_f32 v[196:197], v[144:145], v[68:69], v[196:197]
    v_pk_fma_f32 v[194:195], v[150:151], v[70:71], v[194:195] neg_lo:[1,0,0] neg_hi:[1,0,0]
    v_pk_fma_f32 v[198:199], v[146:147], v[70:71], v[198:199]
    v_cvt_pk_bf16_f32 v152, v168, v172
    v_cvt_pk_bf16_f32 v153, v169, v173
    v_cvt_pk_bf16_f32 v154, v170, v174
    v_cvt_pk_bf16_f32 v155, v171, v175
    v_cvt_pk_bf16_f32 v160, v184, v188
    v_cvt_pk_bf16_f32 v161, v185, v189
    v_mfma_f32_16x16x32_bf16 v[120:123], a[184:187], v[152:155], 0
    v_cvt_pk_bf16_f32 v162, v186, v190
    v_cvt_pk_bf16_f32 v163, v187, v191
    v_mfma_f32_16x16x32_bf16 v[124:127], a[188:191], v[152:155], 0
    v_cvt_pk_bf16_f32 v156, v176, v180
    v_cvt_pk_bf16_f32 v157, v177, v181
    v_mfma_f32_16x16x32_bf16 v[136:139], a[184:187], v[160:163], 0
    v_cvt_pk_bf16_f32 v158, v178, v182
    v_cvt_pk_bf16_f32 v159, v179, v183
    v_mfma_f32_16x16x32_bf16 v[140:143], a[188:191], v[160:163], 0
    v_cvt_pk_bf16_f32 v164, v192, v196
    v_cvt_pk_bf16_f32 v165, v193, v197
    v_mfma_f32_16x16x32_bf16 v[128:131], a[184:187], v[156:159], 0
    v_cvt_pk_bf16_f32 v166, v194, v198
    v_cvt_pk_bf16_f32 v167, v195, v199
    v_mfma_f32_16x16x32_bf16 v[132:135], a[188:191], v[156:159], 0
    v_cvt_pk_bf16_f32 v224, v120, v124
    v_cvt_pk_bf16_f32 v228, v121, v125
    v_mfma_f32_16x16x32_bf16 v[144:147], a[184:187], v[164:167], 0
    v_cvt_pk_bf16_f32 v232, v122, v126
    v_cvt_pk_bf16_f32 v236, v123, v127
    v_mfma_f32_16x16x32_bf16 v[148:151], a[188:191], v[164:167], 0
    v_cvt_pk_bf16_f32 v226, v136, v140
    v_cvt_pk_bf16_f32 v230, v137, v141
    v_cvt_pk_bf16_f32 v234, v138, v142
    v_cvt_pk_bf16_f32 v238, v139, v143
    v_cvt_pk_bf16_f32 v225, v128, v132
    v_cvt_pk_bf16_f32 v229, v129, v133
    v_cvt_pk_bf16_f32 v233, v130, v134
    v_cvt_pk_bf16_f32 v237, v131, v135
    v_cvt_pk_bf16_f32 v227, v144, v148
    ds_write_b128 v241, v[224:227] offset:0
    v_cvt_pk_bf16_f32 v231, v145, v149
    ds_write_b128 v241, v[228:231] offset:1024
    v_cvt_pk_bf16_f32 v235, v146, v150
    ds_write_b128 v241, v[232:235] offset:2048
    v_cvt_pk_bf16_f32 v239, v147, v151
    ds_write_b128 v241, v[236:239] offset:3072
    s_lshl_b32 s56, s40, 14
    s_add_u32 s56, s56, 0x400000
    s_waitcnt lgkmcnt(0)
    s_barrier
    ds_read_b128 v[152:155], v242 offset:0
    ds_read_b128 v[156:159], v242 offset:1024
    ds_read_b128 v[160:163], v242 offset:2048
    ds_read_b128 v[164:167], v242 offset:3072
    s_waitcnt lgkmcnt(3)
    buffer_store_dwordx4 v[152:155], v4, s[4:7], s56 offen offset:0 sc1
    s_waitcnt lgkmcnt(2)
    buffer_store_dwordx4 v[156:159], v4, s[4:7], s56 offen offset:1024 sc1
    s_waitcnt lgkmcnt(1)
    buffer_store_dwordx4 v[160:163], v4, s[4:7], s56 offen offset:2048 sc1
    s_waitcnt lgkmcnt(0)
    buffer_store_dwordx4 v[164:167], v4, s[4:7], s56 offen offset:3072 sc1
    v_lshl_add_u32 v17, v2, 2, 0
    v_lshl_add_u32 v18, v1, 1, 0
    v_mul_u32_u24 v17, v17, v18
    v_cvt_f32_u32 v30, v17
    v_mul_f32 v30, 0x3b000000, v30
    v_fract_f32 v30, v30
    v_cos_f32 v64, v30
    v_sin_f32 v68, v30
    v_lshl_add_u32 v17, v2, 2, 1
    v_lshl_add_u32 v18, v1, 1, 0
    v_mul_u32_u24 v17, v17, v18
    v_cvt_f32_u32 v30, v17
    v_mul_f32 v30, 0x3b000000, v30
    v_fract_f32 v30, v30
    v_cos_f32 v65, v30
    v_sin_f32 v69, v30
    v_lshl_add_u32 v17, v2, 2, 2
    v_lshl_add_u32 v18, v1, 1, 0
    v_mul_u32_u24 v17, v17, v18
    v_cvt_f32_u32 v30, v17
    v_mul_f32 v30, 0x3b000000, v30
    v_fract_f32 v30, v30
    v_cos_f32 v66, v30
    v_sin_f32 v70, v30
    v_lshl_add_u32 v17, v2, 2, 3
    v_lshl_add_u32 v18, v1, 1, 0
    v_mul_u32_u24 v17, v17, v18
    v_cvt_f32_u32 v30, v17
    v_mul_f32 v30, 0x3b000000, v30
    v_fract_f32 v30, v30
    v_cos_f32 v67, v30
    v_sin_f32 v71, v30
    v_lshl_add_u32 v17, v2, 2, 0
    v_lshl_add_u32 v18, v1, 1, 1
    v_mul_u32_u24 v17, v17, v18
    v_cvt_f32_u32 v30, v17
    v_mul_f32 v30, 0x3b000000, v30
    v_fract_f32 v30, v30
    v_cos_f32 v72, v30
    v_sin_f32 v76, v30
    v_lshl_add_u32 v17, v2, 2, 1
    v_lshl_add_u32 v18, v1, 1, 1
    v_mul_u32_u24 v17, v17, v18
    v_cvt_f32_u32 v30, v17
    v_mul_f32 v30, 0x3b000000, v30
    v_fract_f32 v30, v30
    v_cos_f32 v73, v30
    v_sin_f32 v77, v30
    v_lshl_add_u32 v17, v2, 2, 2
    v_lshl_add_u32 v18, v1, 1, 1
    v_mul_u32_u24 v17, v17, v18
    v_cvt_f32_u32 v30, v17
    v_mul_f32 v30, 0x3b000000, v30
    v_fract_f32 v30, v30
    v_cos_f32 v74, v30
    v_sin_f32 v78, v30
    v_lshl_add_u32 v17, v2, 2, 3
    v_lshl_add_u32 v18, v1, 1, 1
    v_mul_u32_u24 v17, v17, v18
    v_cvt_f32_u32 v30, v17
    v_mul_f32 v30, 0x3b000000, v30
    v_fract_f32 v30, v30
    v_cos_f32 v75, v30
    v_sin_f32 v79, v30
    s_lshl_b32 s56, s41, 9
    v_lshlrev_b32 v243, 12, v2
    v_add_u32 v243, 0x18000, v243
    v_lshl_add_u32 v244, v1, 4, s56
    v_add_u32 v241, v243, v244
    v_sub_u32 v242, v243, v244
    v_add_u32 v242, 3832, v242
    v_cmp_eq_u32 vcc, 0, v244
    v_add_u32 v243, 1784, v243
    s_nop 0
    v_cndmask_b32 v243, v242, v243, vcc
    v_lshlrev_b32 v244, 3, v1
    v_lshl_add_u32 v244, v2, 9, v244
    s_add_u32 s56, s53, 0x18000
    v_add_u32 v244, s56, v244
    v_cndmask_b32 v250, 0, -0.5, vcc
    v_add_u32 v245, 2048, v244
    v_lshrrev_b32 v240, 2, v1
    v_lshl_add_u32 v240, v2, 6, v240
    v_lshlrev_b32 v240, 14, v240
    v_and_b32 v246, 3, v0
    v_lshl_add_u32 v240, v246, 4, v240
    s_mul_i32 s56, s41, 4224
    s_add_u32 s56, s56, 0x10000
    v_and_b32 v247, 8, v0
    v_lshlrev_b32 v247, 3, v247
    v_lshl_add_u32 v246, v246, 4, v247
    v_and_b32 v247, 4, v0
    v_lshl_add_u32 v246, v247, 1, v246
    v_lshl_add_u32 v246, v2, 9, v246
    v_add_u32 v246, s56, v246
    s_lshl_b32 s56, s41, 9
    s_add_u32 s56, s56, 0x10000
    v_and_b32 v248, 7, v0
    v_mul_u32_u24 v247, 2112, v248
    v_lshrrev_b32 v249, 3, v0
    v_lshl_add_u32 v247, v249, 4, v247
    v_add_u32 v247, s56, v247
    v_lshlrev_b32 v248, 4, v248
    v_and_b32 v249, 3, v249
    v_lshl_add_u32 v248, v249, 8, v248
    v_lshrrev_b32_e64 v249, 5, v0
    v_lshl_add_u32 v248, v249, 14, v248
    s_lshl_b32 s56, s40, 6
    s_lshl_b32 s57, s41, 17
    s_add_u32 s56, s56, s57
    s_add_u32 s84, s56, 0x400000
    s_add_u32 s85, s56, 0x480000
    s_add_u32 s86, s56, 0x410000
    s_add_u32 s87, s56, 0x490000
    s_add_u32 s56, s48, 0x8000
    s_and_b32 s57, s2, 31
    s_mul_i32 s39, s57, 1024
    s_add_u32 s39, s39, s56
    s_lshr_b32 s57, s2, 5
    s_lshl_b32 s59, s57, 7
    s_add_u32 s59, s59, s56
    v_mul_u32_u24 v17, 8, v16
    v_mov_b32 v18, 1
    s_cmp_eq_u32 s41, 0
    s_cselect_b32 s58, 0, 0x80000000
    v_or_b32_e64 v17, s58, v17
    s_mov_b32 exec_lo, 0xffffffff
    s_mov_b32 exec_hi, 0x0
    s_waitcnt vmcnt(0)
    s_barrier
    buffer_atomic_add v18, v17, s[28:31], s59 offen sc1
    s_mov_b64 exec, -1
    s_cmp_eq_u32 s41, 0
    s_cbranch_scc1 L_interlea_gp23
    s_mov_b32 s50, 229376
    s_add_u32 m0, s53, 0x4000
    s_nop 0
    buffer_load_dwordx4 v5, s[12:15], s50 offen offset:0 lds
    buffer_load_dwordx4 v6, s[12:15], s50 offen offset:1024 lds
    buffer_load_dwordx4 v5, s[16:19], s50 offen offset:2048 lds
    buffer_load_dwordx4 v6, s[16:19], s50 offen offset:3072 lds
    s_mov_b32 s50, 458752
    s_add_u32 m0, s53, 0x8000
    s_nop 0
    buffer_load_dwordx4 v5, s[12:15], s50 offen offset:0 lds
    buffer_load_dwordx4 v6, s[12:15], s50 offen offset:1024 lds
    buffer_load_dwordx4 v5, s[16:19], s50 offen offset:2048 lds
    buffer_load_dwordx4 v6, s[16:19], s50 offen offset:3072 lds
    s_mov_b32 s50, 688128
    s_add_u32 m0, s53, 0xc000
    s_nop 0
    buffer_load_dwordx4 v5, s[12:15], s50 offen offset:0 lds
    buffer_load_dwordx4 v6, s[12:15], s50 offen offset:1024 lds
    buffer_load_dwordx4 v5, s[16:19], s50 offen offset:2048 lds
    buffer_load_dwordx4 v6, s[16:19], s50 offen offset:3072 lds
    s_cmp_lg_u32 s41, 2
    s_cbranch_scc1 L_interlea_gq24
    s_mov_b32 m0, 0x4000
    v_subrev_u32 v17, 114688, v5
    v_subrev_u32 v18, 114688, v6
    s_mov_b32 s50, 229376
    buffer_load_dwordx4 v17, s[12:15], s50 offen offset:0 lds
    buffer_load_dwordx4 v18, s[12:15], s50 offen offset:1024 lds
    buffer_load_dwordx4 v17, s[16:19], s50 offen offset:2048 lds
    buffer_load_dwordx4 v18, s[16:19], s50 offen offset:3072 lds
L_interlea_gq24:
    s_cmp_lg_u32 s41, 3
    s_cbranch_scc1 L_interlea_gq25
    s_mov_b32 m0, 0x8000
    v_subrev_u32 v17, 172032, v5
    v_subrev_u32 v18, 172032, v6
    s_mov_b32 s50, 458752
    buffer_load_dwordx4 v17, s[12:15], s50 offen offset:0 lds
    buffer_load_dwordx4 v18, s[12:15], s50 offen offset:1024 lds
    buffer_load_dwordx4 v17, s[16:19], s50 offen offset:2048 lds
    buffer_load_dwordx4 v18, s[16:19], s50 offen offset:3072 lds
L_interlea_gq25:
    s_cmp_lg_u32 s41, 1
    s_cbranch_scc1 L_interlea_gq26
    s_mov_b32 m0, 0xc000
    v_subrev_u32 v17, 57344, v5
    v_subrev_u32 v18, 57344, v6
    s_mov_b32 s50, 688128
    buffer_load_dwordx4 v17, s[12:15], s50 offen offset:0 lds
    buffer_load_dwordx4 v18, s[12:15], s50 offen offset:1024 lds
    buffer_load_dwordx4 v17, s[16:19], s50 offen offset:2048 lds
    buffer_load_dwordx4 v18, s[16:19], s50 offen offset:3072 lds
L_interlea_gq26:
L_interlea_gp23:
    s_cmp_lg_u32 s42, 0
    s_cbranch_scc1 L_interlea_once27
    v_lshl_add_u32 v20, v2, 2, 0
    v_mul_u32_u24 v19, v1, v20
    v_lshl_add_u32 v21, v19, 1, v20
    v_cvt_f32_u32 v30, v21
    v_mul_f32 v30, 0x3d000000, v30
    v_fract_f32 v30, v30
    v_cos_f32 v17, v30
    v_sin_f32_e64 v18, v30
    v_mul_f32 v17, 0x3f910000, v17
    v_mul_f32 v18, 0x3f910000, v18
    v_cvt_pk_bf16_f32 v29, v17, -v18
    v_accvgpr_write_b32 a208, v29
    v_cvt_pk_bf16_f32 v29, v18, v17
    v_accvgpr_write_b32 a212, v29
    v_cvt_pk_bf16_f32 v29, -v17, v18
    v_accvgpr_write_b32 a216, v29
    v_cvt_pk_bf16_f32 v29, -v18, -v17
    v_accvgpr_write_b32 a220, v29
    v_lshl_add_u32 v20, v2, 2, 1
    v_mul_u32_u24 v19, v1, v20
    v_lshl_add_u32 v21, v19, 1, v20
    v_cvt_f32_u32 v30, v21
    v_mul_f32 v30, 0x3d000000, v30
    v_fract_f32 v30, v30
    v_cos_f32 v17, v30
    v_sin_f32_e64 v18, v30
    v_mul_f32 v17, 0x3f910000, v17
    v_mul_f32 v18, 0x3f910000, v18
    v_cvt_pk_bf16_f32 v29, v17, -v18
    v_accvgpr_write_b32 a209, v29
    v_cvt_pk_bf16_f32 v29, v18, v17
    v_accvgpr_write_b32 a213, v29
    v_cvt_pk_bf16_f32 v29, -v17, v18
    v_accvgpr_write_b32 a217, v29
    v_cvt_pk_bf16_f32 v29, -v18, -v17
    v_accvgpr_write_b32 a221, v29
    v_lshl_add_u32 v20, v2, 2, 2
    v_mul_u32_u24 v19, v1, v20
    v_lshl_add_u32 v21, v19, 1, v20
    v_cvt_f32_u32 v30, v21
    v_mul_f32 v30, 0x3d000000, v30
    v_fract_f32 v30, v30
    v_cos_f32 v17, v30
    v_sin_f32_e64 v18, v30
    v_mul_f32 v17, 0x3f910000, v17
    v_mul_f32 v18, 0x3f910000, v18
    v_cvt_pk_bf16_f32 v29, v17, -v18
    v_accvgpr_write_b32 a210, v29
    v_cvt_pk_bf16_f32 v29, v18, v17
    v_accvgpr_write_b32 a214, v29
    v_cvt_pk_bf16_f32 v29, -v17, v18
    v_accvgpr_write_b32 a218, v29
    v_cvt_pk_bf16_f32 v29, -v18, -v17
    v_accvgpr_write_b32 a222, v29
    v_lshl_add_u32 v20, v2, 2, 3
    v_mul_u32_u24 v19, v1, v20
    v_lshl_add_u32 v21, v19, 1, v20
    v_cvt_f32_u32 v30, v21
    v_mul_f32 v30, 0x3d000000, v30
    v_fract_f32 v30, v30
    v_cos_f32 v17, v30
    v_sin_f32_e64 v18, v30
    v_mul_f32 v17, 0x3f910000, v17
    v_mul_f32 v18, 0x3f910000, v18
    v_cvt_pk_bf16_f32 v29, v17, -v18
    v_accvgpr_write_b32 a211, v29
    v_cvt_pk_bf16_f32 v29, v18, v17
    v_accvgpr_write_b32 a215, v29
    v_cvt_pk_bf16_f32 v29, -v17, v18
    v_accvgpr_write_b32 a219, v29
    v_cvt_pk_bf16_f32 v29, -v18, -v17
    v_accvgpr_write_b32 a223, v29
    v_and_b32 v22, 1, v1
    v_cvt_f32_u32 v23, v22
    v_mul_f32 v23, 0x3e800000, v23
    v_mul_u32_u24 v22, 0x8000, v22
    v_lshl_or_b32 v22, v22, 16, v22
    v_lshrrev_b32 v24, 1, v1
    v_lshl_add_u32 v20, v2, 1, 0
    v_lshlrev_b32 v19, 8, v24
    v_add_u32 v19, s40, v19
    v_mul_u32_u24 v19, v19, v20
    v_cvt_f32_u32 v30, v19
    v_mul_f32 v30, 0xba000000, v30
    v_add_f32 v30, v23, v30
    v_fract_f32 v30, v30
    v_cos_f32 v17, v30
    v_sin_f32 v18, v30
    s_nop 0
    v_cvt_pk_bf16_f32 v29, v17, v18
    v_accvgpr_write_b32 a228, v29
    v_xor_b32 v29, v29, v22
    v_accvgpr_write_b32 a230, v29
    v_lshl_add_u32 v20, v2, 1, 1
    v_lshlrev_b32 v19, 8, v24
    v_add_u32 v19, s40, v19
    v_mul_u32_u24 v19, v19, v20
    v_cvt_f32_u32 v30, v19
    v_mul_f32 v30, 0xba000000, v30
    v_add_f32 v30, v23, v30
    v_fract_f32 v30, v30
    v_cos_f32 v17, v30
    v_sin_f32 v18, v30
    s_nop 0
    v_cvt_pk_bf16_f32 v29, v17, v18
    v_accvgpr_write_b32 a229, v29
    v_xor_b32 v29, v29, v22
    v_accvgpr_write_b32 a231, v29
L_interlea_once27:
    s_lshl_b32 s56, s2, 2
    s_add_u32 s56, s56, s41
    s_mul_i32 s56, s56, 896
    s_lshr_b32 s57, s2, 3
    s_lshl_b32 s57, s57, 2
    s_add_u32 s57, s57, s41
    s_lshl_b32 s57, s57, 3
    s_lshr_b32 s58, s44, 2
    s_add_u32 s57, s57, s58
    s_mul_i32 s57, s57, 896
    s_add_u32 s57, s57, 3670016
    s_cmp_eq_u32 s42, 0
    s_mov_b32 s58, 917504
    s_cselect_b32 s59, 21, 0
    v_add_u32 v20, s57, v16
    v_mov_b32 v22, s68
    v_mov_b32 v23, s69
    v_mov_b32 v24, 0
    v_mov_b32 v25, s58
    s_lshl_b64 exec, -1, 7
    v_subrev_u32 v20, 896, v20
    v_mov_b32 v22, s70
    v_mov_b32 v23, s71
    s_lshl_b64 exec, -1, 14
    v_subrev_u32 v20, 1792, v16
    v_add_u32 v20, s56, v20
    v_mov_b32 v22, s72
    v_mov_b32 v23, s73
    v_mov_b32 v24, s58
    s_lshl_b64 exec, -1, s59
    v_mov_b32 v20, 0
    v_mov_b32 v22, s72
    v_mov_b32 v23, s73
    v_mov_b32 v24, 0
    v_mov_b32 v25, 0
    s_mov_b64 exec, -1
    v_add_co_u32 v20, vcc, v22, v20
    s_nop 1
    v_addc_co_u32 v21, vcc, 0, v23, vcc
    v_mov_b32 v23, 0
    s_cmp_lg_u32 s41, 0
    s_cbranch_scc1 L_interlea_wdone28
    s_mov_b32 s58, 0
    s_mov_b32 exec_lo, 0xff
    s_mov_b32 exec_hi, 0x0
L_interlea_poll29:
    v_mov_b32_e64 v28, 0
    buffer_atomic_add v28, v16, s[28:31], s39 offen sc0 sc1
    s_add_u32 s58, s58, 1
    s_cmp_ge_u32 s58, 0x40000
    s_cbranch_scc1 L_interlea_pollx30
    s_waitcnt vmcnt(0)
    v_cmp_ne_u32 vcc, 32, v28
    s_cbranch_vccnz L_interlea_poll29
L_interlea_pollx30:
L_interlea_wdone28:
    s_barrier
    s_mov_b64 exec, -1
    buffer_load_dwordx4 v[112:115], v240, s[4:7], s84 offen
    buffer_load_dwordx4 v[116:119], v240, s[4:7], s85 offen
    buffer_load_dwordx4 v[120:123], v240, s[4:7], s86 offen
    buffer_load_dwordx4 v[124:127], v240, s[4:7], s87 offen
    s_lshr_b32 s56, s2, 3
    s_lshl_b32 s56, s56, 2
    s_add_u32 s56, s56, s41
    s_lshl_b32 s56, s56, 3
    s_lshr_b32 s57, s44, 2
    s_add_u32 s56, s56, s57
    s_mul_i32 s56, s56, 896
    v_mov_b32_e64 v17, v16
    s_lshl_b64 exec, -1, 7
    v_add_u32 v17, 916608, v17
    s_cmp_lt_u32 s42, 1
    s_cselect_b64 exec, 0x3fff, 1
    s_add_u32 s57, s56, 1835008
    buffer_load_dword a255, v17, s[12:15], s57 offen
    s_add_u32 s57, s56, 1837056
    buffer_load_dword a255, v17, s[16:19], s57 offen
    s_mov_b64 exec, -1
L_interlea_pf31:
    s_lshr_b32 s56, s40, 5
    s_lshl_b32 s56, s56, 19
    s_lshl_b32 s57, s41, 17
    s_add_u32 s56, s56, s57
    s_bfe_u32 s57, s40, 0x40001
    s_lshl_b32 s57, s57, 10
    s_add_u32 s56, s56, s57
    s_and_b32 s57, s40, 1
    s_lshl_b32 s57, s57, 7
    s_add_u32 s56, s56, s57
    s_add_u32 s56, s56, 0x800000
    s_waitcnt vmcnt(4)
    v_swap_b32 v113, v116
    v_swap_b32 v115, v118
    s_nop 0
    v_mfma_f32_16x16x16_bf16 v[128:131], a[228:229], v[112:113], 0
    v_mfma_f32_16x16x16_bf16 v[132:135], a[228:229], v[116:117], 0
    v_mfma_f32_16x16x16_bf16 v[136:139], a[230:231], v[114:115], 0
    v_mfma_f32_16x16x16_bf16 v[140:143], a[230:231], v[118:119], 0
    s_waitcnt vmcnt(2)
    v_swap_b32 v121, v124
    v_swap_b32 v123, v126
    s_nop 0
    v_mfma_f32_16x16x16_bf16 v[144:147], a[228:229], v[120:121], 0
    v_add_f32 v17, v128, v129
    v_add_f32 v18, v130, v131
    v_mfma_f32_16x16x16_bf16 v[148:151], a[228:229], v[124:125], 0
    v_fmac_f32 v128, v250, v17
    v_fmac_f32 v129, v250, v17
    v_mfma_f32_16x16x16_bf16 v[152:155], a[230:231], v[122:123], 0
    v_fmac_f32 v130, v250, v18
    v_fmac_f32 v131, v250, v18
    v_mfma_f32_16x16x16_bf16 v[156:159], a[230:231], v[126:127], 0
    v_cvt_pk_bf16_f32 v160, v128, v129
    v_cvt_pk_bf16_f32 v161, v130, v131
    v_cvt_pk_bf16_f32 v162, v132, v133
    v_cvt_pk_bf16_f32 v163, v134, v135
    ds_write_b128 v241, v[160:163] offset:0
    v_cvt_pk_bf16_f32 v164, v136, v137
    v_cvt_pk_bf16_f32 v165, v138, v139
    ds_write_b64 v243, v[164:165] offset:264
    v_cvt_pk_bf16_f32 v166, v140, v141
    v_cvt_pk_bf16_f32 v167, v142, v143
    ds_write_b64 v242, v[166:167] offset:256
    v_cvt_pk_bf16_f32 v168, v144, v145
    v_cvt_pk_bf16_f32 v169, v146, v147
    v_cvt_pk_bf16_f32 v170, v148, v149
    v_cvt_pk_bf16_f32 v171, v150, v151
    ds_write_b128 v241, v[168:171] offset:256
    v_cvt_pk_bf16_f32 v172, v152, v153
    v_cvt_pk_bf16_f32 v173, v154, v155
    ds_write_b64 v242, v[172:173] offset:8
    v_cvt_pk_bf16_f32 v174, v156, v157
    v_cvt_pk_bf16_f32 v175, v158, v159
    ds_write_b64 v242, v[174:175] offset:0
    s_waitcnt lgkmcnt(0)
    s_barrier
    ds_read2_b32 v[112:113], v244 offset0:0 offset1:32
    ds_read2_b32 v[114:115], v244 offset0:64 offset1:96
    ds_read2_b32 v[116:117], v245 offset0:0 offset1:32
    ds_read2_b32 v[118:119], v245 offset0:64 offset1:96
    ds_read2_b32 v[120:121], v244 offset0:1 offset1:33
    ds_read2_b32 v[122:123], v244 offset0:65 offset1:97
    ds_read2_b32 v[124:125], v245 offset0:1 offset1:33
    ds_read2_b32 v[126:127], v245 offset0:65 offset1:97
    s_waitcnt lgkmcnt(4)
    v_mfma_f32_16x16x32_bf16 v[128:131], v[112:115], a[184:187], 0
    v_mfma_f32_16x16x32_bf16 v[132:135], v[112:115], a[188:191], 0
    v_mfma_f32_16x16x32_bf16 v[136:139], v[112:115], a[208:211], 0
    v_mfma_f32_16x16x32_bf16 v[140:143], v[112:115], a[212:215], 0
    v_mfma_f32_16x16x32_bf16 v[128:131], v[116:119], a[184:187], v[128:131]
    v_mfma_f32_16x16x32_bf16 v[132:135], v[116:119], a[188:191], v[132:135]
    v_mfma_f32_16x16x32_bf16 v[136:139], v[116:119], a[216:219], v[136:139]
    v_mfma_f32_16x16x32_bf16 v[140:143], v[116:119], a[220:223], v[140:143]
    s_waitcnt lgkmcnt(0)
    v_mfma_f32_16x16x32_bf16 v[144:147], v[120:123], a[184:187], 0
    v_mfma_f32_16x16x32_bf16 v[148:151], v[120:123], a[188:191], 0
    v_mfma_f32_16x16x32_bf16 v[152:155], v[120:123], a[208:211], 0
    v_mfma_f32_16x16x32_bf16 v[156:159], v[120:123], a[212:215], 0
    v_mfma_f32_16x16x32_bf16 v[144:147], v[124:127], a[184:187], v[144:147]
    v_mfma_f32_16x16x32_bf16 v[148:151], v[124:127], a[188:191], v[148:151]
    v_mfma_f32_16x16x32_bf16 v[152:155], v[124:127], a[216:219], v[152:155]
    v_mfma_f32_16x16x32_bf16 v[156:159], v[124:127], a[220:223], v[156:159]
    v_pk_mul_f32 v[176:177], v[128:129], v[64:65]
    v_pk_mul_f32 v[180:181], v[132:133], v[64:65]
    v_pk_mul_f32 v[178:179], v[130:131], v[66:67]
    v_pk_mul_f32 v[182:183], v[134:135], v[66:67]
    v_pk_fma_f32 v[176:177], v[132:133], v[68:69], v[176:177] neg_lo:[1,0,0] neg_hi:[1,0,0]
    v_pk_fma_f32 v[180:181], v[128:129], v[68:69], v[180:181]
    v_pk_fma_f32 v[178:179], v[134:135], v[70:71], v[178:179] neg_lo:[1,0,0] neg_hi:[1,0,0]
    v_pk_fma_f32 v[182:183], v[130:131], v[70:71], v[182:183]
    v_pk_mul_f32 v[184:185], v[136:137], v[72:73]
    v_pk_mul_f32 v[188:189], v[140:141], v[72:73]
    v_pk_mul_f32 v[186:187], v[138:139], v[74:75]
    v_pk_mul_f32 v[190:191], v[142:143], v[74:75]
    v_pk_fma_f32 v[184:185], v[140:141], v[76:77], v[184:185] neg_lo:[1,0,0] neg_hi:[1,0,0]
    v_pk_fma_f32 v[188:189], v[136:137], v[76:77], v[188:189]
    v_pk_fma_f32 v[186:187], v[142:143], v[78:79], v[186:187] neg_lo:[1,0,0] neg_hi:[1,0,0]
    v_pk_fma_f32 v[190:191], v[138:139], v[78:79], v[190:191]
    v_pk_mul_f32 v[192:193], v[144:145], v[64:65]
    v_pk_mul_f32 v[196:197], v[148:149], v[64:65]
    v_pk_mul_f32 v[194:195], v[146:147], v[66:67]
    v_pk_mul_f32 v[198:199], v[150:151], v[66:67]
    v_pk_fma_f32 v[192:193], v[148:149], v[68:69], v[192:193] neg_lo:[1,0,0] neg_hi:[1,0,0]
    v_pk_fma_f32 v[196:197], v[144:145], v[68:69], v[196:197]
    v_pk_fma_f32 v[194:195], v[150:151], v[70:71], v[194:195] neg_lo:[1,0,0] neg_hi:[1,0,0]
    v_pk_fma_f32 v[198:199], v[146:147], v[70:71], v[198:199]
    v_pk_mul_f32 v[200:201], v[152:153], v[72:73]
    v_pk_mul_f32 v[204:205], v[156:157], v[72:73]
    v_pk_mul_f32 v[202:203], v[154:155], v[74:75]
    v_pk_mul_f32 v[206:207], v[158:159], v[74:75]
    v_pk_fma_f32 v[200:201], v[156:157], v[76:77], v[200:201] neg_lo:[1,0,0] neg_hi:[1,0,0]
    v_pk_fma_f32 v[204:205], v[152:153], v[76:77], v[204:205]
    v_pk_fma_f32 v[202:203], v[158:159], v[78:79], v[202:203] neg_lo:[1,0,0] neg_hi:[1,0,0]
    v_pk_fma_f32 v[206:207], v[154:155], v[78:79], v[206:207]
    v_cvt_pk_bf16_f32 v160, v176, v180
    v_cvt_pk_bf16_f32 v161, v177, v181
    v_cvt_pk_bf16_f32 v162, v178, v182
    v_cvt_pk_bf16_f32 v163, v179, v183
    v_cvt_pk_bf16_f32 v164, v184, v188
    v_cvt_pk_bf16_f32 v165, v185, v189
    v_mfma_f32_16x16x32_bf16 v[32:35], a[184:187], v[160:163], v[32:35]
    v_cvt_pk_bf16_f32 v166, v186, v190
    v_cvt_pk_bf16_f32 v167, v187, v191
    v_mfma_f32_16x16x32_bf16 v[36:39], a[188:191], v[160:163], v[36:39]
    v_cvt_pk_bf16_f32 v168, v192, v196
    v_cvt_pk_bf16_f32 v169, v193, v197
    v_mfma_f32_16x16x32_bf16 v[40:43], a[184:187], v[164:167], v[40:43]
    v_cvt_pk_bf16_f32 v170, v194, v198
    v_cvt_pk_bf16_f32 v171, v195, v199
    v_mfma_f32_16x16x32_bf16 v[44:47], a[188:191], v[164:167], v[44:47]
    v_cvt_pk_bf16_f32 v172, v200, v204
    v_cvt_pk_bf16_f32 v173, v201, v205
    v_mfma_f32_16x16x32_bf16 v[48:51], a[184:187], v[168:171], v[48:51]
    v_cvt_pk_bf16_f32 v174, v202, v206
    v_cvt_pk_bf16_f32 v175, v203, v207
    v_mfma_f32_16x16x32_bf16 v[52:55], a[188:191], v[168:171], v[52:55]
    v_cvt_pk_bf16_f32 v112, v32, v36
    v_cvt_pk_bf16_f32 v114, v33, v37
    v_mfma_f32_16x16x32_bf16 v[56:59], a[184:187], v[172:175], v[56:59]
    v_cvt_pk_bf16_f32 v116, v34, v38
    v_cvt_pk_bf16_f32 v118, v35, v39
    v_mfma_f32_16x16x32_bf16 v[60:63], a[188:191], v[172:175], v[60:63]
    v_cvt_pk_bf16_f32 v113, v40, v44
    ds_write_b64 v246, v[112:113] offset:0
    v_cvt_pk_bf16_f32 v115, v41, v45
    ds_write_b64 v246, v[114:115] offset:128
    v_cvt_pk_bf16_f32 v117, v42, v46
    ds_write_b64 v246, v[116:117] offset:256
    v_cvt_pk_bf16_f32 v119, v43, v47
    ds_write_b64 v246, v[118:119] offset:384
    v_cvt_pk_bf16_f32 v120, v48, v52
    v_cvt_pk_bf16_f32 v122, v49, v53
    v_cvt_pk_bf16_f32 v124, v50, v54
    v_cvt_pk_bf16_f32 v126, v51, v55
    v_cvt_pk_bf16_f32 v121, v56, v60
    ds_write_b64 v246, v[120:121] offset:2112
    v_cvt_pk_bf16_f32 v123, v57, v61
    ds_write_b64 v246, v[122:123] offset:2240
    v_cvt_pk_bf16_f32 v125, v58, v62
    ds_write_b64 v246, v[124:125] offset:2368
    v_cvt_pk_bf16_f32 v127, v59, v63
    ds_write_b64 v246, v[126:127] offset:2496
    s_waitcnt lgkmcnt(0)
    s_barrier
    ds_read_b128 v[128:131], v247 offset:0
    ds_read_b128 v[132:135], v247 offset:128
    ds_read_b128 v[136:139], v247 offset:256
    ds_read_b128 v[140:143], v247 offset:384
    s_waitcnt lgkmcnt(3)
    buffer_store_dwordx4 v[128:131], v248, s[4:7], s56 offen sc1
    s_add_u32 s56, s56, 0x8000
    s_waitcnt lgkmcnt(2)
    buffer_store_dwordx4 v[132:135], v248, s[4:7], s56 offen sc1
    s_add_u32 s56, s56, 0x8000
    s_waitcnt lgkmcnt(1)
    buffer_store_dwordx4 v[136:139], v248, s[4:7], s56 offen sc1
    s_add_u32 s56, s56, 0x8000
    s_waitcnt lgkmcnt(0)
    buffer_store_dwordx4 v[140:143], v248, s[4:7], s56 offen sc1
    ds_read_b64_tr_b16 a[0:1], v3 offset:0
    ds_read_b64_tr_b16 a[2:3], v3 offset:8192
    ds_read_b64_tr_b16 a[4:5], v3 offset:16384
    ds_read_b64_tr_b16 a[6:7], v3 offset:24576
    ds_read_b64_tr_b16 a[8:9], v3 offset:2048
    ds_read_b64_tr_b16 a[10:11], v3 offset:10240
    ds_read_b64_tr_b16 a[12:13], v3 offset:18432
    ds_read_b64_tr_b16 a[14:15], v3 offset:26624
    ds_read_b64_tr_b16 a[16:17], v3 offset:32
    ds_read_b64_tr_b16 a[18:19], v3 offset:8224
    ds_read_b64_tr_b16 a[20:21], v3 offset:16416
    ds_read_b64_tr_b16 a[22:23], v3 offset:24608
    ds_read_b64_tr_b16 a[24:25], v3 offset:2080
    ds_read_b64_tr_b16 a[26:27], v3 offset:10272
    ds_read_b64_tr_b16 a[28:29], v3 offset:18464
    ds_read_b64_tr_b16 a[30:31], v3 offset:26656
    ds_read_b64_tr_b16 a[32:33], v3 offset:64
    ds_read_b64_tr_b16 a[34:35], v3 offset:8256
    ds_read_b64_tr_b16 a[36:37], v3 offset:16448
    ds_read_b64_tr_b16 a[38:39], v3 offset:24640
    ds_read_b64_tr_b16 a[40:41], v3 offset:2112
    ds_read_b64_tr_b16 a[42:43], v3 offset:10304
    ds_read_b64_tr_b16 a[44:45], v3 offset:18496
    ds_read_b64_tr_b16 a[46:47], v3 offset:26688
    s_lshl_b32 s49, s43, 19
    s_add_u32 s49, s49, 0x800000
    s_lshl_b32 s56, s43, 2
    s_add_u32 s56, s56, s41
    s_mul_i32 s56, s56, 448
    s_lshr_b32 s57, s44, 4
    s_mul_i32 s57, s57, 112
    s_add_u32 s56, s56, s57
    s_lshl_b32 s56, s56, 10
    s_add_u32 s56, s56, 0x1400000
    s_and_b32 s57, s44, 15
    s_lshl_b32 s58, s57, 11
    s_add_u32 s58, s58, s56
    s_add_u32 s84, s58, 0
    s_add_u32 s85, s58, 229376
    s_lshl_b32 s58, s57, 10
    s_add_u32 s58, s58, s56
    s_add_u32 s86, s58, 32768
    s_add_u32 s87, s58, 262144
    s_lshl_b32 s58, s57, 12
    s_add_u32 s58, s58, s56
    s_add_u32 s88, s58, 49152
    s_add_u32 s89, s58, 278528
    v_lshlrev_b32 v19, 4, v0
    v_add_u32 v27, 0x20000, v3
    s_and_b32 s56, s41, 1
    s_lshl_b32 s56, s56, 1
    s_lshr_b32 s57, s41, 1
    s_add_u32 s56, s56, s57
    s_lshl_b32 s58, s45, 2
    s_add_u32 s56, s56, s58
    s_lshl_b32 s94, s56, 16
    s_lshl_b32 s58, s46, 12
    s_add_u32 s94, s94, s58
    s_lshl_b32 s58, s47, 22
    s_add_u32 s94, s94, s58
    s_add_u32 s94, s94, 0xc00000
    s_add_u32 s95, s94, 0x8000
    s_lshl_b32 s57, s57, 12
    s_mul_i32 s58, s47, 114688
    s_add_u32 s57, s57, s58
    s_add_u32 s57, s57, 0x1400000
    s_mul_i32 s51, s56, 229376
    s_add_u32 s51, s51, s57
    s_xor_b32 s56, s56, 1
    s_mul_i32 s91, s56, 229376
    s_add_u32 s91, s91, s57
    s_lshr_b32 s57, s44, 4
    s_lshl_b32 s58, s43, 1
    s_add_u32 s57, s57, s58
    s_add_u32 s92, s48, 0x14000
    s_lshl_b32 s57, s57, 11
    s_add_u32 s92, s92, s57
    s_and_b32 s57, s45, 14
    s_add_u32 s57, s57, s47
    s_add_u32 s93, s48, 0x14000
    s_lshl_b32 s57, s57, 11
    s_add_u32 s93, s93, s57
    s_and_b32 s57, s46, 1
    s_lshl_b32 s57, s57, 7
    s_add_u32 s93, s93, s57
    v_mov_b32 v26, 1
    s_cmp_eq_u32 s41, 0
    s_cselect_b32 s82, 16, 0
    s_cselect_b32 s56, 2, 0
    s_cselect_b32 s57, 1, 0
    v_mov_b32 v14, 0x80000000
    v_cmp_gt_u32 vcc, s56, v0
    s_nop 1
    v_cndmask_b32 v13, v14, v16, vcc
    v_cmp_gt_u32 vcc, s57, v0
    s_nop 1
    v_cndmask_b32 v14, v14, v16, vcc
    s_mov_b32 s57, s43
    s_add_u32 s56, s48, 0x10000
    s_lshl_b32 s57, s57, 11
    s_add_u32 s56, s56, s57
    s_and_b32 s57, s44, 7
    s_mul_i32 s39, s57, 256
    s_add_u32 s39, s39, s56
    s_lshr_b32 s57, s40, 5
    s_add_u32 s56, s48, 0x10000
    s_lshl_b32 s57, s57, 11
    s_add_u32 s56, s56, s57
    s_and_b32 s57, s40, 1
    s_lshl_b32 s59, s57, 7
    s_add_u32 s59, s59, s56
    v_mul_u32_u24 v17, 2, v16
    v_mov_b32 v18, 1
    s_cmp_eq_u32 s41, 0
    s_cselect_b32 s58, 0, 0x80000000
    v_or_b32 v17, s58, v17
    s_mov_b32 exec_lo, 0xff
    s_mov_b32 exec_hi, 0x0
    s_waitcnt vmcnt(0)
    s_barrier
    buffer_atomic_add v18, v17, s[28:31], s59 offen sc1
    s_mov_b64 exec, -1
    s_cmp_eq_u32 s41, 0
    s_cbranch_scc1 L_interlea_gp32
    s_mov_b32 s50, 917504
    s_add_u32 m0, s53, 0x20000
    s_nop 0
    buffer_load_dwordx4 v5, s[12:15], s50 offen offset:0 lds
    buffer_load_dwordx4 v6, s[12:15], s50 offen offset:1024 lds
    buffer_load_dwordx4 v5, s[16:19], s50 offen offset:2048 lds
    buffer_load_dwordx4 v6, s[16:19], s50 offen offset:3072 lds
    s_mov_b32 s50, 1146880
    s_add_u32 m0, s53, 0x24000
    s_nop 0
    buffer_load_dwordx4 v5, s[12:15], s50 offen offset:0 lds
    buffer_load_dwordx4 v6, s[12:15], s50 offen offset:1024 lds
    buffer_load_dwordx4 v5, s[16:19], s50 offen offset:2048 lds
    buffer_load_dwordx4 v6, s[16:19], s50 offen offset:3072 lds
    s_cmp_lg_u32 s41, 2
    s_cbranch_scc1 L_interlea_gq33
    s_nop 0
    s_mov_b32 m0, 0x20000
    v_subrev_u32 v17, 114688, v5
    v_subrev_u32 v18, 114688, v6
    s_mov_b32 s50, 917504
    buffer_load_dwordx4 v17, s[12:15], s50 offen offset:0 lds
    buffer_load_dwordx4 v18, s[12:15], s50 offen offset:1024 lds
    buffer_load_dwordx4 v17, s[16:19], s50 offen offset:2048 lds
    buffer_load_dwordx4 v18, s[16:19], s50 offen offset:3072 lds
L_interlea_gq33:
    s_cmp_lg_u32 s41, 3
    s_cbranch_scc1 L_interlea_gq34
    s_mov_b32 m0, 0x24000
    v_subrev_u32 v17, 172032, v5
    v_subrev_u32 v18, 172032, v6
    s_mov_b32 s50, 1146880
    buffer_load_dwordx4 v17, s[12:15], s50 offen offset:0 lds
    buffer_load_dwordx4 v18, s[12:15], s50 offen offset:1024 lds
    buffer_load_dwordx4 v17, s[16:19], s50 offen offset:2048 lds
    buffer_load_dwordx4 v18, s[16:19], s50 offen offset:3072 lds
L_interlea_gq34:
L_interlea_gp32:
    s_cmp_lg_u32 s41, 0
    s_cbranch_scc1 L_interlea_wdone35
    s_mov_b32 s58, 0
    s_mov_b32 exec_lo, 0x3
    s_mov_b32 exec_hi, 0x0
L_interlea_poll36:
    v_mov_b32_e64 v28, 0
    buffer_atomic_add v28, v16, s[28:31], s39 offen sc0 sc1
    s_add_u32 s58, s58, 1
    s_cmp_ge_u32 s58, 0x40000
    s_cbranch_scc1 L_interlea_pollx37
    s_waitcnt vmcnt(0)
    v_cmp_ne_u32 vcc, 16, v28
    s_cbranch_vccnz L_interlea_poll36
L_interlea_pollx37:
L_interlea_wdone35:
    s_barrier
    s_mov_b64 exec, -1
    buffer_load_dwordx4 a[56:59], v4, s[4:7], s49 offen offset:0
    buffer_load_dwordx4 a[60:63], v4, s[4:7], s49 offen offset:1024
    buffer_load_dwordx4 a[64:67], v4, s[4:7], s49 offen offset:2048
    buffer_load_dwordx4 a[68:71], v4, s[4:7], s49 offen offset:3072
    s_add_u32 s49, s49, 0x4000
    buffer_load_dwordx4 a[72:75], v4, s[4:7], s49 offen offset:0
    buffer_load_dwordx4 a[76:79], v4, s[4:7], s49 offen offset:1024
    buffer_load_dwordx4 a[80:83], v4, s[4:7], s49 offen offset:2048
    buffer_load_dwordx4 a[84:87], v4, s[4:7], s49 offen offset:3072
    s_add_u32 s49, s49, 0x4000
    s_mov_b32 s50, 1376256
    v_pk_mul_f32 v[180:181], v[32:33], v[32:33]
    v_pk_mul_f32 v[182:183], v[48:49], v[48:49]
    v_pk_fma_f32 v[180:181], v[34:35], v[34:35], v[180:181]
    v_pk_add_f32 v[176:177], v[32:33], v[34:35]
    v_pk_fma_f32 v[182:183], v[50:51], v[50:51], v[182:183]
    v_pk_add_f32 v[178:179], v[48:49], v[50:51]
    v_pk_fma_f32 v[180:181], v[36:37], v[36:37], v[180:181]
    v_pk_add_f32 v[176:177], v[176:177], v[36:37]
    v_pk_fma_f32 v[182:183], v[52:53], v[52:53], v[182:183]
    v_pk_add_f32 v[178:179], v[178:179], v[52:53]
    v_pk_fma_f32 v[180:181], v[38:39], v[38:39], v[180:181]
    v_pk_add_f32 v[176:177], v[176:177], v[38:39]
    v_pk_fma_f32 v[182:183], v[54:55], v[54:55], v[182:183]
    v_pk_add_f32 v[178:179], v[178:179], v[54:55]
    v_pk_fma_f32 v[180:181], v[40:41], v[40:41], v[180:181]
    v_pk_add_f32 v[176:177], v[176:177], v[40:41]
    v_pk_fma_f32 v[182:183], v[56:57], v[56:57], v[182:183]
    v_pk_add_f32 v[178:179], v[178:179], v[56:57]
    v_pk_fma_f32 v[180:181], v[42:43], v[42:43], v[180:181]
    v_pk_add_f32 v[176:177], v[176:177], v[42:43]
    v_pk_fma_f32 v[182:183], v[58:59], v[58:59], v[182:183]
    v_pk_add_f32 v[178:179], v[178:179], v[58:59]
    v_pk_fma_f32 v[180:181], v[44:45], v[44:45], v[180:181]
    v_pk_add_f32 v[176:177], v[176:177], v[44:45]
    v_pk_fma_f32 v[182:183], v[60:61], v[60:61], v[182:183]
    v_pk_add_f32 v[178:179], v[178:179], v[60:61]
    v_pk_fma_f32 v[180:181], v[46:47], v[46:47], v[180:181]
    v_pk_add_f32 v[176:177], v[176:177], v[46:47]
    v_pk_fma_f32 v[182:183], v[62:63], v[62:63], v[182:183]
    v_pk_add_f32 v[178:179], v[178:179], v[62:63]
    v_add_f32 v176, v176, v177
    v_add_f32 v178, v178, v179
    v_add_f32 v180, v180, v181
    v_add_f32 v182, v182, v183
    v_permlane16_swap_b32 v176, v178
    s_nop 0
    v_permlane16_swap_b32 v180, v182
    v_add_f32 v176, v176, v178
    v_add_f32 v180, v180, v182
    s_nop 1
    v_permlane32_swap_b32 v176, v180
    v_add_f32 v180, v176, v180
    s_nop 1
    v_add_f32_dpp v180, v180, v180 row_ror:8 row_mask:0xf bank_mask:0xf
    s_nop 1
    v_add_f32_dpp v180, v180, v180 row_ror:4 row_mask:0xf bank_mask:0xf
    s_nop 1
    v_add_f32_dpp v180, v180, v180 row_ror:2 row_mask:0xf bank_mask:0xf
    s_nop 1
    v_add_f32_dpp v180, v180, v180 row_ror:1 row_mask:0xf bank_mask:0xf
    v_mov_b32 v176, v180
    s_nop 1
    v_permlane32_swap_b32 v176, v180
    v_mul_f32 v176, 0x3a800000, v176
    v_mul_f32 v180, 0x3a800000, v180
    v_fma_f32 v180, -v176, v176, v180
    v_max_f32 v180, 0, v180
    v_add_f32 v180, 0x3727c5ac, v180
    v_accvgpr_write_b32 a152, v112
    v_accvgpr_write_b32 a156, v113
    v_accvgpr_write_b32 a153, v114
    v_accvgpr_write_b32 a157, v115
    v_accvgpr_write_b32 a154, v116
    v_accvgpr_write_b32 a158, v117
    v_accvgpr_write_b32 a155, v118
    v_accvgpr_write_b32 a159, v119
    v_accvgpr_write_b32 a160, v120
    v_accvgpr_write_b32 a164, v121
    v_accvgpr_write_b32 a161, v122
    v_accvgpr_write_b32 a165, v123
    v_accvgpr_write_b32 a162, v124
    v_accvgpr_write_b32 a166, v125
    v_accvgpr_write_b32 a163, v126
    v_accvgpr_write_b32 a167, v127
    v_accvgpr_write_b32 a168, v180
    v_accvgpr_write_b32 a169, v254
    s_add_u32 s55, s53, 0x10000
    s_sub_u32 s52, s36, 458752
    s_waitcnt vmcnt(7) lgkmcnt(0)
    v_mfma_f32_16x16x32_bf16 v[32:35], a[0:3], a[56:59], 0
    ds_read_b64_tr_b16 a[48:49], v3 offset:96
    v_mfma_f32_16x16x32_bf16 v[48:51], a[8:11], a[56:59], 0
    buffer_load_dwordx4 a[88:91], v4, s[4:7], s49 offen offset:0
    v_mfma_f32_16x16x32_bf16 v[64:67], a[16:19], a[56:59], 0
    ds_read_b64_tr_b16 a[50:51], v3 offset:8288
    v_mfma_f32_16x16x32_bf16 v[80:83], a[24:27], a[56:59], 0
    ds_read_b64_tr_b16 a[52:53], v3 offset:16480
    ds_read_b64_tr_b16 a[54:55], v3 offset:24672
    s_waitcnt vmcnt(7)
    v_mfma_f32_16x16x32_bf16 v[36:39], a[0:3], a[60:63], 0
    v_mfma_f32_16x16x32_bf16 v[52:55], a[8:11], a[60:63], 0
    buffer_load_dwordx4 a[92:95], v4, s[4:7], s49 offen offset:1024
    v_mfma_f32_16x16x32_bf16 v[68:71], a[16:19], a[60:63], 0
    v_mfma_f32_16x16x32_bf16 v[84:87], a[24:27], a[60:63], 0
    s_waitcnt vmcnt(7)
    v_mfma_f32_16x16x32_bf16 v[40:43], a[0:3], a[64:67], 0
    v_mfma_f32_16x16x32_bf16 v[56:59], a[8:11], a[64:67], 0
    buffer_load_dwordx4 a[96:99], v4, s[4:7], s49 offen offset:2048
    v_mfma_f32_16x16x32_bf16 v[72:75], a[16:19], a[64:67], 0
    v_mfma_f32_16x16x32_bf16 v[88:91], a[24:27], a[64:67], 0
    s_waitcnt vmcnt(7)
    v_mfma_f32_16x16x32_bf16 v[44:47], a[0:3], a[68:71], 0
    v_mfma_f32_16x16x32_bf16 v[60:63], a[8:11], a[68:71], 0
    buffer_load_dwordx4 a[100:103], v4, s[4:7], s49 offen offset:3072
    v_mfma_f32_16x16x32_bf16 v[76:79], a[16:19], a[68:71], 0
    s_add_u32 s49, s49, 0x4000
    v_mfma_f32_16x16x32_bf16 v[92:95], a[24:27], a[68:71], 0
    s_waitcnt vmcnt(7)
    v_mfma_f32_16x16x32_bf16 v[32:35], a[4:7], a[72:75], v[32:35]
    v_mfma_f32_16x16x32_bf16 v[48:51], a[12:15], a[72:75], v[48:51]
    buffer_load_dwordx4 a[104:107], v4, s[4:7], s49 offen offset:0
    v_mfma_f32_16x16x32_bf16 v[64:67], a[20:23], a[72:75], v[64:67]
    v_mfma_f32_16x16x32_bf16 v[80:83], a[28:31], a[72:75], v[80:83]
    s_waitcnt vmcnt(7)
    v_mfma_f32_16x16x32_bf16 v[36:39], a[4:7], a[76:79], v[36:39]
    v_mfma_f32_16x16x32_bf16 v[52:55], a[12:15], a[76:79], v[52:55]
    buffer_load_dwordx4 a[108:111], v4, s[4:7], s49 offen offset:1024
    v_mfma_f32_16x16x32_bf16 v[68:71], a[20:23], a[76:79], v[68:71]
    v_mfma_f32_16x16x32_bf16 v[84:87], a[28:31], a[76:79], v[84:87]
    s_waitcnt vmcnt(7)
    v_mfma_f32_16x16x32_bf16 v[40:43], a[4:7], a[80:83], v[40:43]
    v_mfma_f32_16x16x32_bf16 v[56:59], a[12:15], a[80:83], v[56:59]
    buffer_load_dwordx4 a[112:115], v4, s[4:7], s49 offen offset:2048
    v_mfma_f32_16x16x32_bf16 v[72:75], a[20:23], a[80:83], v[72:75]
    v_mfma_f32_16x16x32_bf16 v[88:91], a[28:31], a[80:83], v[88:91]
    s_waitcnt vmcnt(7)
    v_mfma_f32_16x16x32_bf16 v[44:47], a[4:7], a[84:87], v[44:47]
    v_mfma_f32_16x16x32_bf16 v[60:63], a[12:15], a[84:87], v[60:63]
    buffer_load_dwordx4 a[116:119], v4, s[4:7], s49 offen offset:3072
    v_mfma_f32_16x16x32_bf16 v[76:79], a[20:23], a[84:87], v[76:79]
    s_add_u32 s49, s49, 0x4000
    v_mfma_f32_16x16x32_bf16 v[92:95], a[28:31], a[84:87], v[92:95]
    v_mfma_f32_16x16x32_bf16 v[96:99], a[32:35], a[56:59], 0
    ds_read_b64_tr_b16 a[0:1], v3 offset:2144
    v_mfma_f32_16x16x32_bf16 v[96:99], a[36:39], a[72:75], v[96:99]
    buffer_load_dwordx4 a[120:123], v4, s[4:7], s49 offen offset:0
    v_mfma_f32_16x16x32_bf16 v[100:103], a[32:35], a[60:63], 0
    ds_read_b64_tr_b16 a[2:3], v3 offset:10336
    v_mfma_f32_16x16x32_bf16 v[100:103], a[36:39], a[76:79], v[100:103]
    ds_read_b64_tr_b16 a[4:5], v3 offset:18528
    v_mfma_f32_16x16x32_bf16 v[104:107], a[32:35], a[64:67], 0
    ds_read_b64_tr_b16 a[6:7], v3 offset:26720
    v_mfma_f32_16x16x32_bf16 v[104:107], a[36:39], a[80:83], v[104:107]
    buffer_load_dwordx4 a[124:127], v4, s[4:7], s49 offen offset:1024
    v_mfma_f32_16x16x32_bf16 v[108:111], a[32:35], a[68:71], 0
    ds_read_b64_tr_b16 a[8:9], v3 offset:128
    v_mfma_f32_16x16x32_bf16 v[108:111], a[36:39], a[84:87], v[108:111]
    ds_read_b64_tr_b16 a[10:11], v3 offset:8320
    ds_read_b64_tr_b16 a[12:13], v3 offset:16512
    ds_read_b64_tr_b16 a[14:15], v3 offset:24704
    v_mfma_f32_16x16x32_bf16 v[124:127], a[40:43], a[68:71], 0
    ds_read_b64_tr_b16 a[16:17], v3 offset:2176
    v_mfma_f32_16x16x32_bf16 v[124:127], a[44:47], a[84:87], v[124:127]
    buffer_load_dwordx4 a[128:131], v4, s[4:7], s49 offen offset:2048
    v_mfma_f32_16x16x32_bf16 v[120:123], a[40:43], a[64:67], 0
    ds_read_b64_tr_b16 a[18:19], v3 offset:10368
    v_mfma_f32_16x16x32_bf16 v[120:123], a[44:47], a[80:83], v[120:123]
    ds_read_b64_tr_b16 a[20:21], v3 offset:18560
    v_mfma_f32_16x16x32_bf16 v[116:119], a[40:43], a[60:63], 0
    ds_read_b64_tr_b16 a[22:23], v3 offset:26752
    v_mfma_f32_16x16x32_bf16 v[116:119], a[44:47], a[76:79], v[116:119]
    buffer_load_dwordx4 a[132:135], v4, s[4:7], s49 offen offset:3072
    v_mfma_f32_16x16x32_bf16 v[112:115], a[40:43], a[56:59], 0
    s_add_u32 s49, s49, 0x4000
    v_mfma_f32_16x16x32_bf16 v[112:115], a[44:47], a[72:75], v[112:115]
    ds_read_b64_tr_b16 a[24:25], v3 offset:160
    ds_read_b64_tr_b16 a[26:27], v3 offset:8352
    ds_read_b64_tr_b16 a[28:29], v3 offset:16544
    ds_read_b64_tr_b16 a[30:31], v3 offset:24736
    s_waitcnt lgkmcnt(12)
    v_mfma_f32_16x16x32_bf16 v[128:131], a[48:51], a[56:59], 0
    ds_read_b64_tr_b16 a[32:33], v3 offset:2208
    v_mfma_f32_16x16x32_bf16 v[128:131], a[52:55], a[72:75], v[128:131]
    buffer_load_dwordx4 a[136:139], v4, s[4:7], s49 offen offset:0
    v_mfma_f32_16x16x32_bf16 v[132:135], a[48:51], a[60:63], 0
    ds_read_b64_tr_b16 a[34:35], v3 offset:10400
    v_mfma_f32_16x16x32_bf16 v[132:135], a[52:55], a[76:79], v[132:135]
    ds_read_b64_tr_b16 a[36:37], v3 offset:18592
    v_mfma_f32_16x16x32_bf16 v[136:139], a[48:51], a[64:67], 0
    ds_read_b64_tr_b16 a[38:39], v3 offset:26784
    v_mfma_f32_16x16x32_bf16 v[136:139], a[52:55], a[80:83], v[136:139]
    buffer_load_dwordx4 a[140:143], v4, s[4:7], s49 offen offset:1024
    v_mfma_f32_16x16x32_bf16 v[140:143], a[48:51], a[68:71], 0
    ds_read_b64_tr_b16 a[40:41], v3 offset:192
    v_mfma_f32_16x16x32_bf16 v[140:143], a[52:55], a[84:87], v[140:143]
    ds_read_b64_tr_b16 a[42:43], v3 offset:8384
    ds_read_b64_tr_b16 a[44:45], v3 offset:16576
    ds_read_b64_tr_b16 a[46:47], v3 offset:24768
    v_mfma_f32_16x16x32_bf16 v[156:159], a[0:3], a[68:71], 0
    ds_read_b64_tr_b16 a[48:49], v3 offset:2240
    v_mfma_f32_16x16x32_bf16 v[156:159], a[4:7], a[84:87], v[156:159]
    buffer_load_dwordx4 a[144:147], v4, s[4:7], s49 offen offset:2048
    v_mfma_f32_16x16x32_bf16 v[152:155], a[0:3], a[64:67], 0
    ds_read_b64_tr_b16 a[50:51], v3 offset:10432
    v_mfma_f32_16x16x32_bf16 v[152:155], a[4:7], a[80:83], v[152:155]
    ds_read_b64_tr_b16 a[52:53], v3 offset:18624
    v_mfma_f32_16x16x32_bf16 v[148:151], a[0:3], a[60:63], 0
    ds_read_b64_tr_b16 a[54:55], v3 offset:26816
    v_mfma_f32_16x16x32_bf16 v[148:151], a[4:7], a[76:79], v[148:151]
    buffer_load_dwordx4 a[148:151], v4, s[4:7], s49 offen offset:3072
    v_mfma_f32_16x16x32_bf16 v[144:147], a[0:3], a[56:59], 0
    s_add_u32 s49, s49, 0x4000
    v_mfma_f32_16x16x32_bf16 v[144:147], a[4:7], a[72:75], v[144:147]
    s_waitcnt vmcnt(24) lgkmcnt(0)
    s_barrier
    v_mfma_f32_16x16x32_bf16 v[160:163], a[8:11], a[56:59], 0
    s_add_u32 m0, s53, 0x0
    v_mfma_f32_16x16x32_bf16 v[160:163], a[12:15], a[72:75], v[160:163]
    buffer_load_dwordx4 v5, s[12:15], s50 offen offset:0 lds
    v_mfma_f32_16x16x32_bf16 v[164:167], a[8:11], a[60:63], 0
    ds_read_b64_tr_b16 a[0:1], v3 offset:32768
    v_mfma_f32_16x16x32_bf16 v[164:167], a[12:15], a[76:79], v[164:167]
    ds_read_b64_tr_b16 a[2:3], v3 offset:40960
    v_mfma_f32_16x16x32_bf16 v[168:171], a[8:11], a[64:67], 0
    ds_read_b64_tr_b16 a[4:5], v3 offset:49152
    v_mfma_f32_16x16x32_bf16 v[168:171], a[12:15], a[80:83], v[168:171]
    buffer_load_dwordx4 v6, s[12:15], s50 offen offset:1024 lds
    v_mfma_f32_16x16x32_bf16 v[172:175], a[8:11], a[68:71], 0
    ds_read_b64_tr_b16 a[6:7], v3 offset:57344
    v_mfma_f32_16x16x32_bf16 v[172:175], a[12:15], a[84:87], v[172:175]
    v_mfma_f32_16x16x32_bf16 v[188:191], a[16:19], a[68:71], 0
    ds_read_b64_tr_b16 a[8:9], v3 offset:34816
    v_mfma_f32_16x16x32_bf16 v[188:191], a[20:23], a[84:87], v[188:191]
    buffer_load_dwordx4 v5, s[16:19], s50 offen offset:2048 lds
    v_mfma_f32_16x16x32_bf16 v[184:187], a[16:19], a[64:67], 0
    ds_read_b64_tr_b16 a[10:11], v3 offset:43008
    v_mfma_f32_16x16x32_bf16 v[184:187], a[20:23], a[80:83], v[184:187]
    ds_read_b64_tr_b16 a[12:13], v3 offset:51200
    v_mfma_f32_16x16x32_bf16 v[180:183], a[16:19], a[60:63], 0
    ds_read_b64_tr_b16 a[14:15], v3 offset:59392
    v_mfma_f32_16x16x32_bf16 v[180:183], a[20:23], a[76:79], v[180:183]
    buffer_load_dwordx4 v6, s[16:19], s50 offen offset:3072 lds
    v_mfma_f32_16x16x32_bf16 v[176:179], a[16:19], a[56:59], 0
    s_add_u32 s50, s50, 229376
    s_add_u32 m0, s53, 0x4000
    v_mfma_f32_16x16x32_bf16 v[176:179], a[20:23], a[72:75], v[176:179]
    v_mfma_f32_16x16x32_bf16 v[192:195], a[24:27], a[56:59], 0
    ds_read_b64_tr_b16 a[16:17], v3 offset:32800
    v_mfma_f32_16x16x32_bf16 v[192:195], a[28:31], a[72:75], v[192:195]
    ds_read_b64_tr_b16 a[18:19], v3 offset:40992
    v_mfma_f32_16x16x32_bf16 v[196:199], a[24:27], a[60:63], 0
    ds_read_b64_tr_b16 a[20:21], v3 offset:49184
    v_mfma_f32_16x16x32_bf16 v[196:199], a[28:31], a[76:79], v[196:199]
    ds_read_b64_tr_b16 a[22:23], v3 offset:57376
    v_mfma_f32_16x16x32_bf16 v[200:203], a[24:27], a[64:67], 0
    v_mfma_f32_16x16x32_bf16 v[200:203], a[28:31], a[80:83], v[200:203]
    buffer_load_dwordx4 v5, s[12:15], s50 offen offset:0 lds
    v_mfma_f32_16x16x32_bf16 v[204:207], a[24:27], a[68:71], 0
    v_mfma_f32_16x16x32_bf16 v[204:207], a[28:31], a[84:87], v[204:207]
    v_mfma_f32_16x16x32_bf16 v[220:223], a[32:35], a[68:71], 0
    ds_read_b64_tr_b16 a[24:25], v3 offset:34848
    v_mfma_f32_16x16x32_bf16 v[220:223], a[36:39], a[84:87], v[220:223]
    ds_read_b64_tr_b16 a[26:27], v3 offset:43040
    v_mfma_f32_16x16x32_bf16 v[216:219], a[32:35], a[64:67], 0
    ds_read_b64_tr_b16 a[28:29], v3 offset:51232
    v_mfma_f32_16x16x32_bf16 v[216:219], a[36:39], a[80:83], v[216:219]
    ds_read_b64_tr_b16 a[30:31], v3 offset:59424
    v_mfma_f32_16x16x32_bf16 v[212:215], a[32:35], a[60:63], 0
    v_mfma_f32_16x16x32_bf16 v[212:215], a[36:39], a[76:79], v[212:215]
    buffer_load_dwordx4 v6, s[12:15], s50 offen offset:1024 lds
    v_mfma_f32_16x16x32_bf16 v[208:211], a[32:35], a[56:59], 0
    v_mfma_f32_16x16x32_bf16 v[208:211], a[36:39], a[72:75], v[208:211]
    v_mfma_f32_16x16x32_bf16 v[224:227], a[40:43], a[56:59], 0
    ds_read_b64_tr_b16 a[32:33], v3 offset:32832
    v_mfma_f32_16x16x32_bf16 v[224:227], a[44:47], a[72:75], v[224:227]
    ds_read_b64_tr_b16 a[34:35], v3 offset:41024
    v_mfma_f32_16x16x32_bf16 v[228:231], a[40:43], a[60:63], 0
    ds_read_b64_tr_b16 a[36:37], v3 offset:49216
    v_mfma_f32_16x16x32_bf16 v[228:231], a[44:47], a[76:79], v[228:231]
    ds_read_b64_tr_b16 a[38:39], v3 offset:57408
    v_mfma_f32_16x16x32_bf16 v[232:235], a[40:43], a[64:67], 0
    v_mfma_f32_16x16x32_bf16 v[232:235], a[44:47], a[80:83], v[232:235]
    buffer_load_dwordx4 v5, s[16:19], s50 offen offset:2048 lds
    v_mfma_f32_16x16x32_bf16 v[236:239], a[40:43], a[68:71], 0
    v_mfma_f32_16x16x32_bf16 v[236:239], a[44:47], a[84:87], v[236:239]
    v_mfma_f32_16x16x32_bf16 v[252:255], a[48:51], a[68:71], 0
    ds_read_b64_tr_b16 a[40:41], v3 offset:34880
    v_mfma_f32_16x16x32_bf16 v[252:255], a[52:55], a[84:87], v[252:255]
    ds_read_b64_tr_b16 a[42:43], v3 offset:43072
    v_mfma_f32_16x16x32_bf16 v[248:251], a[48:51], a[64:67], 0
    ds_read_b64_tr_b16 a[44:45], v3 offset:51264
    v_mfma_f32_16x16x32_bf16 v[248:251], a[52:55], a[80:83], v[248:251]
    ds_read_b64_tr_b16 a[46:47], v3 offset:59456
    v_mfma_f32_16x16x32_bf16 v[244:247], a[48:51], a[60:63], 0
    v_mfma_f32_16x16x32_bf16 v[244:247], a[52:55], a[76:79], v[244:247]
    buffer_load_dwordx4 v6, s[16:19], s50 offen offset:3072 lds
    v_mfma_f32_16x16x32_bf16 v[240:243], a[48:51], a[56:59], 0
    s_add_u32 s50, s50, 229376
    v_mfma_f32_16x16x32_bf16 v[240:243], a[52:55], a[72:75], v[240:243]
L_g1m:
    s_mov_b32 s54, 4
    .p2align 6
L_interlea_loop38:
    s_waitcnt vmcnt(16) lgkmcnt(12)
    v_mfma_f32_16x16x32_bf16 v[32:35], a[0:3], a[88:91], v[32:35]
    ds_read_b64_tr_b16 a[48:49], v3 offset:32864
    v_mfma_f32_16x16x32_bf16 v[32:35], a[4:7], a[104:107], v[32:35]
    buffer_load_dwordx4 a[56:59], v4, s[4:7], s49 offen offset:0
    v_mfma_f32_16x16x32_bf16 v[36:39], a[0:3], a[92:95], v[36:39]
    ds_read_b64_tr_b16 a[50:51], v3 offset:41056
    v_mfma_f32_16x16x32_bf16 v[36:39], a[4:7], a[108:111], v[36:39]
    ds_read_b64_tr_b16 a[52:53], v3 offset:49248
    v_mfma_f32_16x16x32_bf16 v[40:43], a[0:3], a[96:99], v[40:43]
    ds_read_b64_tr_b16 a[54:55], v3 offset:57440
    v_mfma_f32_16x16x32_bf16 v[40:43], a[4:7], a[112:115], v[40:43]
    buffer_load_dwordx4 a[60:63], v4, s[4:7], s49 offen offset:1024
    v_mfma_f32_16x16x32_bf16 v[44:47], a[0:3], a[100:103], v[44:47]
    v_mfma_f32_16x16x32_bf16 v[44:47], a[4:7], a[116:119], v[44:47]
    v_mfma_f32_16x16x32_bf16 v[60:63], a[8:11], a[100:103], v[60:63]
    ds_read_b64_tr_b16 a[0:1], v3 offset:34912
    v_mfma_f32_16x16x32_bf16 v[60:63], a[12:15], a[116:119], v[60:63]
    buffer_load_dwordx4 a[64:67], v4, s[4:7], s49 offen offset:2048
    v_mfma_f32_16x16x32_bf16 v[56:59], a[8:11], a[96:99], v[56:59]
    ds_read_b64_tr_b16 a[2:3], v3 offset:43104
    v_mfma_f32_16x16x32_bf16 v[56:59], a[12:15], a[112:115], v[56:59]
    ds_read_b64_tr_b16 a[4:5], v3 offset:51296
    v_mfma_f32_16x16x32_bf16 v[52:55], a[8:11], a[92:95], v[52:55]
    ds_read_b64_tr_b16 a[6:7], v3 offset:59488
    v_mfma_f32_16x16x32_bf16 v[52:55], a[12:15], a[108:111], v[52:55]
    buffer_load_dwordx4 a[68:71], v4, s[4:7], s49 offen offset:3072
    v_mfma_f32_16x16x32_bf16 v[48:51], a[8:11], a[88:91], v[48:51]
    s_add_u32 s49, s49, 0x4000
    v_mfma_f32_16x16x32_bf16 v[48:51], a[12:15], a[104:107], v[48:51]
    v_mfma_f32_16x16x32_bf16 v[64:67], a[16:19], a[88:91], v[64:67]
    ds_read_b64_tr_b16 a[8:9], v3 offset:32896
    v_mfma_f32_16x16x32_bf16 v[64:67], a[20:23], a[104:107], v[64:67]
    buffer_load_dwordx4 a[72:75], v4, s[4:7], s49 offen offset:0
    v_mfma_f32_16x16x32_bf16 v[68:71], a[16:19], a[92:95], v[68:71]
    ds_read_b64_tr_b16 a[10:11], v3 offset:41088
    v_mfma_f32_16x16x32_bf16 v[68:71], a[20:23], a[108:111], v[68:71]
    ds_read_b64_tr_b16 a[12:13], v3 offset:49280
    v_mfma_f32_16x16x32_bf16 v[72:75], a[16:19], a[96:99], v[72:75]
    ds_read_b64_tr_b16 a[14:15], v3 offset:57472
    v_mfma_f32_16x16x32_bf16 v[72:75], a[20:23], a[112:115], v[72:75]
    buffer_load_dwordx4 a[76:79], v4, s[4:7], s49 offen offset:1024
    v_mfma_f32_16x16x32_bf16 v[76:79], a[16:19], a[100:103], v[76:79]
    v_mfma_f32_16x16x32_bf16 v[76:79], a[20:23], a[116:119], v[76:79]
    s_waitcnt lgkmcnt(12)
    v_mfma_f32_16x16x32_bf16 v[92:95], a[24:27], a[100:103], v[92:95]
    ds_read_b64_tr_b16 a[16:17], v3 offset:34944
    v_mfma_f32_16x16x32_bf16 v[92:95], a[28:31], a[116:119], v[92:95]
    buffer_load_dwordx4 a[80:83], v4, s[4:7], s49 offen offset:2048
    v_mfma_f32_16x16x32_bf16 v[88:91], a[24:27], a[96:99], v[88:91]
    ds_read_b64_tr_b16 a[18:19], v3 offset:43136
    v_mfma_f32_16x16x32_bf16 v[88:91], a[28:31], a[112:115], v[88:91]
    ds_read_b64_tr_b16 a[20:21], v3 offset:51328
    v_mfma_f32_16x16x32_bf16 v[84:87], a[24:27], a[92:95], v[84:87]
    ds_read_b64_tr_b16 a[22:23], v3 offset:59520
    v_mfma_f32_16x16x32_bf16 v[84:87], a[28:31], a[108:111], v[84:87]
    buffer_load_dwordx4 a[84:87], v4, s[4:7], s49 offen offset:3072
    v_mfma_f32_16x16x32_bf16 v[80:83], a[24:27], a[88:91], v[80:83]
    s_add_u32 s49, s49, 0x4000
    v_mfma_f32_16x16x32_bf16 v[80:83], a[28:31], a[104:107], v[80:83]
    v_mfma_f32_16x16x32_bf16 v[96:99], a[32:35], a[88:91], v[96:99]
    ds_read_b64_tr_b16 a[24:25], v3 offset:32928
    v_mfma_f32_16x16x32_bf16 v[96:99], a[36:39], a[104:107], v[96:99]
    ds_read_b64_tr_b16 a[26:27], v3 offset:41120
    v_mfma_f32_16x16x32_bf16 v[100:103], a[32:35], a[92:95], v[100:103]
    ds_read_b64_tr_b16 a[28:29], v3 offset:49312
    v_mfma_f32_16x16x32_bf16 v[100:103], a[36:39], a[108:111], v[100:103]
    ds_read_b64_tr_b16 a[30:31], v3 offset:57504
    v_mfma_f32_16x16x32_bf16 v[104:107], a[32:35], a[96:99], v[104:107]
    v_mfma_f32_16x16x32_bf16 v[104:107], a[36:39], a[112:115], v[104:107]
    v_mfma_f32_16x16x32_bf16 v[108:111], a[32:35], a[100:103], v[108:111]
    v_mfma_f32_16x16x32_bf16 v[108:111], a[36:39], a[116:119], v[108:111]
    v_mfma_f32_16x16x32_bf16 v[124:127], a[40:43], a[100:103], v[124:127]
    ds_read_b64_tr_b16 a[32:33], v3 offset:34976
    v_mfma_f32_16x16x32_bf16 v[124:127], a[44:47], a[116:119], v[124:127]
    ds_read_b64_tr_b16 a[34:35], v3 offset:43168
    v_mfma_f32_16x16x32_bf16 v[120:123], a[40:43], a[96:99], v[120:123]
    ds_read_b64_tr_b16 a[36:37], v3 offset:51360
    v_mfma_f32_16x16x32_bf16 v[120:123], a[44:47], a[112:115], v[120:123]
    ds_read_b64_tr_b16 a[38:39], v3 offset:59552
    v_mfma_f32_16x16x32_bf16 v[116:119], a[40:43], a[92:95], v[116:119]
    global_load_dword a255, v[20:21], off
    v_mfma_f32_16x16x32_bf16 v[116:119], a[44:47], a[108:111], v[116:119]
    s_cmp_ge_u32 s54, 3
    s_cselect_b32 s83, -1, 0
    v_mfma_f32_16x16x32_bf16 v[112:115], a[40:43], a[88:91], v[112:115]
    v_bfi_b32 v22, s83, v25, v24
    v_mfma_f32_16x16x32_bf16 v[112:115], a[44:47], a[104:107], v[112:115]
    v_lshl_add_u64 v[20:21], v[22:23], 0, v[20:21]
    s_waitcnt lgkmcnt(12)
    v_mfma_f32_16x16x32_bf16 v[128:131], a[48:51], a[88:91], v[128:131]
    ds_read_b64_tr_b16 a[40:41], v3 offset:32960
    v_mfma_f32_16x16x32_bf16 v[128:131], a[52:55], a[104:107], v[128:131]
    ds_read_b64_tr_b16 a[42:43], v3 offset:41152
    v_mfma_f32_16x16x32_bf16 v[132:135], a[48:51], a[92:95], v[132:135]
    ds_read_b64_tr_b16 a[44:45], v3 offset:49344
    v_mfma_f32_16x16x32_bf16 v[132:135], a[52:55], a[108:111], v[132:135]
    ds_read_b64_tr_b16 a[46:47], v3 offset:57536
    v_mfma_f32_16x16x32_bf16 v[136:139], a[48:51], a[96:99], v[136:139]
    v_mfma_f32_16x16x32_bf16 v[136:139], a[52:55], a[112:115], v[136:139]
    v_mfma_f32_16x16x32_bf16 v[140:143], a[48:51], a[100:103], v[140:143]
    v_mfma_f32_16x16x32_bf16 v[140:143], a[52:55], a[116:119], v[140:143]
    v_mfma_f32_16x16x32_bf16 v[156:159], a[0:3], a[100:103], v[156:159]
    ds_read_b64_tr_b16 a[48:49], v3 offset:35008
    v_mfma_f32_16x16x32_bf16 v[156:159], a[4:7], a[116:119], v[156:159]
    ds_read_b64_tr_b16 a[50:51], v3 offset:43200
    v_mfma_f32_16x16x32_bf16 v[152:155], a[0:3], a[96:99], v[152:155]
    ds_read_b64_tr_b16 a[52:53], v3 offset:51392
    v_mfma_f32_16x16x32_bf16 v[152:155], a[4:7], a[112:115], v[152:155]
    ds_read_b64_tr_b16 a[54:55], v3 offset:59584
    v_mfma_f32_16x16x32_bf16 v[148:151], a[0:3], a[92:95], v[148:151]
    v_mfma_f32_16x16x32_bf16 v[148:151], a[4:7], a[108:111], v[148:151]
    v_mfma_f32_16x16x32_bf16 v[144:147], a[0:3], a[88:91], v[144:147]
    v_mfma_f32_16x16x32_bf16 v[144:147], a[4:7], a[104:107], v[144:147]
    s_waitcnt vmcnt(29) lgkmcnt(0)
    s_barrier
    v_mfma_f32_16x16x32_bf16 v[160:163], a[8:11], a[88:91], v[160:163]
    s_add_u32 m0, s53, 0x8000
    v_mfma_f32_16x16x32_bf16 v[160:163], a[12:15], a[104:107], v[160:163]
    buffer_load_dwordx4 v5, s[12:15], s50 offen offset:0 lds
    v_mfma_f32_16x16x32_bf16 v[164:167], a[8:11], a[92:95], v[164:167]
    ds_read_b64_tr_b16 a[0:1], v27 offset:0
    v_mfma_f32_16x16x32_bf16 v[164:167], a[12:15], a[108:111], v[164:167]
    ds_read_b64_tr_b16 a[2:3], v27 offset:8192
    v_mfma_f32_16x16x32_bf16 v[168:171], a[8:11], a[96:99], v[168:171]
    ds_read_b64_tr_b16 a[4:5], v27 offset:16384
    v_mfma_f32_16x16x32_bf16 v[168:171], a[12:15], a[112:115], v[168:171]
    buffer_load_dwordx4 v6, s[12:15], s50 offen offset:1024 lds
    v_mfma_f32_16x16x32_bf16 v[172:175], a[8:11], a[100:103], v[172:175]
    ds_read_b64_tr_b16 a[6:7], v27 offset:24576
    v_mfma_f32_16x16x32_bf16 v[172:175], a[12:15], a[116:119], v[172:175]
    v_mfma_f32_16x16x32_bf16 v[188:191], a[16:19], a[100:103], v[188:191]
    ds_read_b64_tr_b16 a[8:9], v27 offset:2048
    v_mfma_f32_16x16x32_bf16 v[188:191], a[20:23], a[116:119], v[188:191]
    buffer_load_dwordx4 v5, s[16:19], s50 offen offset:2048 lds
    v_mfma_f32_16x16x32_bf16 v[184:187], a[16:19], a[96:99], v[184:187]
    ds_read_b64_tr_b16 a[10:11], v27 offset:10240
    v_mfma_f32_16x16x32_bf16 v[184:187], a[20:23], a[112:115], v[184:187]
    ds_read_b64_tr_b16 a[12:13], v27 offset:18432
    v_mfma_f32_16x16x32_bf16 v[180:183], a[16:19], a[92:95], v[180:183]
    ds_read_b64_tr_b16 a[14:15], v27 offset:26624
    v_mfma_f32_16x16x32_bf16 v[180:183], a[20:23], a[108:111], v[180:183]
    buffer_load_dwordx4 v6, s[16:19], s50 offen offset:3072 lds
    v_mfma_f32_16x16x32_bf16 v[176:179], a[16:19], a[88:91], v[176:179]
    s_add_u32 s50, s50, 229376
    s_add_u32 m0, s53, 0xc000
    v_mfma_f32_16x16x32_bf16 v[176:179], a[20:23], a[104:107], v[176:179]
    v_mfma_f32_16x16x32_bf16 v[192:195], a[24:27], a[88:91], v[192:195]
    ds_read_b64_tr_b16 a[16:17], v27 offset:32
    v_mfma_f32_16x16x32_bf16 v[192:195], a[28:31], a[104:107], v[192:195]
    ds_read_b64_tr_b16 a[18:19], v27 offset:8224
    v_mfma_f32_16x16x32_bf16 v[196:199], a[24:27], a[92:95], v[196:199]
    ds_read_b64_tr_b16 a[20:21], v27 offset:16416
    v_mfma_f32_16x16x32_bf16 v[196:199], a[28:31], a[108:111], v[196:199]
    ds_read_b64_tr_b16 a[22:23], v27 offset:24608
    v_mfma_f32_16x16x32_bf16 v[200:203], a[24:27], a[96:99], v[200:203]
    v_mfma_f32_16x16x32_bf16 v[200:203], a[28:31], a[112:115], v[200:203]
    buffer_load_dwordx4 v5, s[12:15], s50 offen offset:0 lds
    v_mfma_f32_16x16x32_bf16 v[204:207], a[24:27], a[100:103], v[204:207]
    v_mfma_f32_16x16x32_bf16 v[204:207], a[28:31], a[116:119], v[204:207]
    v_mfma_f32_16x16x32_bf16 v[220:223], a[32:35], a[100:103], v[220:223]
    ds_read_b64_tr_b16 a[24:25], v27 offset:2080
    v_mfma_f32_16x16x32_bf16 v[220:223], a[36:39], a[116:119], v[220:223]
    ds_read_b64_tr_b16 a[26:27], v27 offset:10272
    v_mfma_f32_16x16x32_bf16 v[216:219], a[32:35], a[96:99], v[216:219]
    ds_read_b64_tr_b16 a[28:29], v27 offset:18464
    v_mfma_f32_16x16x32_bf16 v[216:219], a[36:39], a[112:115], v[216:219]
    ds_read_b64_tr_b16 a[30:31], v27 offset:26656
    v_mfma_f32_16x16x32_bf16 v[212:215], a[32:35], a[92:95], v[212:215]
    v_mfma_f32_16x16x32_bf16 v[212:215], a[36:39], a[108:111], v[212:215]
    buffer_load_dwordx4 v6, s[12:15], s50 offen offset:1024 lds
    v_mfma_f32_16x16x32_bf16 v[208:211], a[32:35], a[88:91], v[208:211]
    v_mfma_f32_16x16x32_bf16 v[208:211], a[36:39], a[104:107], v[208:211]
    v_mfma_f32_16x16x32_bf16 v[224:227], a[40:43], a[88:91], v[224:227]
    ds_read_b64_tr_b16 a[32:33], v27 offset:64
    v_mfma_f32_16x16x32_bf16 v[224:227], a[44:47], a[104:107], v[224:227]
    ds_read_b64_tr_b16 a[34:35], v27 offset:8256
    v_mfma_f32_16x16x32_bf16 v[228:231], a[40:43], a[92:95], v[228:231]
    ds_read_b64_tr_b16 a[36:37], v27 offset:16448
    v_mfma_f32_16x16x32_bf16 v[228:231], a[44:47], a[108:111], v[228:231]
    ds_read_b64_tr_b16 a[38:39], v27 offset:24640
    v_mfma_f32_16x16x32_bf16 v[232:235], a[40:43], a[96:99], v[232:235]
    v_mfma_f32_16x16x32_bf16 v[232:235], a[44:47], a[112:115], v[232:235]
    buffer_load_dwordx4 v5, s[16:19], s50 offen offset:2048 lds
    v_mfma_f32_16x16x32_bf16 v[236:239], a[40:43], a[100:103], v[236:239]
    v_mfma_f32_16x16x32_bf16 v[236:239], a[44:47], a[116:119], v[236:239]
    v_mfma_f32_16x16x32_bf16 v[252:255], a[48:51], a[100:103], v[252:255]
    ds_read_b64_tr_b16 a[40:41], v27 offset:2112
    v_mfma_f32_16x16x32_bf16 v[252:255], a[52:55], a[116:119], v[252:255]
    ds_read_b64_tr_b16 a[42:43], v27 offset:10304
    v_mfma_f32_16x16x32_bf16 v[248:251], a[48:51], a[96:99], v[248:251]
    ds_read_b64_tr_b16 a[44:45], v27 offset:18496
    v_mfma_f32_16x16x32_bf16 v[248:251], a[52:55], a[112:115], v[248:251]
    ds_read_b64_tr_b16 a[46:47], v27 offset:26688
    v_mfma_f32_16x16x32_bf16 v[244:247], a[48:51], a[92:95], v[244:247]
    v_mfma_f32_16x16x32_bf16 v[244:247], a[52:55], a[108:111], v[244:247]
    buffer_load_dwordx4 v6, s[16:19], s50 offen offset:3072 lds
    v_mfma_f32_16x16x32_bf16 v[240:243], a[48:51], a[88:91], v[240:243]
    s_add_u32 s50, s50, 229376
    v_mfma_f32_16x16x32_bf16 v[240:243], a[52:55], a[104:107], v[240:243]
    s_waitcnt vmcnt(25) lgkmcnt(12)
    v_mfma_f32_16x16x32_bf16 v[32:35], a[0:3], a[120:123], v[32:35]
    ds_read_b64_tr_b16 a[48:49], v27 offset:96
    v_mfma_f32_16x16x32_bf16 v[32:35], a[4:7], a[136:139], v[32:35]
    buffer_load_dwordx4 a[88:91], v4, s[4:7], s49 offen offset:0
    v_mfma_f32_16x16x32_bf16 v[36:39], a[0:3], a[124:127], v[36:39]
    ds_read_b64_tr_b16 a[50:51], v27 offset:8288
    v_mfma_f32_16x16x32_bf16 v[36:39], a[4:7], a[140:143], v[36:39]
    ds_read_b64_tr_b16 a[52:53], v27 offset:16480
    v_mfma_f32_16x16x32_bf16 v[40:43], a[0:3], a[128:131], v[40:43]
    ds_read_b64_tr_b16 a[54:55], v27 offset:24672
    v_mfma_f32_16x16x32_bf16 v[40:43], a[4:7], a[144:147], v[40:43]
    buffer_load_dwordx4 a[92:95], v4, s[4:7], s49 offen offset:1024
    v_mfma_f32_16x16x32_bf16 v[44:47], a[0:3], a[132:135], v[44:47]
    v_mfma_f32_16x16x32_bf16 v[44:47], a[4:7], a[148:151], v[44:47]
    v_mfma_f32_16x16x32_bf16 v[60:63], a[8:11], a[132:135], v[60:63]
    ds_read_b64_tr_b16 a[0:1], v27 offset:2144
    v_mfma_f32_16x16x32_bf16 v[60:63], a[12:15], a[148:151], v[60:63]
    buffer_load_dwordx4 a[96:99], v4, s[4:7], s49 offen offset:2048
    v_mfma_f32_16x16x32_bf16 v[56:59], a[8:11], a[128:131], v[56:59]
    ds_read_b64_tr_b16 a[2:3], v27 offset:10336
    v_mfma_f32_16x16x32_bf16 v[56:59], a[12:15], a[144:147], v[56:59]
    ds_read_b64_tr_b16 a[4:5], v27 offset:18528
    v_mfma_f32_16x16x32_bf16 v[52:55], a[8:11], a[124:127], v[52:55]
    ds_read_b64_tr_b16 a[6:7], v27 offset:26720
    v_mfma_f32_16x16x32_bf16 v[52:55], a[12:15], a[140:143], v[52:55]
    buffer_load_dwordx4 a[100:103], v4, s[4:7], s49 offen offset:3072
    v_mfma_f32_16x16x32_bf16 v[48:51], a[8:11], a[120:123], v[48:51]
    s_add_u32 s49, s49, 0x4000
    v_mfma_f32_16x16x32_bf16 v[48:51], a[12:15], a[136:139], v[48:51]
    v_mfma_f32_16x16x32_bf16 v[64:67], a[16:19], a[120:123], v[64:67]
    ds_read_b64_tr_b16 a[8:9], v27 offset:128
    v_mfma_f32_16x16x32_bf16 v[64:67], a[20:23], a[136:139], v[64:67]
    buffer_load_dwordx4 a[104:107], v4, s[4:7], s49 offen offset:0
    v_mfma_f32_16x16x32_bf16 v[68:71], a[16:19], a[124:127], v[68:71]
    ds_read_b64_tr_b16 a[10:11], v27 offset:8320
    v_mfma_f32_16x16x32_bf16 v[68:71], a[20:23], a[140:143], v[68:71]
    ds_read_b64_tr_b16 a[12:13], v27 offset:16512
    v_mfma_f32_16x16x32_bf16 v[72:75], a[16:19], a[128:131], v[72:75]
    ds_read_b64_tr_b16 a[14:15], v27 offset:24704
    v_mfma_f32_16x16x32_bf16 v[72:75], a[20:23], a[144:147], v[72:75]
    buffer_load_dwordx4 a[108:111], v4, s[4:7], s49 offen offset:1024
    v_mfma_f32_16x16x32_bf16 v[76:79], a[16:19], a[132:135], v[76:79]
    v_mfma_f32_16x16x32_bf16 v[76:79], a[20:23], a[148:151], v[76:79]
    s_waitcnt lgkmcnt(12)
    v_mfma_f32_16x16x32_bf16 v[92:95], a[24:27], a[132:135], v[92:95]
    ds_read_b64_tr_b16 a[16:17], v27 offset:2176
    v_mfma_f32_16x16x32_bf16 v[92:95], a[28:31], a[148:151], v[92:95]
    buffer_load_dwordx4 a[112:115], v4, s[4:7], s49 offen offset:2048
    v_mfma_f32_16x16x32_bf16 v[88:91], a[24:27], a[128:131], v[88:91]
    ds_read_b64_tr_b16 a[18:19], v27 offset:10368
    v_mfma_f32_16x16x32_bf16 v[88:91], a[28:31], a[144:147], v[88:91]
    ds_read_b64_tr_b16 a[20:21], v27 offset:18560
    v_mfma_f32_16x16x32_bf16 v[84:87], a[24:27], a[124:127], v[84:87]
    ds_read_b64_tr_b16 a[22:23], v27 offset:26752
    v_mfma_f32_16x16x32_bf16 v[84:87], a[28:31], a[140:143], v[84:87]
    buffer_load_dwordx4 a[116:119], v4, s[4:7], s49 offen offset:3072
    v_mfma_f32_16x16x32_bf16 v[80:83], a[24:27], a[120:123], v[80:83]
    s_add_u32 s49, s49, 0x4000
    v_mfma_f32_16x16x32_bf16 v[80:83], a[28:31], a[136:139], v[80:83]
    v_mfma_f32_16x16x32_bf16 v[96:99], a[32:35], a[120:123], v[96:99]
    ds_read_b64_tr_b16 a[24:25], v27 offset:160
    v_mfma_f32_16x16x32_bf16 v[96:99], a[36:39], a[136:139], v[96:99]
    ds_read_b64_tr_b16 a[26:27], v27 offset:8352
    v_mfma_f32_16x16x32_bf16 v[100:103], a[32:35], a[124:127], v[100:103]
    ds_read_b64_tr_b16 a[28:29], v27 offset:16544
    v_mfma_f32_16x16x32_bf16 v[100:103], a[36:39], a[140:143], v[100:103]
    ds_read_b64_tr_b16 a[30:31], v27 offset:24736
    v_mfma_f32_16x16x32_bf16 v[104:107], a[32:35], a[128:131], v[104:107]
    v_mfma_f32_16x16x32_bf16 v[104:107], a[36:39], a[144:147], v[104:107]
    v_mfma_f32_16x16x32_bf16 v[108:111], a[32:35], a[132:135], v[108:111]
    v_mfma_f32_16x16x32_bf16 v[108:111], a[36:39], a[148:151], v[108:111]
    v_mfma_f32_16x16x32_bf16 v[124:127], a[40:43], a[132:135], v[124:127]
    ds_read_b64_tr_b16 a[32:33], v27 offset:2208
    v_mfma_f32_16x16x32_bf16 v[124:127], a[44:47], a[148:151], v[124:127]
    ds_read_b64_tr_b16 a[34:35], v27 offset:10400
    v_mfma_f32_16x16x32_bf16 v[120:123], a[40:43], a[128:131], v[120:123]
    ds_read_b64_tr_b16 a[36:37], v27 offset:18592
    v_mfma_f32_16x16x32_bf16 v[120:123], a[44:47], a[144:147], v[120:123]
    ds_read_b64_tr_b16 a[38:39], v27 offset:26784
    v_mfma_f32_16x16x32_bf16 v[116:119], a[40:43], a[124:127], v[116:119]
    global_load_dword a255, v[20:21], off
    v_mfma_f32_16x16x32_bf16 v[116:119], a[44:47], a[140:143], v[116:119]
    s_cmp_ge_u32 s54, 4
    s_cselect_b32 s83, -1, 0
    v_mfma_f32_16x16x32_bf16 v[112:115], a[40:43], a[120:123], v[112:115]
    v_bfi_b32 v22, s83, v25, v24
    v_mfma_f32_16x16x32_bf16 v[112:115], a[44:47], a[136:139], v[112:115]
    v_lshl_add_u64 v[20:21], v[22:23], 0, v[20:21]
    s_waitcnt lgkmcnt(12)
    v_mfma_f32_16x16x32_bf16 v[128:131], a[48:51], a[120:123], v[128:131]
    ds_read_b64_tr_b16 a[40:41], v27 offset:192
    v_mfma_f32_16x16x32_bf16 v[128:131], a[52:55], a[136:139], v[128:131]
    ds_read_b64_tr_b16 a[42:43], v27 offset:8384
    v_mfma_f32_16x16x32_bf16 v[132:135], a[48:51], a[124:127], v[132:135]
    ds_read_b64_tr_b16 a[44:45], v27 offset:16576
    v_mfma_f32_16x16x32_bf16 v[132:135], a[52:55], a[140:143], v[132:135]
    ds_read_b64_tr_b16 a[46:47], v27 offset:24768
    v_mfma_f32_16x16x32_bf16 v[136:139], a[48:51], a[128:131], v[136:139]
    v_mfma_f32_16x16x32_bf16 v[136:139], a[52:55], a[144:147], v[136:139]
    v_mfma_f32_16x16x32_bf16 v[140:143], a[48:51], a[132:135], v[140:143]
    v_mfma_f32_16x16x32_bf16 v[140:143], a[52:55], a[148:151], v[140:143]
    v_mfma_f32_16x16x32_bf16 v[156:159], a[0:3], a[132:135], v[156:159]
    ds_read_b64_tr_b16 a[48:49], v27 offset:2240
    v_mfma_f32_16x16x32_bf16 v[156:159], a[4:7], a[148:151], v[156:159]
    ds_read_b64_tr_b16 a[50:51], v27 offset:10432
    v_mfma_f32_16x16x32_bf16 v[152:155], a[0:3], a[128:131], v[152:155]
    ds_read_b64_tr_b16 a[52:53], v27 offset:18624
    v_mfma_f32_16x16x32_bf16 v[152:155], a[4:7], a[144:147], v[152:155]
    ds_read_b64_tr_b16 a[54:55], v27 offset:26816
    v_mfma_f32_16x16x32_bf16 v[148:151], a[0:3], a[124:127], v[148:151]
    v_mfma_f32_16x16x32_bf16 v[148:151], a[4:7], a[140:143], v[148:151]
    v_mfma_f32_16x16x32_bf16 v[144:147], a[0:3], a[120:123], v[144:147]
    v_mfma_f32_16x16x32_bf16 v[144:147], a[4:7], a[136:139], v[144:147]
    s_waitcnt vmcnt(26) lgkmcnt(0)
    s_barrier
    v_mfma_f32_16x16x32_bf16 v[160:163], a[8:11], a[120:123], v[160:163]
    s_add_u32 m0, s53, 0x20000
    v_mfma_f32_16x16x32_bf16 v[160:163], a[12:15], a[136:139], v[160:163]
    buffer_load_dwordx4 v5, s[12:15], s50 offen offset:0 lds
    v_mfma_f32_16x16x32_bf16 v[164:167], a[8:11], a[124:127], v[164:167]
    ds_read_b64_tr_b16 a[0:1], v3 offset:0
    v_mfma_f32_16x16x32_bf16 v[164:167], a[12:15], a[140:143], v[164:167]
    ds_read_b64_tr_b16 a[2:3], v3 offset:8192
    v_mfma_f32_16x16x32_bf16 v[168:171], a[8:11], a[128:131], v[168:171]
    ds_read_b64_tr_b16 a[4:5], v3 offset:16384
    v_mfma_f32_16x16x32_bf16 v[168:171], a[12:15], a[144:147], v[168:171]
    buffer_load_dwordx4 v6, s[12:15], s50 offen offset:1024 lds
    v_mfma_f32_16x16x32_bf16 v[172:175], a[8:11], a[132:135], v[172:175]
    ds_read_b64_tr_b16 a[6:7], v3 offset:24576
    v_mfma_f32_16x16x32_bf16 v[172:175], a[12:15], a[148:151], v[172:175]
    v_mfma_f32_16x16x32_bf16 v[188:191], a[16:19], a[132:135], v[188:191]
    ds_read_b64_tr_b16 a[8:9], v3 offset:2048
    v_mfma_f32_16x16x32_bf16 v[188:191], a[20:23], a[148:151], v[188:191]
    buffer_load_dwordx4 v5, s[16:19], s50 offen offset:2048 lds
    v_mfma_f32_16x16x32_bf16 v[184:187], a[16:19], a[128:131], v[184:187]
    ds_read_b64_tr_b16 a[10:11], v3 offset:10240
    v_mfma_f32_16x16x32_bf16 v[184:187], a[20:23], a[144:147], v[184:187]
    ds_read_b64_tr_b16 a[12:13], v3 offset:18432
    v_mfma_f32_16x16x32_bf16 v[180:183], a[16:19], a[124:127], v[180:183]
    ds_read_b64_tr_b16 a[14:15], v3 offset:26624
    v_mfma_f32_16x16x32_bf16 v[180:183], a[20:23], a[140:143], v[180:183]
    buffer_load_dwordx4 v6, s[16:19], s50 offen offset:3072 lds
    v_mfma_f32_16x16x32_bf16 v[176:179], a[16:19], a[120:123], v[176:179]
    s_add_u32 s50, s50, 229376
    s_add_u32 m0, s53, 0x24000
    v_mfma_f32_16x16x32_bf16 v[176:179], a[20:23], a[136:139], v[176:179]
    v_mfma_f32_16x16x32_bf16 v[192:195], a[24:27], a[120:123], v[192:195]
    ds_read_b64_tr_b16 a[16:17], v3 offset:32
    v_mfma_f32_16x16x32_bf16 v[192:195], a[28:31], a[136:139], v[192:195]
    ds_read_b64_tr_b16 a[18:19], v3 offset:8224
    v_mfma_f32_16x16x32_bf16 v[196:199], a[24:27], a[124:127], v[196:199]
    ds_read_b64_tr_b16 a[20:21], v3 offset:16416
    v_mfma_f32_16x16x32_bf16 v[196:199], a[28:31], a[140:143], v[196:199]
    ds_read_b64_tr_b16 a[22:23], v3 offset:24608
    v_mfma_f32_16x16x32_bf16 v[200:203], a[24:27], a[128:131], v[200:203]
    v_mfma_f32_16x16x32_bf16 v[200:203], a[28:31], a[144:147], v[200:203]
    buffer_load_dwordx4 v5, s[12:15], s50 offen offset:0 lds
    v_mfma_f32_16x16x32_bf16 v[204:207], a[24:27], a[132:135], v[204:207]
    v_mfma_f32_16x16x32_bf16 v[204:207], a[28:31], a[148:151], v[204:207]
    v_mfma_f32_16x16x32_bf16 v[220:223], a[32:35], a[132:135], v[220:223]
    ds_read_b64_tr_b16 a[24:25], v3 offset:2080
    v_mfma_f32_16x16x32_bf16 v[220:223], a[36:39], a[148:151], v[220:223]
    ds_read_b64_tr_b16 a[26:27], v3 offset:10272
    v_mfma_f32_16x16x32_bf16 v[216:219], a[32:35], a[128:131], v[216:219]
    ds_read_b64_tr_b16 a[28:29], v3 offset:18464
    v_mfma_f32_16x16x32_bf16 v[216:219], a[36:39], a[144:147], v[216:219]
    ds_read_b64_tr_b16 a[30:31], v3 offset:26656
    v_mfma_f32_16x16x32_bf16 v[212:215], a[32:35], a[124:127], v[212:215]
    v_mfma_f32_16x16x32_bf16 v[212:215], a[36:39], a[140:143], v[212:215]
    buffer_load_dwordx4 v6, s[12:15], s50 offen offset:1024 lds
    v_mfma_f32_16x16x32_bf16 v[208:211], a[32:35], a[120:123], v[208:211]
    v_mfma_f32_16x16x32_bf16 v[208:211], a[36:39], a[136:139], v[208:211]
    v_mfma_f32_16x16x32_bf16 v[224:227], a[40:43], a[120:123], v[224:227]
    ds_read_b64_tr_b16 a[32:33], v3 offset:64
    v_mfma_f32_16x16x32_bf16 v[224:227], a[44:47], a[136:139], v[224:227]
    ds_read_b64_tr_b16 a[34:35], v3 offset:8256
    v_mfma_f32_16x16x32_bf16 v[228:231], a[40:43], a[124:127], v[228:231]
    ds_read_b64_tr_b16 a[36:37], v3 offset:16448
    v_mfma_f32_16x16x32_bf16 v[228:231], a[44:47], a[140:143], v[228:231]
    ds_read_b64_tr_b16 a[38:39], v3 offset:24640
    v_mfma_f32_16x16x32_bf16 v[232:235], a[40:43], a[128:131], v[232:235]
    v_mfma_f32_16x16x32_bf16 v[232:235], a[44:47], a[144:147], v[232:235]
    buffer_load_dwordx4 v5, s[16:19], s50 offen offset:2048 lds
    v_mfma_f32_16x16x32_bf16 v[236:239], a[40:43], a[132:135], v[236:239]
    v_mfma_f32_16x16x32_bf16 v[236:239], a[44:47], a[148:151], v[236:239]
    v_mfma_f32_16x16x32_bf16 v[252:255], a[48:51], a[132:135], v[252:255]
    ds_read_b64_tr_b16 a[40:41], v3 offset:2112
    v_mfma_f32_16x16x32_bf16 v[252:255], a[52:55], a[148:151], v[252:255]
    ds_read_b64_tr_b16 a[42:43], v3 offset:10304
    v_mfma_f32_16x16x32_bf16 v[248:251], a[48:51], a[128:131], v[248:251]
    ds_read_b64_tr_b16 a[44:45], v3 offset:18496
    v_mfma_f32_16x16x32_bf16 v[248:251], a[52:55], a[144:147], v[248:251]
    ds_read_b64_tr_b16 a[46:47], v3 offset:26688
    v_mfma_f32_16x16x32_bf16 v[244:247], a[48:51], a[124:127], v[244:247]
    v_mfma_f32_16x16x32_bf16 v[244:247], a[52:55], a[140:143], v[244:247]
    buffer_load_dwordx4 v6, s[16:19], s50 offen offset:3072 lds
    v_mfma_f32_16x16x32_bf16 v[240:243], a[48:51], a[120:123], v[240:243]
    s_add_u32 s50, s50, 229376
    v_mfma_f32_16x16x32_bf16 v[240:243], a[52:55], a[136:139], v[240:243]
    s_waitcnt vmcnt(26) lgkmcnt(12)
    v_mfma_f32_16x16x32_bf16 v[32:35], a[0:3], a[56:59], v[32:35]
    ds_read_b64_tr_b16 a[48:49], v3 offset:96
    v_mfma_f32_16x16x32_bf16 v[32:35], a[4:7], a[72:75], v[32:35]
    buffer_load_dwordx4 a[120:123], v4, s[4:7], s49 offen offset:0
    v_mfma_f32_16x16x32_bf16 v[36:39], a[0:3], a[60:63], v[36:39]
    ds_read_b64_tr_b16 a[50:51], v3 offset:8288
    v_mfma_f32_16x16x32_bf16 v[36:39], a[4:7], a[76:79], v[36:39]
    ds_read_b64_tr_b16 a[52:53], v3 offset:16480
    v_mfma_f32_16x16x32_bf16 v[40:43], a[0:3], a[64:67], v[40:43]
    ds_read_b64_tr_b16 a[54:55], v3 offset:24672
    v_mfma_f32_16x16x32_bf16 v[40:43], a[4:7], a[80:83], v[40:43]
    buffer_load_dwordx4 a[124:127], v4, s[4:7], s49 offen offset:1024
    v_mfma_f32_16x16x32_bf16 v[44:47], a[0:3], a[68:71], v[44:47]
    v_mfma_f32_16x16x32_bf16 v[44:47], a[4:7], a[84:87], v[44:47]
    v_mfma_f32_16x16x32_bf16 v[60:63], a[8:11], a[68:71], v[60:63]
    ds_read_b64_tr_b16 a[0:1], v3 offset:2144
    v_mfma_f32_16x16x32_bf16 v[60:63], a[12:15], a[84:87], v[60:63]
    buffer_load_dwordx4 a[128:131], v4, s[4:7], s49 offen offset:2048
    v_mfma_f32_16x16x32_bf16 v[56:59], a[8:11], a[64:67], v[56:59]
    ds_read_b64_tr_b16 a[2:3], v3 offset:10336
    v_mfma_f32_16x16x32_bf16 v[56:59], a[12:15], a[80:83], v[56:59]
    ds_read_b64_tr_b16 a[4:5], v3 offset:18528
    v_mfma_f32_16x16x32_bf16 v[52:55], a[8:11], a[60:63], v[52:55]
    ds_read_b64_tr_b16 a[6:7], v3 offset:26720
    v_mfma_f32_16x16x32_bf16 v[52:55], a[12:15], a[76:79], v[52:55]
    buffer_load_dwordx4 a[132:135], v4, s[4:7], s49 offen offset:3072
    v_mfma_f32_16x16x32_bf16 v[48:51], a[8:11], a[56:59], v[48:51]
    s_add_u32 s49, s49, 0x4000
    v_mfma_f32_16x16x32_bf16 v[48:51], a[12:15], a[72:75], v[48:51]
    v_mfma_f32_16x16x32_bf16 v[64:67], a[16:19], a[56:59], v[64:67]
    ds_read_b64_tr_b16 a[8:9], v3 offset:128
    v_mfma_f32_16x16x32_bf16 v[64:67], a[20:23], a[72:75], v[64:67]
    buffer_load_dwordx4 a[136:139], v4, s[4:7], s49 offen offset:0
    v_mfma_f32_16x16x32_bf16 v[68:71], a[16:19], a[60:63], v[68:71]
    ds_read_b64_tr_b16 a[10:11], v3 offset:8320
    v_mfma_f32_16x16x32_bf16 v[68:71], a[20:23], a[76:79], v[68:71]
    ds_read_b64_tr_b16 a[12:13], v3 offset:16512
    v_mfma_f32_16x16x32_bf16 v[72:75], a[16:19], a[64:67], v[72:75]
    ds_read_b64_tr_b16 a[14:15], v3 offset:24704
    v_mfma_f32_16x16x32_bf16 v[72:75], a[20:23], a[80:83], v[72:75]
    buffer_load_dwordx4 a[140:143], v4, s[4:7], s49 offen offset:1024
    v_mfma_f32_16x16x32_bf16 v[76:79], a[16:19], a[68:71], v[76:79]
    v_mfma_f32_16x16x32_bf16 v[76:79], a[20:23], a[84:87], v[76:79]
    s_waitcnt lgkmcnt(12)
    v_mfma_f32_16x16x32_bf16 v[92:95], a[24:27], a[68:71], v[92:95]
    ds_read_b64_tr_b16 a[16:17], v3 offset:2176
    v_mfma_f32_16x16x32_bf16 v[92:95], a[28:31], a[84:87], v[92:95]
    buffer_load_dwordx4 a[144:147], v4, s[4:7], s49 offen offset:2048
    v_mfma_f32_16x16x32_bf16 v[88:91], a[24:27], a[64:67], v[88:91]
    ds_read_b64_tr_b16 a[18:19], v3 offset:10368
    v_mfma_f32_16x16x32_bf16 v[88:91], a[28:31], a[80:83], v[88:91]
    ds_read_b64_tr_b16 a[20:21], v3 offset:18560
    v_mfma_f32_16x16x32_bf16 v[84:87], a[24:27], a[60:63], v[84:87]
    ds_read_b64_tr_b16 a[22:23], v3 offset:26752
    v_mfma_f32_16x16x32_bf16 v[84:87], a[28:31], a[76:79], v[84:87]
    buffer_load_dwordx4 a[148:151], v4, s[4:7], s49 offen offset:3072
    v_mfma_f32_16x16x32_bf16 v[80:83], a[24:27], a[56:59], v[80:83]
    s_add_u32 s49, s49, 0x4000
    s_mov_b32 m0, s55
    v_mfma_f32_16x16x32_bf16 v[80:83], a[28:31], a[72:75], v[80:83]
    s_add_u32 s55, s55, 0x4000
    s_add_u32 s52, s52, 458752
    v_mfma_f32_16x16x32_bf16 v[96:99], a[32:35], a[56:59], v[96:99]
    s_add_u32 s38, s52, 227328
    v_mfma_f32_16x16x32_bf16 v[96:99], a[36:39], a[72:75], v[96:99]
    ds_read_b64_tr_b16 a[24:25], v3 offset:160
    v_mfma_f32_16x16x32_bf16 v[100:103], a[32:35], a[60:63], v[100:103]
    ds_read_b64_tr_b16 a[26:27], v3 offset:8352
    v_mfma_f32_16x16x32_bf16 v[100:103], a[36:39], a[76:79], v[100:103]
    ds_read_b64_tr_b16 a[28:29], v3 offset:16544
    v_mfma_f32_16x16x32_bf16 v[104:107], a[32:35], a[64:67], v[104:107]
    ds_read_b64_tr_b16 a[30:31], v3 offset:24736
    v_mfma_f32_16x16x32_bf16 v[104:107], a[36:39], a[80:83], v[104:107]
    buffer_load_dwordx4 v11, s[20:23], s52 offen offset:0 lds
    v_mfma_f32_16x16x32_bf16 v[108:111], a[32:35], a[68:71], v[108:111]
    v_mfma_f32_16x16x32_bf16 v[108:111], a[36:39], a[84:87], v[108:111]
    v_mfma_f32_16x16x32_bf16 v[124:127], a[40:43], a[68:71], v[124:127]
    ds_read_b64_tr_b16 a[32:33], v3 offset:2208
    v_mfma_f32_16x16x32_bf16 v[124:127], a[44:47], a[84:87], v[124:127]
    ds_read_b64_tr_b16 a[34:35], v3 offset:10400
    v_mfma_f32_16x16x32_bf16 v[120:123], a[40:43], a[64:67], v[120:123]
    ds_read_b64_tr_b16 a[36:37], v3 offset:18592
    v_mfma_f32_16x16x32_bf16 v[120:123], a[44:47], a[80:83], v[120:123]
    ds_read_b64_tr_b16 a[38:39], v3 offset:26784
    v_mfma_f32_16x16x32_bf16 v[116:119], a[40:43], a[60:63], v[116:119]
    v_mfma_f32_16x16x32_bf16 v[116:119], a[44:47], a[76:79], v[116:119]
    buffer_load_dwordx4 v12, s[20:23], s52 offen offset:1024 lds
    v_mfma_f32_16x16x32_bf16 v[112:115], a[40:43], a[56:59], v[112:115]
    v_mfma_f32_16x16x32_bf16 v[112:115], a[44:47], a[72:75], v[112:115]
    s_waitcnt lgkmcnt(12)
    v_mfma_f32_16x16x32_bf16 v[128:131], a[48:51], a[56:59], v[128:131]
    ds_read_b64_tr_b16 a[40:41], v3 offset:192
    v_mfma_f32_16x16x32_bf16 v[128:131], a[52:55], a[72:75], v[128:131]
    ds_read_b64_tr_b16 a[42:43], v3 offset:8384
    v_mfma_f32_16x16x32_bf16 v[132:135], a[48:51], a[60:63], v[132:135]
    ds_read_b64_tr_b16 a[44:45], v3 offset:16576
    v_mfma_f32_16x16x32_bf16 v[132:135], a[52:55], a[76:79], v[132:135]
    ds_read_b64_tr_b16 a[46:47], v3 offset:24768
    v_mfma_f32_16x16x32_bf16 v[136:139], a[48:51], a[64:67], v[136:139]
    v_mfma_f32_16x16x32_bf16 v[136:139], a[52:55], a[80:83], v[136:139]
    buffer_load_dwordx4 v11, s[20:23], s38 offen offset:2048 lds
    v_mfma_f32_16x16x32_bf16 v[140:143], a[48:51], a[68:71], v[140:143]
    v_mfma_f32_16x16x32_bf16 v[140:143], a[52:55], a[84:87], v[140:143]
    v_mfma_f32_16x16x32_bf16 v[156:159], a[0:3], a[68:71], v[156:159]
    ds_read_b64_tr_b16 a[48:49], v3 offset:2240
    v_mfma_f32_16x16x32_bf16 v[156:159], a[4:7], a[84:87], v[156:159]
    ds_read_b64_tr_b16 a[50:51], v3 offset:10432
    v_mfma_f32_16x16x32_bf16 v[152:155], a[0:3], a[64:67], v[152:155]
    ds_read_b64_tr_b16 a[52:53], v3 offset:18624
    v_mfma_f32_16x16x32_bf16 v[152:155], a[4:7], a[80:83], v[152:155]
    ds_read_b64_tr_b16 a[54:55], v3 offset:26816
    v_mfma_f32_16x16x32_bf16 v[148:151], a[0:3], a[60:63], v[148:151]
    v_mfma_f32_16x16x32_bf16 v[148:151], a[4:7], a[76:79], v[148:151]
    buffer_load_dwordx4 v12, s[20:23], s38 offen offset:3072 lds
    v_mfma_f32_16x16x32_bf16 v[144:147], a[0:3], a[56:59], v[144:147]
    v_mfma_f32_16x16x32_bf16 v[144:147], a[4:7], a[72:75], v[144:147]
    s_waitcnt vmcnt(29) lgkmcnt(0)
    s_barrier
    v_mfma_f32_16x16x32_bf16 v[160:163], a[8:11], a[56:59], v[160:163]
    s_add_u32 m0, s53, 0x0
    v_mfma_f32_16x16x32_bf16 v[160:163], a[12:15], a[72:75], v[160:163]
    buffer_load_dwordx4 v5, s[12:15], s50 offen offset:0 lds
    v_mfma_f32_16x16x32_bf16 v[164:167], a[8:11], a[60:63], v[164:167]
    ds_read_b64_tr_b16 a[0:1], v3 offset:32768
    v_mfma_f32_16x16x32_bf16 v[164:167], a[12:15], a[76:79], v[164:167]
    ds_read_b64_tr_b16 a[2:3], v3 offset:40960
    v_mfma_f32_16x16x32_bf16 v[168:171], a[8:11], a[64:67], v[168:171]
    ds_read_b64_tr_b16 a[4:5], v3 offset:49152
    v_mfma_f32_16x16x32_bf16 v[168:171], a[12:15], a[80:83], v[168:171]
    buffer_load_dwordx4 v6, s[12:15], s50 offen offset:1024 lds
    v_mfma_f32_16x16x32_bf16 v[172:175], a[8:11], a[68:71], v[172:175]
    ds_read_b64_tr_b16 a[6:7], v3 offset:57344
    v_mfma_f32_16x16x32_bf16 v[172:175], a[12:15], a[84:87], v[172:175]
    v_mfma_f32_16x16x32_bf16 v[188:191], a[16:19], a[68:71], v[188:191]
    ds_read_b64_tr_b16 a[8:9], v3 offset:34816
    v_mfma_f32_16x16x32_bf16 v[188:191], a[20:23], a[84:87], v[188:191]
    buffer_load_dwordx4 v5, s[16:19], s50 offen offset:2048 lds
    v_mfma_f32_16x16x32_bf16 v[184:187], a[16:19], a[64:67], v[184:187]
    ds_read_b64_tr_b16 a[10:11], v3 offset:43008
    v_mfma_f32_16x16x32_bf16 v[184:187], a[20:23], a[80:83], v[184:187]
    ds_read_b64_tr_b16 a[12:13], v3 offset:51200
    v_mfma_f32_16x16x32_bf16 v[180:183], a[16:19], a[60:63], v[180:183]
    ds_read_b64_tr_b16 a[14:15], v3 offset:59392
    v_mfma_f32_16x16x32_bf16 v[180:183], a[20:23], a[76:79], v[180:183]
    buffer_load_dwordx4 v6, s[16:19], s50 offen offset:3072 lds
    v_mfma_f32_16x16x32_bf16 v[176:179], a[16:19], a[56:59], v[176:179]
    s_add_u32 s50, s50, 229376
    s_add_u32 m0, s53, 0x4000
    v_mfma_f32_16x16x32_bf16 v[176:179], a[20:23], a[72:75], v[176:179]
    v_mfma_f32_16x16x32_bf16 v[192:195], a[24:27], a[56:59], v[192:195]
    ds_read_b64_tr_b16 a[16:17], v3 offset:32800
    v_mfma_f32_16x16x32_bf16 v[192:195], a[28:31], a[72:75], v[192:195]
    ds_read_b64_tr_b16 a[18:19], v3 offset:40992
    v_mfma_f32_16x16x32_bf16 v[196:199], a[24:27], a[60:63], v[196:199]
    ds_read_b64_tr_b16 a[20:21], v3 offset:49184
    v_mfma_f32_16x16x32_bf16 v[196:199], a[28:31], a[76:79], v[196:199]
    ds_read_b64_tr_b16 a[22:23], v3 offset:57376
    v_mfma_f32_16x16x32_bf16 v[200:203], a[24:27], a[64:67], v[200:203]
    v_mfma_f32_16x16x32_bf16 v[200:203], a[28:31], a[80:83], v[200:203]
    buffer_load_dwordx4 v5, s[12:15], s50 offen offset:0 lds
    v_mfma_f32_16x16x32_bf16 v[204:207], a[24:27], a[68:71], v[204:207]
    v_mfma_f32_16x16x32_bf16 v[204:207], a[28:31], a[84:87], v[204:207]
    v_mfma_f32_16x16x32_bf16 v[220:223], a[32:35], a[68:71], v[220:223]
    ds_read_b64_tr_b16 a[24:25], v3 offset:34848
    v_mfma_f32_16x16x32_bf16 v[220:223], a[36:39], a[84:87], v[220:223]
    ds_read_b64_tr_b16 a[26:27], v3 offset:43040
    v_mfma_f32_16x16x32_bf16 v[216:219], a[32:35], a[64:67], v[216:219]
    ds_read_b64_tr_b16 a[28:29], v3 offset:51232
    v_mfma_f32_16x16x32_bf16 v[216:219], a[36:39], a[80:83], v[216:219]
    ds_read_b64_tr_b16 a[30:31], v3 offset:59424
    v_mfma_f32_16x16x32_bf16 v[212:215], a[32:35], a[60:63], v[212:215]
    v_mfma_f32_16x16x32_bf16 v[212:215], a[36:39], a[76:79], v[212:215]
    buffer_load_dwordx4 v6, s[12:15], s50 offen offset:1024 lds
    v_mfma_f32_16x16x32_bf16 v[208:211], a[32:35], a[56:59], v[208:211]
    v_mfma_f32_16x16x32_bf16 v[208:211], a[36:39], a[72:75], v[208:211]
    v_mfma_f32_16x16x32_bf16 v[224:227], a[40:43], a[56:59], v[224:227]
    ds_read_b64_tr_b16 a[32:33], v3 offset:32832
    v_mfma_f32_16x16x32_bf16 v[224:227], a[44:47], a[72:75], v[224:227]
    ds_read_b64_tr_b16 a[34:35], v3 offset:41024
    v_mfma_f32_16x16x32_bf16 v[228:231], a[40:43], a[60:63], v[228:231]
    ds_read_b64_tr_b16 a[36:37], v3 offset:49216
    v_mfma_f32_16x16x32_bf16 v[228:231], a[44:47], a[76:79], v[228:231]
    ds_read_b64_tr_b16 a[38:39], v3 offset:57408
    v_mfma_f32_16x16x32_bf16 v[232:235], a[40:43], a[64:67], v[232:235]
    v_mfma_f32_16x16x32_bf16 v[232:235], a[44:47], a[80:83], v[232:235]
    buffer_load_dwordx4 v5, s[16:19], s50 offen offset:2048 lds
    v_mfma_f32_16x16x32_bf16 v[236:239], a[40:43], a[68:71], v[236:239]
    v_mfma_f32_16x16x32_bf16 v[236:239], a[44:47], a[84:87], v[236:239]
    v_mfma_f32_16x16x32_bf16 v[252:255], a[48:51], a[68:71], v[252:255]
    ds_read_b64_tr_b16 a[40:41], v3 offset:34880
    v_mfma_f32_16x16x32_bf16 v[252:255], a[52:55], a[84:87], v[252:255]
    ds_read_b64_tr_b16 a[42:43], v3 offset:43072
    v_mfma_f32_16x16x32_bf16 v[248:251], a[48:51], a[64:67], v[248:251]
    ds_read_b64_tr_b16 a[44:45], v3 offset:51264
    v_mfma_f32_16x16x32_bf16 v[248:251], a[52:55], a[80:83], v[248:251]
    ds_read_b64_tr_b16 a[46:47], v3 offset:59456
    v_mfma_f32_16x16x32_bf16 v[244:247], a[48:51], a[60:63], v[244:247]
    v_mfma_f32_16x16x32_bf16 v[244:247], a[52:55], a[76:79], v[244:247]
    buffer_load_dwordx4 v6, s[16:19], s50 offen offset:3072 lds
    v_mfma_f32_16x16x32_bf16 v[240:243], a[48:51], a[56:59], v[240:243]
    s_add_u32 s50, s50, 229376
    v_mfma_f32_16x16x32_bf16 v[240:243], a[52:55], a[72:75], v[240:243]
    s_sub_u32 s54, s54, 1
    s_cmp_lg_u32 s54, 0
    s_cbranch_scc1 L_interlea_loop38
    s_waitcnt vmcnt(29) lgkmcnt(12)
    v_mfma_f32_16x16x32_bf16 v[32:35], a[0:3], a[88:91], v[32:35]
    ds_read_b64_tr_b16 a[48:49], v3 offset:32864
    v_mfma_f32_16x16x32_bf16 v[32:35], a[4:7], a[104:107], v[32:35]
    buffer_load_dwordx4 a[56:59], v4, s[4:7], s49 offen offset:0
    v_mfma_f32_16x16x32_bf16 v[36:39], a[0:3], a[92:95], v[36:39]
    ds_read_b64_tr_b16 a[50:51], v3 offset:41056
    v_mfma_f32_16x16x32_bf16 v[36:39], a[4:7], a[108:111], v[36:39]
    ds_read_b64_tr_b16 a[52:53], v3 offset:49248
    v_mfma_f32_16x16x32_bf16 v[40:43], a[0:3], a[96:99], v[40:43]
    ds_read_b64_tr_b16 a[54:55], v3 offset:57440
    v_mfma_f32_16x16x32_bf16 v[40:43], a[4:7], a[112:115], v[40:43]
    buffer_load_dwordx4 a[60:63], v4, s[4:7], s49 offen offset:1024
    v_mfma_f32_16x16x32_bf16 v[44:47], a[0:3], a[100:103], v[44:47]
    v_mfma_f32_16x16x32_bf16 v[44:47], a[4:7], a[116:119], v[44:47]
    v_mfma_f32_16x16x32_bf16 v[60:63], a[8:11], a[100:103], v[60:63]
    ds_read_b64_tr_b16 a[0:1], v3 offset:34912
    v_mfma_f32_16x16x32_bf16 v[60:63], a[12:15], a[116:119], v[60:63]
    buffer_load_dwordx4 a[64:67], v4, s[4:7], s49 offen offset:2048
    v_mfma_f32_16x16x32_bf16 v[56:59], a[8:11], a[96:99], v[56:59]
    ds_read_b64_tr_b16 a[2:3], v3 offset:43104
    v_mfma_f32_16x16x32_bf16 v[56:59], a[12:15], a[112:115], v[56:59]
    ds_read_b64_tr_b16 a[4:5], v3 offset:51296
    v_mfma_f32_16x16x32_bf16 v[52:55], a[8:11], a[92:95], v[52:55]
    ds_read_b64_tr_b16 a[6:7], v3 offset:59488
    v_mfma_f32_16x16x32_bf16 v[52:55], a[12:15], a[108:111], v[52:55]
    buffer_load_dwordx4 a[68:71], v4, s[4:7], s49 offen offset:3072
    v_mfma_f32_16x16x32_bf16 v[48:51], a[8:11], a[88:91], v[48:51]
    s_add_u32 s49, s49, 0x4000
    v_mfma_f32_16x16x32_bf16 v[48:51], a[12:15], a[104:107], v[48:51]
    v_mfma_f32_16x16x32_bf16 v[64:67], a[16:19], a[88:91], v[64:67]
    ds_read_b64_tr_b16 a[8:9], v3 offset:32896
    v_mfma_f32_16x16x32_bf16 v[64:67], a[20:23], a[104:107], v[64:67]
    buffer_load_dwordx4 a[72:75], v4, s[4:7], s49 offen offset:0
    v_mfma_f32_16x16x32_bf16 v[68:71], a[16:19], a[92:95], v[68:71]
    ds_read_b64_tr_b16 a[10:11], v3 offset:41088
    v_mfma_f32_16x16x32_bf16 v[68:71], a[20:23], a[108:111], v[68:71]
    ds_read_b64_tr_b16 a[12:13], v3 offset:49280
    v_mfma_f32_16x16x32_bf16 v[72:75], a[16:19], a[96:99], v[72:75]
    ds_read_b64_tr_b16 a[14:15], v3 offset:57472
    v_mfma_f32_16x16x32_bf16 v[72:75], a[20:23], a[112:115], v[72:75]
    buffer_load_dwordx4 a[76:79], v4, s[4:7], s49 offen offset:1024
    v_mfma_f32_16x16x32_bf16 v[76:79], a[16:19], a[100:103], v[76:79]
    v_mfma_f32_16x16x32_bf16 v[76:79], a[20:23], a[116:119], v[76:79]
    s_waitcnt lgkmcnt(12)
    v_mfma_f32_16x16x32_bf16 v[92:95], a[24:27], a[100:103], v[92:95]
    ds_read_b64_tr_b16 a[16:17], v3 offset:34944
    v_mfma_f32_16x16x32_bf16 v[92:95], a[28:31], a[116:119], v[92:95]
    buffer_load_dwordx4 a[80:83], v4, s[4:7], s49 offen offset:2048
    v_mfma_f32_16x16x32_bf16 v[88:91], a[24:27], a[96:99], v[88:91]
    ds_read_b64_tr_b16 a[18:19], v3 offset:43136
    v_mfma_f32_16x16x32_bf16 v[88:91], a[28:31], a[112:115], v[88:91]
    ds_read_b64_tr_b16 a[20:21], v3 offset:51328
    v_mfma_f32_16x16x32_bf16 v[84:87], a[24:27], a[92:95], v[84:87]
    ds_read_b64_tr_b16 a[22:23], v3 offset:59520
    v_mfma_f32_16x16x32_bf16 v[84:87], a[28:31], a[108:111], v[84:87]
    buffer_load_dwordx4 a[84:87], v4, s[4:7], s49 offen offset:3072
    v_mfma_f32_16x16x32_bf16 v[80:83], a[24:27], a[88:91], v[80:83]
    s_add_u32 s49, s49, 0x4000
    v_mfma_f32_16x16x32_bf16 v[80:83], a[28:31], a[104:107], v[80:83]
    v_mfma_f32_16x16x32_bf16 v[96:99], a[32:35], a[88:91], v[96:99]
    ds_read_b64_tr_b16 a[24:25], v3 offset:32928
    v_mfma_f32_16x16x32_bf16 v[96:99], a[36:39], a[104:107], v[96:99]
    ds_read_b64_tr_b16 a[26:27], v3 offset:41120
    v_mfma_f32_16x16x32_bf16 v[100:103], a[32:35], a[92:95], v[100:103]
    ds_read_b64_tr_b16 a[28:29], v3 offset:49312
    v_mfma_f32_16x16x32_bf16 v[100:103], a[36:39], a[108:111], v[100:103]
    ds_read_b64_tr_b16 a[30:31], v3 offset:57504
    v_mfma_f32_16x16x32_bf16 v[104:107], a[32:35], a[96:99], v[104:107]
    v_mfma_f32_16x16x32_bf16 v[104:107], a[36:39], a[112:115], v[104:107]
    v_mfma_f32_16x16x32_bf16 v[108:111], a[32:35], a[100:103], v[108:111]
    v_mfma_f32_16x16x32_bf16 v[108:111], a[36:39], a[116:119], v[108:111]
    v_mfma_f32_16x16x32_bf16 v[124:127], a[40:43], a[100:103], v[124:127]
    ds_read_b64_tr_b16 a[32:33], v3 offset:34976
    v_mfma_f32_16x16x32_bf16 v[124:127], a[44:47], a[116:119], v[124:127]
    ds_read_b64_tr_b16 a[34:35], v3 offset:43168
    v_mfma_f32_16x16x32_bf16 v[120:123], a[40:43], a[96:99], v[120:123]
    ds_read_b64_tr_b16 a[36:37], v3 offset:51360
    v_mfma_f32_16x16x32_bf16 v[120:123], a[44:47], a[112:115], v[120:123]
    ds_read_b64_tr_b16 a[38:39], v3 offset:59552
    v_mfma_f32_16x16x32_bf16 v[116:119], a[40:43], a[92:95], v[116:119]
    v_lshlrev_b32 v25, 1, v4
    v_mfma_f32_16x16x32_bf16 v[116:119], a[44:47], a[108:111], v[116:119]
    v_and_b32 v25, 0x6000, v25
    v_mfma_f32_16x16x32_bf16 v[112:115], a[40:43], a[88:91], v[112:115]
    v_add_u32_e64 v25, v25, v16
    v_mfma_f32_16x16x32_bf16 v[112:115], a[44:47], a[104:107], v[112:115]
    s_waitcnt lgkmcnt(12)
    v_mfma_f32_16x16x32_bf16 v[128:131], a[48:51], a[88:91], v[128:131]
    ds_read_b64_tr_b16 a[40:41], v3 offset:32960
    v_mfma_f32_16x16x32_bf16 v[128:131], a[52:55], a[104:107], v[128:131]
    ds_read_b64_tr_b16 a[42:43], v3 offset:41152
    v_mfma_f32_16x16x32_bf16 v[132:135], a[48:51], a[92:95], v[132:135]
    ds_read_b64_tr_b16 a[44:45], v3 offset:49344
    v_mfma_f32_16x16x32_bf16 v[132:135], a[52:55], a[108:111], v[132:135]
    ds_read_b64_tr_b16 a[46:47], v3 offset:57536
    v_mfma_f32_16x16x32_bf16 v[136:139], a[48:51], a[96:99], v[136:139]
    v_add_u32 v25, (L_g1t-L_pc), v25
    v_mfma_f32_16x16x32_bf16 v[136:139], a[52:55], a[112:115], v[136:139]
    v_min_u32 v25, (L_end-L_pc), v25
    v_mfma_f32_16x16x32_bf16 v[140:143], a[48:51], a[100:103], v[140:143]
    global_load_dword a254, v25, s[66:67]
    v_mfma_f32_16x16x32_bf16 v[140:143], a[52:55], a[116:119], v[140:143]
    v_mfma_f32_16x16x32_bf16 v[156:159], a[0:3], a[100:103], v[156:159]
    ds_read_b64_tr_b16 a[48:49], v3 offset:35008
    v_mfma_f32_16x16x32_bf16 v[156:159], a[4:7], a[116:119], v[156:159]
    ds_read_b64_tr_b16 a[50:51], v3 offset:43200
    v_mfma_f32_16x16x32_bf16 v[152:155], a[0:3], a[96:99], v[152:155]
    ds_read_b64_tr_b16 a[52:53], v3 offset:51392
    v_mfma_f32_16x16x32_bf16 v[152:155], a[4:7], a[112:115], v[152:155]
    ds_read_b64_tr_b16 a[54:55], v3 offset:59584
    v_mfma_f32_16x16x32_bf16 v[148:151], a[0:3], a[92:95], v[148:151]
    v_mfma_f32_16x16x32_bf16 v[148:151], a[4:7], a[108:111], v[148:151]
    v_mfma_f32_16x16x32_bf16 v[144:147], a[0:3], a[88:91], v[144:147]
    v_mfma_f32_16x16x32_bf16 v[144:147], a[4:7], a[104:107], v[144:147]
    s_waitcnt vmcnt(9) lgkmcnt(0)
    s_barrier
    v_mfma_f32_16x16x32_bf16 v[160:163], a[8:11], a[88:91], v[160:163]
    s_add_u32 m0, s53, 0x8000
    s_add_u32 s52, s36, 1835008
    v_mfma_f32_16x16x32_bf16 v[160:163], a[12:15], a[104:107], v[160:163]
    s_add_u32 s38, s36, 2062336
    v_mfma_f32_16x16x32_bf16 v[164:167], a[8:11], a[92:95], v[164:167]
    ds_read_b64_tr_b16 a[0:1], v27 offset:0
    v_mfma_f32_16x16x32_bf16 v[164:167], a[12:15], a[108:111], v[164:167]
    ds_read_b64_tr_b16 a[2:3], v27 offset:8192
    v_mfma_f32_16x16x32_bf16 v[168:171], a[8:11], a[96:99], v[168:171]
    ds_read_b64_tr_b16 a[4:5], v27 offset:16384
    v_mfma_f32_16x16x32_bf16 v[168:171], a[12:15], a[112:115], v[168:171]
    buffer_load_dwordx4 v11, s[20:23], s52 offen offset:0 lds
    v_mfma_f32_16x16x32_bf16 v[172:175], a[8:11], a[100:103], v[172:175]
    ds_read_b64_tr_b16 a[6:7], v27 offset:24576
    v_mfma_f32_16x16x32_bf16 v[172:175], a[12:15], a[116:119], v[172:175]
    v_mfma_f32_16x16x32_bf16 v[188:191], a[16:19], a[100:103], v[188:191]
    ds_read_b64_tr_b16 a[8:9], v27 offset:2048
    v_mfma_f32_16x16x32_bf16 v[188:191], a[20:23], a[116:119], v[188:191]
    buffer_load_dwordx4 v12, s[20:23], s52 offen offset:1024 lds
    v_mfma_f32_16x16x32_bf16 v[184:187], a[16:19], a[96:99], v[184:187]
    ds_read_b64_tr_b16 a[10:11], v27 offset:10240
    v_mfma_f32_16x16x32_bf16 v[184:187], a[20:23], a[112:115], v[184:187]
    ds_read_b64_tr_b16 a[12:13], v27 offset:18432
    v_mfma_f32_16x16x32_bf16 v[180:183], a[16:19], a[92:95], v[180:183]
    ds_read_b64_tr_b16 a[14:15], v27 offset:26624
    v_mfma_f32_16x16x32_bf16 v[180:183], a[20:23], a[108:111], v[180:183]
    buffer_load_dwordx4 v11, s[20:23], s38 offen offset:2048 lds
    v_mfma_f32_16x16x32_bf16 v[176:179], a[16:19], a[88:91], v[176:179]
    v_mfma_f32_16x16x32_bf16 v[176:179], a[20:23], a[104:107], v[176:179]
    v_mfma_f32_16x16x32_bf16 v[192:195], a[24:27], a[88:91], v[192:195]
    ds_read_b64_tr_b16 a[16:17], v3 offset:0
    v_mfma_f32_16x16x32_bf16 v[192:195], a[28:31], a[104:107], v[192:195]
    buffer_load_dwordx4 v12, s[20:23], s38 offen offset:3072 lds
    v_mfma_f32_16x16x32_bf16 v[196:199], a[24:27], a[92:95], v[196:199]
    s_add_u32 m0, s53, 0xc000
    s_add_u32 s52, s36, 2293760
    v_mfma_f32_16x16x32_bf16 v[196:199], a[28:31], a[108:111], v[196:199]
    s_add_u32 s38, s36, 2521088
    v_mfma_f32_16x16x32_bf16 v[200:203], a[24:27], a[96:99], v[200:203]
    ds_read_b64_tr_b16 a[18:19], v3 offset:8192
    v_mfma_f32_16x16x32_bf16 v[200:203], a[28:31], a[112:115], v[200:203]
    buffer_load_dwordx4 v11, s[20:23], s52 offen offset:0 lds
    v_mfma_f32_16x16x32_bf16 v[204:207], a[24:27], a[100:103], v[204:207]
    ds_read_b64_tr_b16 a[20:21], v3 offset:16384
    v_mfma_f32_16x16x32_bf16 v[204:207], a[28:31], a[116:119], v[204:207]
    ds_read_b64_tr_b16 a[22:23], v3 offset:24576
    v_mfma_f32_16x16x32_bf16 v[220:223], a[32:35], a[100:103], v[220:223]
    ds_read_b64_tr_b16 a[24:25], v3 offset:2048
    v_mfma_f32_16x16x32_bf16 v[220:223], a[36:39], a[116:119], v[220:223]
    ds_read_b64_tr_b16 a[26:27], v3 offset:10240
    v_mfma_f32_16x16x32_bf16 v[216:219], a[32:35], a[96:99], v[216:219]
    ds_read_b64_tr_b16 a[28:29], v3 offset:18432
    v_mfma_f32_16x16x32_bf16 v[216:219], a[36:39], a[112:115], v[216:219]
    ds_read_b64_tr_b16 a[30:31], v3 offset:26624
    v_mfma_f32_16x16x32_bf16 v[212:215], a[32:35], a[92:95], v[212:215]
    v_mfma_f32_16x16x32_bf16 v[212:215], a[36:39], a[108:111], v[212:215]
    buffer_load_dwordx4 v12, s[20:23], s52 offen offset:1024 lds
    v_mfma_f32_16x16x32_bf16 v[208:211], a[32:35], a[88:91], v[208:211]
    v_mfma_f32_16x16x32_bf16 v[208:211], a[36:39], a[104:107], v[208:211]
    v_mfma_f32_16x16x32_bf16 v[224:227], a[40:43], a[88:91], v[224:227]
    ds_read_b64_tr_b16 a[32:33], v27 offset:32
    v_mfma_f32_16x16x32_bf16 v[224:227], a[44:47], a[104:107], v[224:227]
    ds_read_b64_tr_b16 a[34:35], v27 offset:8224
    v_mfma_f32_16x16x32_bf16 v[228:231], a[40:43], a[92:95], v[228:231]
    ds_read_b64_tr_b16 a[36:37], v27 offset:16416
    v_mfma_f32_16x16x32_bf16 v[228:231], a[44:47], a[108:111], v[228:231]
    ds_read_b64_tr_b16 a[38:39], v27 offset:24608
    v_mfma_f32_16x16x32_bf16 v[232:235], a[40:43], a[96:99], v[232:235]
    v_mfma_f32_16x16x32_bf16 v[232:235], a[44:47], a[112:115], v[232:235]
    buffer_load_dwordx4 v11, s[20:23], s38 offen offset:2048 lds
    v_mfma_f32_16x16x32_bf16 v[236:239], a[40:43], a[100:103], v[236:239]
    v_mfma_f32_16x16x32_bf16 v[236:239], a[44:47], a[116:119], v[236:239]
    v_mfma_f32_16x16x32_bf16 v[252:255], a[48:51], a[100:103], v[252:255]
    ds_read_b64_tr_b16 a[40:41], v27 offset:2080
    v_mfma_f32_16x16x32_bf16 v[252:255], a[52:55], a[116:119], v[252:255]
    ds_read_b64_tr_b16 a[42:43], v27 offset:10272
    v_mfma_f32_16x16x32_bf16 v[248:251], a[48:51], a[96:99], v[248:251]
    ds_read_b64_tr_b16 a[44:45], v27 offset:18464
    v_mfma_f32_16x16x32_bf16 v[248:251], a[52:55], a[112:115], v[248:251]
    ds_read_b64_tr_b16 a[46:47], v27 offset:26656
    v_mfma_f32_16x16x32_bf16 v[244:247], a[48:51], a[92:95], v[244:247]
    v_mfma_f32_16x16x32_bf16 v[244:247], a[52:55], a[108:111], v[244:247]
    buffer_load_dwordx4 v12, s[20:23], s38 offen offset:3072 lds
    v_mfma_f32_16x16x32_bf16 v[240:243], a[48:51], a[88:91], v[240:243]
    v_mfma_f32_16x16x32_bf16 v[240:243], a[52:55], a[104:107], v[240:243]
L_g1t:
    s_waitcnt vmcnt(29) lgkmcnt(12)
    v_mfma_f32_16x16x32_bf16 v[32:35], a[0:3], a[120:123], v[32:35]
    ds_read_b64_tr_b16 a[88:89], v3 offset:32
    v_mfma_f32_16x16x32_bf16 v[32:35], a[4:7], a[136:139], v[32:35]
    ds_read_b64_tr_b16 a[90:91], v3 offset:8224
    v_mfma_f32_16x16x32_bf16 v[36:39], a[0:3], a[124:127], v[36:39]
    ds_read_b64_tr_b16 a[92:93], v3 offset:16416
    v_mfma_f32_16x16x32_bf16 v[36:39], a[4:7], a[140:143], v[36:39]
    ds_read_b64_tr_b16 a[94:95], v3 offset:24608
    v_mfma_f32_16x16x32_bf16 v[40:43], a[0:3], a[128:131], v[40:43]
    ds_read_b64_tr_b16 a[96:97], v3 offset:2080
    v_mfma_f32_16x16x32_bf16 v[40:43], a[4:7], a[144:147], v[40:43]
    ds_read_b64_tr_b16 a[98:99], v3 offset:10272
    v_mfma_f32_16x16x32_bf16 v[44:47], a[0:3], a[132:135], v[44:47]
    ds_read_b64_tr_b16 a[100:101], v3 offset:18464
    v_mfma_f32_16x16x32_bf16 v[44:47], a[4:7], a[148:151], v[44:47]
    ds_read_b64_tr_b16 a[102:103], v3 offset:26656
    s_waitcnt lgkmcnt(12)
    v_mfma_f32_16x16x32_bf16 v[60:63], a[8:11], a[132:135], v[60:63]
    ds_read_b64_tr_b16 a[104:105], v27 offset:64
    v_mfma_f32_16x16x32_bf16 v[60:63], a[12:15], a[148:151], v[60:63]
    ds_read_b64_tr_b16 a[106:107], v27 offset:8256
    v_mfma_f32_16x16x32_bf16 v[56:59], a[8:11], a[128:131], v[56:59]
    ds_read_b64_tr_b16 a[108:109], v27 offset:16448
    v_mfma_f32_16x16x32_bf16 v[56:59], a[12:15], a[144:147], v[56:59]
    ds_read_b64_tr_b16 a[110:111], v27 offset:24640
    v_mfma_f32_16x16x32_bf16 v[52:55], a[8:11], a[124:127], v[52:55]
    ds_read_b64_tr_b16 a[112:113], v27 offset:2112
    v_mfma_f32_16x16x32_bf16 v[52:55], a[12:15], a[140:143], v[52:55]
    ds_read_b64_tr_b16 a[114:115], v27 offset:10304
    v_mfma_f32_16x16x32_bf16 v[48:51], a[8:11], a[120:123], v[48:51]
    ds_read_b64_tr_b16 a[116:117], v27 offset:18496
    v_mfma_f32_16x16x32_bf16 v[48:51], a[12:15], a[136:139], v[48:51]
    ds_read_b64_tr_b16 a[118:119], v27 offset:26688
    s_waitcnt vmcnt(9) lgkmcnt(12)
    v_mfma_f32_16x16x32_bf16 v[32:35], a[16:19], a[56:59], v[32:35]
    ds_read_b64_tr_b16 a[48:49], v3 offset:64
    v_mfma_f32_16x16x32_bf16 v[32:35], a[20:23], a[72:75], v[32:35]
    ds_read_b64_tr_b16 a[50:51], v3 offset:8256
    v_mfma_f32_16x16x32_bf16 v[36:39], a[16:19], a[60:63], v[36:39]
    ds_read_b64_tr_b16 a[52:53], v3 offset:16448
    v_mfma_f32_16x16x32_bf16 v[36:39], a[20:23], a[76:79], v[36:39]
    ds_read_b64_tr_b16 a[54:55], v3 offset:24640
    v_mfma_f32_16x16x32_bf16 v[40:43], a[16:19], a[64:67], v[40:43]
    ds_read_b64_tr_b16 a[0:1], v3 offset:2112
    v_mfma_f32_16x16x32_bf16 v[40:43], a[20:23], a[80:83], v[40:43]
    ds_read_b64_tr_b16 a[2:3], v3 offset:10304
    v_mfma_f32_16x16x32_bf16 v[44:47], a[16:19], a[68:71], v[44:47]
    ds_read_b64_tr_b16 a[4:5], v3 offset:18496
    v_mfma_f32_16x16x32_bf16 v[44:47], a[20:23], a[84:87], v[44:47]
    ds_read_b64_tr_b16 a[6:7], v3 offset:26688
    s_waitcnt lgkmcnt(12)
    v_mfma_f32_16x16x32_bf16 v[60:63], a[24:27], a[68:71], v[60:63]
    ds_read_b64_tr_b16 a[8:9], v27 offset:96
    v_mfma_f32_16x16x32_bf16 v[60:63], a[28:31], a[84:87], v[60:63]
    ds_read_b64_tr_b16 a[10:11], v27 offset:8288
    v_mfma_f32_16x16x32_bf16 v[56:59], a[24:27], a[64:67], v[56:59]
    ds_read_b64_tr_b16 a[12:13], v27 offset:16480
    v_mfma_f32_16x16x32_bf16 v[56:59], a[28:31], a[80:83], v[56:59]
    ds_read_b64_tr_b16 a[14:15], v27 offset:24672
    v_mfma_f32_16x16x32_bf16 v[52:55], a[24:27], a[60:63], v[52:55]
    ds_read_b64_tr_b16 a[16:17], v27 offset:2144
    v_mfma_f32_16x16x32_bf16 v[52:55], a[28:31], a[76:79], v[52:55]
    ds_read_b64_tr_b16 a[18:19], v27 offset:10336
    v_mfma_f32_16x16x32_bf16 v[48:51], a[24:27], a[56:59], v[48:51]
    ds_read_b64_tr_b16 a[20:21], v27 offset:18528
    v_mfma_f32_16x16x32_bf16 v[48:51], a[28:31], a[72:75], v[48:51]
    ds_read_b64_tr_b16 a[22:23], v27 offset:26720
    s_waitcnt lgkmcnt(12)
    v_mfma_f32_16x16x32_bf16 v[64:67], a[32:35], a[120:123], v[64:67]
    ds_read_b64_tr_b16 a[24:25], v3 offset:96
    v_mfma_f32_16x16x32_bf16 v[64:67], a[36:39], a[136:139], v[64:67]
    ds_read_b64_tr_b16 a[26:27], v3 offset:8288
    v_mfma_f32_16x16x32_bf16 v[68:71], a[32:35], a[124:127], v[68:71]
    ds_read_b64_tr_b16 a[28:29], v3 offset:16480
    v_mfma_f32_16x16x32_bf16 v[68:71], a[36:39], a[140:143], v[68:71]
    ds_read_b64_tr_b16 a[30:31], v3 offset:24672
    v_mfma_f32_16x16x32_bf16 v[72:75], a[32:35], a[128:131], v[72:75]
    v_mul_f32 v40, v40, v56
    v_mul_f32 v41, v41, v57
    v_mfma_f32_16x16x32_bf16 v[72:75], a[36:39], a[144:147], v[72:75]
    v_mul_f32 v42, v42, v58
    v_mul_f32 v43, v43, v59
    v_mfma_f32_16x16x32_bf16 v[76:79], a[32:35], a[132:135], v[76:79]
    v_mul_f32 v44, v44, v60
    v_mul_f32 v45, v45, v61
    v_mfma_f32_16x16x32_bf16 v[76:79], a[36:39], a[148:151], v[76:79]
    v_mul_f32 v46, v46, v62
    v_mul_f32 v47, v47, v63
    s_waitcnt lgkmcnt(12)
    v_mfma_f32_16x16x32_bf16 v[92:95], a[40:43], a[132:135], v[92:95]
    ds_read_b64_tr_b16 a[32:33], v3 offset:2144
    v_mul_f32 v32, v32, v48
    v_mfma_f32_16x16x32_bf16 v[92:95], a[44:47], a[148:151], v[92:95]
    ds_read_b64_tr_b16 a[34:35], v3 offset:10336
    v_mul_f32 v33, v33, v49
    v_mfma_f32_16x16x32_bf16 v[88:91], a[40:43], a[128:131], v[88:91]
    ds_read_b64_tr_b16 a[36:37], v3 offset:18528
    v_mul_f32 v34, v34, v50
    v_mfma_f32_16x16x32_bf16 v[88:91], a[44:47], a[144:147], v[88:91]
    ds_read_b64_tr_b16 a[38:39], v3 offset:26720
    v_mul_f32 v35, v35, v51
    v_mfma_f32_16x16x32_bf16 v[84:87], a[40:43], a[124:127], v[84:87]
    v_mul_f32 v36, v36, v52
    v_mul_f32 v37, v37, v53
    v_mfma_f32_16x16x32_bf16 v[84:87], a[44:47], a[140:143], v[84:87]
    v_mul_f32 v38, v38, v54
    v_mul_f32 v39, v39, v55
    v_mfma_f32_16x16x32_bf16 v[80:83], a[40:43], a[120:123], v[80:83]
    v_cvt_pk_bf16_f32 v56, v40, v41
    v_cvt_pk_bf16_f32 v57, v42, v43
    v_mfma_f32_16x16x32_bf16 v[80:83], a[44:47], a[136:139], v[80:83]
    v_cvt_pk_bf16_f32 v58, v44, v45
    v_cvt_pk_bf16_f32 v59, v46, v47
    s_waitcnt lgkmcnt(12)
    v_mfma_f32_16x16x32_bf16 v[64:67], a[88:91], a[56:59], v[64:67]
    ds_read_b64_tr_b16 a[40:41], v27 offset:128
    v_cvt_pk_bf16_f32 v48, v32, v33
    v_mfma_f32_16x16x32_bf16 v[64:67], a[92:95], a[72:75], v[64:67]
    ds_read_b64_tr_b16 a[42:43], v27 offset:8320
    v_cvt_pk_bf16_f32 v49, v34, v35
    v_mfma_f32_16x16x32_bf16 v[68:71], a[88:91], a[60:63], v[68:71]
    ds_read_b64_tr_b16 a[44:45], v27 offset:16512
    v_cvt_pk_bf16_f32 v50, v36, v37
    v_mfma_f32_16x16x32_bf16 v[68:71], a[92:95], a[76:79], v[68:71]
    ds_read_b64_tr_b16 a[46:47], v27 offset:24704
    v_cvt_pk_bf16_f32 v51, v38, v39
    v_mfma_f32_16x16x32_bf16 v[72:75], a[88:91], a[64:67], v[72:75]
    v_permlane16_swap_b32 v56, v58
    v_permlane16_swap_b32 v57, v59
    v_mfma_f32_16x16x32_bf16 v[72:75], a[92:95], a[80:83], v[72:75]
    v_permlane16_swap_b32 v48, v50
    v_permlane16_swap_b32 v49, v51
    v_mfma_f32_16x16x32_bf16 v[76:79], a[88:91], a[68:71], v[76:79]
    buffer_store_dwordx4 v[48:51], v19, s[4:7], s84 offen offset:0 sc1
    v_mfma_f32_16x16x32_bf16 v[76:79], a[92:95], a[84:87], v[76:79]
    buffer_store_dwordx4 v[56:59], v19, s[4:7], s85 offen offset:0 sc1
    s_waitcnt lgkmcnt(12)
    v_mfma_f32_16x16x32_bf16 v[92:95], a[96:99], a[68:71], v[92:95]
    ds_read_b64_tr_b16 a[88:89], v27 offset:2176
    v_mfma_f32_16x16x32_bf16 v[92:95], a[100:103], a[84:87], v[92:95]
    ds_read_b64_tr_b16 a[90:91], v27 offset:10368
    v_mfma_f32_16x16x32_bf16 v[88:91], a[96:99], a[64:67], v[88:91]
    ds_read_b64_tr_b16 a[92:93], v27 offset:18560
    v_mfma_f32_16x16x32_bf16 v[88:91], a[100:103], a[80:83], v[88:91]
    ds_read_b64_tr_b16 a[94:95], v27 offset:26752
    v_mfma_f32_16x16x32_bf16 v[84:87], a[96:99], a[60:63], v[84:87]
    v_mfma_f32_16x16x32_bf16 v[84:87], a[100:103], a[76:79], v[84:87]
    v_mfma_f32_16x16x32_bf16 v[80:83], a[96:99], a[56:59], v[80:83]
    v_mfma_f32_16x16x32_bf16 v[80:83], a[100:103], a[72:75], v[80:83]
    s_waitcnt lgkmcnt(12)
    v_mfma_f32_16x16x32_bf16 v[96:99], a[104:107], a[120:123], v[96:99]
    ds_read_b64_tr_b16 a[96:97], v3 offset:128
    v_mfma_f32_16x16x32_bf16 v[96:99], a[108:111], a[136:139], v[96:99]
    ds_read_b64_tr_b16 a[98:99], v3 offset:8320
    v_mfma_f32_16x16x32_bf16 v[100:103], a[104:107], a[124:127], v[100:103]
    ds_read_b64_tr_b16 a[100:101], v3 offset:16512
    v_mfma_f32_16x16x32_bf16 v[100:103], a[108:111], a[140:143], v[100:103]
    ds_read_b64_tr_b16 a[102:103], v3 offset:24704
    v_mfma_f32_16x16x32_bf16 v[104:107], a[104:107], a[128:131], v[104:107]
    v_mul_f32 v72, v72, v88
    v_mul_f32 v73, v73, v89
    v_mfma_f32_16x16x32_bf16 v[104:107], a[108:111], a[144:147], v[104:107]
    v_mul_f32 v74, v74, v90
    v_mul_f32 v75, v75, v91
    v_mfma_f32_16x16x32_bf16 v[108:111], a[104:107], a[132:135], v[108:111]
    v_mul_f32 v76, v76, v92
    v_mul_f32 v77, v77, v93
    v_mfma_f32_16x16x32_bf16 v[108:111], a[108:111], a[148:151], v[108:111]
    v_mul_f32 v78, v78, v94
    v_mul_f32 v79, v79, v95
    s_waitcnt lgkmcnt(12)
    v_mfma_f32_16x16x32_bf16 v[124:127], a[112:115], a[132:135], v[124:127]
    ds_read_b64_tr_b16 a[104:105], v3 offset:2176
    v_mul_f32 v64, v64, v80
    v_mfma_f32_16x16x32_bf16 v[124:127], a[116:119], a[148:151], v[124:127]
    ds_read_b64_tr_b16 a[106:107], v3 offset:10368
    v_mul_f32 v65, v65, v81
    v_mfma_f32_16x16x32_bf16 v[120:123], a[112:115], a[128:131], v[120:123]
    ds_read_b64_tr_b16 a[108:109], v3 offset:18560
    v_mul_f32 v66, v66, v82
    v_mfma_f32_16x16x32_bf16 v[120:123], a[116:119], a[144:147], v[120:123]
    ds_read_b64_tr_b16 a[110:111], v3 offset:26752
    v_mul_f32 v67, v67, v83
    v_mfma_f32_16x16x32_bf16 v[116:119], a[112:115], a[124:127], v[116:119]
    v_mul_f32 v68, v68, v84
    v_mul_f32 v69, v69, v85
    v_mfma_f32_16x16x32_bf16 v[116:119], a[116:119], a[140:143], v[116:119]
    v_mul_f32 v70, v70, v86
    v_mul_f32 v71, v71, v87
    v_mfma_f32_16x16x32_bf16 v[112:115], a[112:115], a[120:123], v[112:115]
    v_cvt_pk_bf16_f32 v88, v72, v73
    v_cvt_pk_bf16_f32 v89, v74, v75
    v_mfma_f32_16x16x32_bf16 v[112:115], a[116:119], a[136:139], v[112:115]
    v_cvt_pk_bf16_f32 v90, v76, v77
    v_cvt_pk_bf16_f32 v91, v78, v79
    s_waitcnt lgkmcnt(12)
    v_mfma_f32_16x16x32_bf16 v[96:99], a[48:51], a[56:59], v[96:99]
    ds_read_b64_tr_b16 a[112:113], v27 offset:160
    v_cvt_pk_bf16_f32 v80, v64, v65
    v_mfma_f32_16x16x32_bf16 v[96:99], a[52:55], a[72:75], v[96:99]
    ds_read_b64_tr_b16 a[114:115], v27 offset:8352
    v_cvt_pk_bf16_f32 v81, v66, v67
    v_mfma_f32_16x16x32_bf16 v[100:103], a[48:51], a[60:63], v[100:103]
    ds_read_b64_tr_b16 a[116:117], v27 offset:16544
    v_cvt_pk_bf16_f32 v82, v68, v69
    v_mfma_f32_16x16x32_bf16 v[100:103], a[52:55], a[76:79], v[100:103]
    ds_read_b64_tr_b16 a[118:119], v27 offset:24736
    v_cvt_pk_bf16_f32 v83, v70, v71
    v_mfma_f32_16x16x32_bf16 v[104:107], a[48:51], a[64:67], v[104:107]
    v_permlane16_swap_b32 v88, v90
    v_permlane16_swap_b32 v89, v91
    v_mfma_f32_16x16x32_bf16 v[104:107], a[52:55], a[80:83], v[104:107]
    v_permlane16_swap_b32 v80, v82
    v_permlane16_swap_b32 v81, v83
    v_mfma_f32_16x16x32_bf16 v[108:111], a[48:51], a[68:71], v[108:111]
    buffer_store_dwordx4 v[80:83], v19, s[4:7], s84 offen offset:1024 sc1
    v_mfma_f32_16x16x32_bf16 v[108:111], a[52:55], a[84:87], v[108:111]
    buffer_store_dwordx4 v[88:91], v19, s[4:7], s85 offen offset:1024 sc1
    s_waitcnt lgkmcnt(12)
    v_mfma_f32_16x16x32_bf16 v[124:127], a[0:3], a[68:71], v[124:127]
    ds_read_b64_tr_b16 a[48:49], v27 offset:2208
    v_mfma_f32_16x16x32_bf16 v[124:127], a[4:7], a[84:87], v[124:127]
    ds_read_b64_tr_b16 a[50:51], v27 offset:10400
    v_mfma_f32_16x16x32_bf16 v[120:123], a[0:3], a[64:67], v[120:123]
    ds_read_b64_tr_b16 a[52:53], v27 offset:18592
    v_mfma_f32_16x16x32_bf16 v[120:123], a[4:7], a[80:83], v[120:123]
    ds_read_b64_tr_b16 a[54:55], v27 offset:26784
    v_mfma_f32_16x16x32_bf16 v[116:119], a[0:3], a[60:63], v[116:119]
    v_mfma_f32_16x16x32_bf16 v[116:119], a[4:7], a[76:79], v[116:119]
    v_mfma_f32_16x16x32_bf16 v[112:115], a[0:3], a[56:59], v[112:115]
    v_mfma_f32_16x16x32_bf16 v[112:115], a[4:7], a[72:75], v[112:115]
    s_waitcnt lgkmcnt(12)
    v_mfma_f32_16x16x32_bf16 v[128:131], a[8:11], a[120:123], v[128:131]
    ds_read_b64_tr_b16 a[0:1], v3 offset:160
    v_mfma_f32_16x16x32_bf16 v[128:131], a[12:15], a[136:139], v[128:131]
    ds_read_b64_tr_b16 a[2:3], v3 offset:8352
    v_mfma_f32_16x16x32_bf16 v[132:135], a[8:11], a[124:127], v[132:135]
    ds_read_b64_tr_b16 a[4:5], v3 offset:16544
    v_mfma_f32_16x16x32_bf16 v[132:135], a[12:15], a[140:143], v[132:135]
    ds_read_b64_tr_b16 a[6:7], v3 offset:24736
    v_mfma_f32_16x16x32_bf16 v[136:139], a[8:11], a[128:131], v[136:139]
    v_mul_f32 v104, v104, v120
    v_mul_f32 v105, v105, v121
    v_mfma_f32_16x16x32_bf16 v[136:139], a[12:15], a[144:147], v[136:139]
    v_mul_f32 v106, v106, v122
    v_mul_f32 v107, v107, v123
    v_mfma_f32_16x16x32_bf16 v[140:143], a[8:11], a[132:135], v[140:143]
    v_mul_f32 v108, v108, v124
    v_mul_f32 v109, v109, v125
    v_mfma_f32_16x16x32_bf16 v[140:143], a[12:15], a[148:151], v[140:143]
    v_mul_f32 v110, v110, v126
    v_mul_f32 v111, v111, v127
    s_waitcnt lgkmcnt(12)
    v_mfma_f32_16x16x32_bf16 v[156:159], a[16:19], a[132:135], v[156:159]
    ds_read_b64_tr_b16 a[8:9], v3 offset:2208
    v_mul_f32 v96, v96, v112
    v_mfma_f32_16x16x32_bf16 v[156:159], a[20:23], a[148:151], v[156:159]
    ds_read_b64_tr_b16 a[10:11], v3 offset:10400
    v_mul_f32 v97, v97, v113
    v_mfma_f32_16x16x32_bf16 v[152:155], a[16:19], a[128:131], v[152:155]
    ds_read_b64_tr_b16 a[12:13], v3 offset:18592
    v_mul_f32 v98, v98, v114
    v_mfma_f32_16x16x32_bf16 v[152:155], a[20:23], a[144:147], v[152:155]
    ds_read_b64_tr_b16 a[14:15], v3 offset:26784
    v_mul_f32 v99, v99, v115
    v_mfma_f32_16x16x32_bf16 v[148:151], a[16:19], a[124:127], v[148:151]
    v_mul_f32 v100, v100, v116
    v_mul_f32 v101, v101, v117
    v_mfma_f32_16x16x32_bf16 v[148:151], a[20:23], a[140:143], v[148:151]
    v_mul_f32 v102, v102, v118
    v_mul_f32 v103, v103, v119
    v_mfma_f32_16x16x32_bf16 v[144:147], a[16:19], a[120:123], v[144:147]
    v_cvt_pk_bf16_f32 v120, v104, v105
    v_cvt_pk_bf16_f32 v121, v106, v107
    v_mfma_f32_16x16x32_bf16 v[144:147], a[20:23], a[136:139], v[144:147]
    v_cvt_pk_bf16_f32 v122, v108, v109
    v_cvt_pk_bf16_f32 v123, v110, v111
    s_waitcnt lgkmcnt(12)
    v_mfma_f32_16x16x32_bf16 v[128:131], a[24:27], a[56:59], v[128:131]
    ds_read_b64_tr_b16 a[16:17], v27 offset:192
    v_cvt_pk_bf16_f32 v112, v96, v97
    v_mfma_f32_16x16x32_bf16 v[128:131], a[28:31], a[72:75], v[128:131]
    ds_read_b64_tr_b16 a[18:19], v27 offset:8384
    v_cvt_pk_bf16_f32 v113, v98, v99
    v_mfma_f32_16x16x32_bf16 v[132:135], a[24:27], a[60:63], v[132:135]
    ds_read_b64_tr_b16 a[20:21], v27 offset:16576
    v_cvt_pk_bf16_f32 v114, v100, v101
    v_mfma_f32_16x16x32_bf16 v[132:135], a[28:31], a[76:79], v[132:135]
    ds_read_b64_tr_b16 a[22:23], v27 offset:24768
    v_cvt_pk_bf16_f32 v115, v102, v103
    v_mfma_f32_16x16x32_bf16 v[136:139], a[24:27], a[64:67], v[136:139]
    v_permlane16_swap_b32 v120, v122
    v_permlane16_swap_b32 v121, v123
    v_mfma_f32_16x16x32_bf16 v[136:139], a[28:31], a[80:83], v[136:139]
    v_permlane16_swap_b32 v112, v114
    v_permlane16_swap_b32 v113, v115
    v_mfma_f32_16x16x32_bf16 v[140:143], a[24:27], a[68:71], v[140:143]
    buffer_store_dwordx4 v[112:115], v19, s[4:7], s86 offen offset:0 sc1
    v_mfma_f32_16x16x32_bf16 v[140:143], a[28:31], a[84:87], v[140:143]
    buffer_store_dwordx4 v[120:123], v19, s[4:7], s87 offen offset:0 sc1
    s_waitcnt lgkmcnt(12)
    v_mfma_f32_16x16x32_bf16 v[156:159], a[32:35], a[68:71], v[156:159]
    ds_read_b64_tr_b16 a[24:25], v27 offset:2240
    v_mfma_f32_16x16x32_bf16 v[156:159], a[36:39], a[84:87], v[156:159]
    ds_read_b64_tr_b16 a[26:27], v27 offset:10432
    v_mfma_f32_16x16x32_bf16 v[152:155], a[32:35], a[64:67], v[152:155]
    ds_read_b64_tr_b16 a[28:29], v27 offset:18624
    v_mfma_f32_16x16x32_bf16 v[152:155], a[36:39], a[80:83], v[152:155]
    ds_read_b64_tr_b16 a[30:31], v27 offset:26816
    v_mfma_f32_16x16x32_bf16 v[148:151], a[32:35], a[60:63], v[148:151]
    v_mfma_f32_16x16x32_bf16 v[148:151], a[36:39], a[76:79], v[148:151]
    v_mfma_f32_16x16x32_bf16 v[144:147], a[32:35], a[56:59], v[144:147]
    v_mfma_f32_16x16x32_bf16 v[144:147], a[36:39], a[72:75], v[144:147]
    s_waitcnt lgkmcnt(12)
    v_mfma_f32_16x16x32_bf16 v[160:163], a[40:43], a[120:123], v[160:163]
    ds_read_b64_tr_b16 a[32:33], v3 offset:192
    v_mfma_f32_16x16x32_bf16 v[160:163], a[44:47], a[136:139], v[160:163]
    ds_read_b64_tr_b16 a[34:35], v3 offset:8384
    v_mfma_f32_16x16x32_bf16 v[164:167], a[40:43], a[124:127], v[164:167]
    ds_read_b64_tr_b16 a[36:37], v3 offset:16576
    v_mfma_f32_16x16x32_bf16 v[164:167], a[44:47], a[140:143], v[164:167]
    ds_read_b64_tr_b16 a[38:39], v3 offset:24768
    v_mfma_f32_16x16x32_bf16 v[168:171], a[40:43], a[128:131], v[168:171]
    v_mul_f32 v136, v136, v152
    v_mul_f32 v137, v137, v153
    v_mfma_f32_16x16x32_bf16 v[168:171], a[44:47], a[144:147], v[168:171]
    v_mul_f32 v138, v138, v154
    v_mul_f32 v139, v139, v155
    v_mfma_f32_16x16x32_bf16 v[172:175], a[40:43], a[132:135], v[172:175]
    v_mul_f32 v140, v140, v156
    v_mul_f32 v141, v141, v157
    v_mfma_f32_16x16x32_bf16 v[172:175], a[44:47], a[148:151], v[172:175]
    v_mul_f32 v142, v142, v158
    v_mul_f32 v143, v143, v159
    s_waitcnt lgkmcnt(12)
    v_mfma_f32_16x16x32_bf16 v[188:191], a[88:91], a[132:135], v[188:191]
    ds_read_b64_tr_b16 a[40:41], v3 offset:2240
    v_mul_f32 v128, v128, v144
    v_mfma_f32_16x16x32_bf16 v[188:191], a[92:95], a[148:151], v[188:191]
    ds_read_b64_tr_b16 a[42:43], v3 offset:10432
    v_mul_f32 v129, v129, v145
    v_mfma_f32_16x16x32_bf16 v[184:187], a[88:91], a[128:131], v[184:187]
    ds_read_b64_tr_b16 a[44:45], v3 offset:18624
    v_mul_f32 v130, v130, v146
    v_mfma_f32_16x16x32_bf16 v[184:187], a[92:95], a[144:147], v[184:187]
    ds_read_b64_tr_b16 a[46:47], v3 offset:26816
    v_mul_f32 v131, v131, v147
    v_mfma_f32_16x16x32_bf16 v[180:183], a[88:91], a[124:127], v[180:183]
    v_mul_f32 v132, v132, v148
    v_mul_f32 v133, v133, v149
    v_mfma_f32_16x16x32_bf16 v[180:183], a[92:95], a[140:143], v[180:183]
    v_mul_f32 v134, v134, v150
    v_mul_f32 v135, v135, v151
    v_mfma_f32_16x16x32_bf16 v[176:179], a[88:91], a[120:123], v[176:179]
    v_cvt_pk_bf16_f32 v152, v136, v137
    v_cvt_pk_bf16_f32 v153, v138, v139
    v_mfma_f32_16x16x32_bf16 v[176:179], a[92:95], a[136:139], v[176:179]
    v_cvt_pk_bf16_f32 v154, v140, v141
    v_cvt_pk_bf16_f32 v155, v142, v143
    s_waitcnt lgkmcnt(12)
    v_mfma_f32_16x16x32_bf16 v[160:163], a[96:99], a[56:59], v[160:163]
    v_cvt_pk_bf16_f32 v144, v128, v129
    v_cvt_pk_bf16_f32 v145, v130, v131
    v_mfma_f32_16x16x32_bf16 v[160:163], a[100:103], a[72:75], v[160:163]
    v_cvt_pk_bf16_f32 v146, v132, v133
    v_cvt_pk_bf16_f32 v147, v134, v135
    v_mfma_f32_16x16x32_bf16 v[164:167], a[96:99], a[60:63], v[164:167]
    v_permlane16_swap_b32 v152, v154
    v_permlane16_swap_b32 v153, v155
    v_mfma_f32_16x16x32_bf16 v[164:167], a[100:103], a[76:79], v[164:167]
    v_permlane16_swap_b32 v144, v146
    v_permlane16_swap_b32 v145, v147
    v_mfma_f32_16x16x32_bf16 v[168:171], a[96:99], a[64:67], v[168:171]
    buffer_store_dwordx4 v[144:147], v19, s[4:7], s88 offen offset:0 sc1
    v_mfma_f32_16x16x32_bf16 v[168:171], a[100:103], a[80:83], v[168:171]
    buffer_store_dwordx4 v[152:155], v19, s[4:7], s89 offen offset:0 sc1
    v_mfma_f32_16x16x32_bf16 v[172:175], a[96:99], a[68:71], v[172:175]
    v_mfma_f32_16x16x32_bf16 v[172:175], a[100:103], a[84:87], v[172:175]
    s_waitcnt lgkmcnt(12)
    v_mfma_f32_16x16x32_bf16 v[188:191], a[104:107], a[68:71], v[188:191]
    v_mfma_f32_16x16x32_bf16 v[188:191], a[108:111], a[84:87], v[188:191]
    v_mfma_f32_16x16x32_bf16 v[184:187], a[104:107], a[64:67], v[184:187]
    v_mfma_f32_16x16x32_bf16 v[184:187], a[108:111], a[80:83], v[184:187]
    v_mfma_f32_16x16x32_bf16 v[180:183], a[104:107], a[60:63], v[180:183]
    v_mfma_f32_16x16x32_bf16 v[180:183], a[108:111], a[76:79], v[180:183]
    v_mfma_f32_16x16x32_bf16 v[176:179], a[104:107], a[56:59], v[176:179]
    v_mfma_f32_16x16x32_bf16 v[176:179], a[108:111], a[72:75], v[176:179]
    s_waitcnt lgkmcnt(12)
    v_mfma_f32_16x16x32_bf16 v[192:195], a[112:115], a[120:123], v[192:195]
    s_waitcnt vmcnt(2) lgkmcnt(0)
    s_barrier
    buffer_atomic_add v26, v13, s[28:31], s92 offen offset:0 sc1
    v_mfma_f32_16x16x32_bf16 v[192:195], a[116:119], a[136:139], v[192:195]
    s_add_u32 m0, s53, 0x0
    s_add_u32 s52, s36, 2752512
    v_mfma_f32_16x16x32_bf16 v[196:199], a[112:115], a[124:127], v[196:199]
    s_add_u32 s38, s36, 2979840
    v_mfma_f32_16x16x32_bf16 v[196:199], a[116:119], a[140:143], v[196:199]
    v_mfma_f32_16x16x32_bf16 v[200:203], a[112:115], a[128:131], v[200:203]
    v_mfma_f32_16x16x32_bf16 v[200:203], a[116:119], a[144:147], v[200:203]
    buffer_load_dwordx4 v11, s[20:23], s52 offen offset:0 lds
    v_mfma_f32_16x16x32_bf16 v[204:207], a[112:115], a[132:135], v[204:207]
    v_mfma_f32_16x16x32_bf16 v[204:207], a[116:119], a[148:151], v[204:207]
    v_mul_f32 v168, v168, v184
    v_mul_f32 v169, v169, v185
    v_mfma_f32_16x16x32_bf16 v[220:223], a[48:51], a[132:135], v[220:223]
    v_mul_f32 v170, v170, v186
    v_mul_f32 v171, v171, v187
    v_mfma_f32_16x16x32_bf16 v[220:223], a[52:55], a[148:151], v[220:223]
    buffer_load_dwordx4 v12, s[20:23], s52 offen offset:1024 lds
    v_mfma_f32_16x16x32_bf16 v[216:219], a[48:51], a[128:131], v[216:219]
    v_mul_f32 v172, v172, v188
    v_mul_f32 v173, v173, v189
    v_mfma_f32_16x16x32_bf16 v[216:219], a[52:55], a[144:147], v[216:219]
    v_mul_f32 v174, v174, v190
    v_mul_f32 v175, v175, v191
    v_mfma_f32_16x16x32_bf16 v[212:215], a[48:51], a[124:127], v[212:215]
    v_mul_f32 v160, v160, v176
    v_mul_f32 v161, v161, v177
    v_mfma_f32_16x16x32_bf16 v[212:215], a[52:55], a[140:143], v[212:215]
    buffer_load_dwordx4 v11, s[20:23], s38 offen offset:2048 lds
    v_mfma_f32_16x16x32_bf16 v[208:211], a[48:51], a[120:123], v[208:211]
    v_mul_f32 v162, v162, v178
    v_mul_f32 v163, v163, v179
    v_mfma_f32_16x16x32_bf16 v[208:211], a[52:55], a[136:139], v[208:211]
    v_mul_f32 v164, v164, v180
    v_mul_f32 v165, v165, v181
    v_mfma_f32_16x16x32_bf16 v[192:195], a[0:3], a[56:59], v[192:195]
    v_mul_f32 v166, v166, v182
    v_mul_f32 v167, v167, v183
    v_mfma_f32_16x16x32_bf16 v[192:195], a[4:7], a[72:75], v[192:195]
    buffer_load_dwordx4 v12, s[20:23], s38 offen offset:3072 lds
    v_mfma_f32_16x16x32_bf16 v[196:199], a[0:3], a[60:63], v[196:199]
    s_add_u32 m0, s53, 0x4000
    s_add_u32 s52, s36, 3211264
    v_mfma_f32_16x16x32_bf16 v[196:199], a[4:7], a[76:79], v[196:199]
    s_add_u32 s38, s36, 3438592
    v_cvt_pk_bf16_f32 v184, v168, v169
    v_mfma_f32_16x16x32_bf16 v[200:203], a[0:3], a[64:67], v[200:203]
    v_cvt_pk_bf16_f32 v185, v170, v171
    v_cvt_pk_bf16_f32 v186, v172, v173
    v_mfma_f32_16x16x32_bf16 v[200:203], a[4:7], a[80:83], v[200:203]
    buffer_load_dwordx4 v11, s[20:23], s52 offen offset:0 lds
    v_mfma_f32_16x16x32_bf16 v[204:207], a[0:3], a[68:71], v[204:207]
    v_cvt_pk_bf16_f32 v187, v174, v175
    v_cvt_pk_bf16_f32 v176, v160, v161
    v_mfma_f32_16x16x32_bf16 v[204:207], a[4:7], a[84:87], v[204:207]
    v_cvt_pk_bf16_f32 v177, v162, v163
    v_cvt_pk_bf16_f32 v178, v164, v165
    v_mfma_f32_16x16x32_bf16 v[220:223], a[8:11], a[68:71], v[220:223]
    v_cvt_pk_bf16_f32 v179, v166, v167
    v_permlane16_swap_b32 v184, v186
    v_mfma_f32_16x16x32_bf16 v[220:223], a[12:15], a[84:87], v[220:223]
    buffer_load_dwordx4 v12, s[20:23], s52 offen offset:1024 lds
    v_mfma_f32_16x16x32_bf16 v[216:219], a[8:11], a[64:67], v[216:219]
    v_permlane16_swap_b32 v185, v187
    v_permlane16_swap_b32 v176, v178
    v_mfma_f32_16x16x32_bf16 v[216:219], a[12:15], a[80:83], v[216:219]
    v_permlane16_swap_b32 v177, v179
    buffer_store_dwordx4 v[176:179], v19, s[4:7], s88 offen offset:1024 sc1
    v_mfma_f32_16x16x32_bf16 v[212:215], a[8:11], a[60:63], v[212:215]
    buffer_store_dwordx4 v[184:187], v19, s[4:7], s89 offen offset:1024 sc1
    v_mfma_f32_16x16x32_bf16 v[212:215], a[12:15], a[76:79], v[212:215]
    buffer_load_dwordx4 v11, s[20:23], s38 offen offset:2048 lds
    v_mfma_f32_16x16x32_bf16 v[208:211], a[8:11], a[56:59], v[208:211]
    v_mfma_f32_16x16x32_bf16 v[208:211], a[12:15], a[72:75], v[208:211]
    v_mfma_f32_16x16x32_bf16 v[224:227], a[16:19], a[120:123], v[224:227]
    v_mov_b32_e64 v17, 0
    buffer_atomic_add v17, v14, s[28:31], s93 offen offset:0 sc0 sc1
    v_mfma_f32_16x16x32_bf16 v[224:227], a[20:23], a[136:139], v[224:227]
    buffer_load_dwordx4 v12, s[20:23], s38 offen offset:3072 lds
    v_mfma_f32_16x16x32_bf16 v[228:231], a[16:19], a[124:127], v[228:231]
    s_add_u32 m0, s53, 0x20000
    s_add_u32 s52, s37, 65536
    v_mfma_f32_16x16x32_bf16 v[228:231], a[20:23], a[140:143], v[228:231]
    s_add_u32 s38, s37, 522240
    v_mfma_f32_16x16x32_bf16 v[232:235], a[16:19], a[128:131], v[232:235]
    v_mfma_f32_16x16x32_bf16 v[232:235], a[20:23], a[144:147], v[232:235]
    buffer_load_dwordx4 v11, s[20:23], s52 offen offset:0 lds
    v_mfma_f32_16x16x32_bf16 v[236:239], a[16:19], a[132:135], v[236:239]
    v_mfma_f32_16x16x32_bf16 v[236:239], a[20:23], a[148:151], v[236:239]
    v_mfma_f32_16x16x32_bf16 v[252:255], a[24:27], a[132:135], v[252:255]
    v_mul_f32 v200, v200, v216
    v_mul_f32 v201, v201, v217
    v_mfma_f32_16x16x32_bf16 v[252:255], a[28:31], a[148:151], v[252:255]
    buffer_load_dwordx4 v12, s[20:23], s52 offen offset:1024 lds
    v_mfma_f32_16x16x32_bf16 v[248:251], a[24:27], a[128:131], v[248:251]
    v_mul_f32 v202, v202, v218
    v_mul_f32 v203, v203, v219
    v_mfma_f32_16x16x32_bf16 v[248:251], a[28:31], a[144:147], v[248:251]
    v_mul_f32 v204, v204, v220
    v_mul_f32 v205, v205, v221
    v_mfma_f32_16x16x32_bf16 v[244:247], a[24:27], a[124:127], v[244:247]
    v_mul_f32 v206, v206, v222
    v_mul_f32 v207, v207, v223
    v_mfma_f32_16x16x32_bf16 v[244:247], a[28:31], a[140:143], v[244:247]
    buffer_load_dwordx4 v11, s[20:23], s38 offen offset:2048 lds
    v_mfma_f32_16x16x32_bf16 v[240:243], a[24:27], a[120:123], v[240:243]
    v_mul_f32 v192, v192, v208
    v_mul_f32 v193, v193, v209
    v_mfma_f32_16x16x32_bf16 v[240:243], a[28:31], a[136:139], v[240:243]
    v_mul_f32 v194, v194, v210
    v_mul_f32 v195, v195, v211
    v_mfma_f32_16x16x32_bf16 v[224:227], a[32:35], a[56:59], v[224:227]
    v_mul_f32 v196, v196, v212
    v_mul_f32 v197, v197, v213
    v_mfma_f32_16x16x32_bf16 v[224:227], a[36:39], a[72:75], v[224:227]
    buffer_load_dwordx4 v12, s[20:23], s38 offen offset:3072 lds
    v_mfma_f32_16x16x32_bf16 v[228:231], a[32:35], a[60:63], v[228:231]
    s_add_u32 m0, s53, 0x24000
    s_add_u32 s52, s37, 983040
    v_mfma_f32_16x16x32_bf16 v[228:231], a[36:39], a[76:79], v[228:231]
    s_add_u32 s38, s37, 1439744
    v_mul_f32 v198, v198, v214
    v_mfma_f32_16x16x32_bf16 v[232:235], a[32:35], a[64:67], v[232:235]
    v_mul_f32 v199, v199, v215
    v_cvt_pk_bf16_f32 v216, v200, v201
    v_mfma_f32_16x16x32_bf16 v[232:235], a[36:39], a[80:83], v[232:235]
    buffer_load_dwordx4 v11, s[20:23], s52 offen offset:0 lds
    v_mfma_f32_16x16x32_bf16 v[236:239], a[32:35], a[68:71], v[236:239]
    v_cvt_pk_bf16_f32 v217, v202, v203
    v_cvt_pk_bf16_f32 v218, v204, v205
    v_mfma_f32_16x16x32_bf16 v[236:239], a[36:39], a[84:87], v[236:239]
    v_cvt_pk_bf16_f32 v219, v206, v207
    v_cvt_pk_bf16_f32 v208, v192, v193
    v_mfma_f32_16x16x32_bf16 v[252:255], a[40:43], a[68:71], v[252:255]
    v_cvt_pk_bf16_f32 v209, v194, v195
    v_cvt_pk_bf16_f32 v210, v196, v197
    v_mfma_f32_16x16x32_bf16 v[252:255], a[44:47], a[84:87], v[252:255]
    buffer_load_dwordx4 v12, s[20:23], s52 offen offset:1024 lds
    v_mfma_f32_16x16x32_bf16 v[248:251], a[40:43], a[64:67], v[248:251]
    v_cvt_pk_bf16_f32 v211, v198, v199
    v_permlane16_swap_b32 v216, v218
    v_mfma_f32_16x16x32_bf16 v[248:251], a[44:47], a[80:83], v[248:251]
    v_permlane16_swap_b32 v217, v219
    v_permlane16_swap_b32 v208, v210
    v_mfma_f32_16x16x32_bf16 v[244:247], a[40:43], a[60:63], v[244:247]
    v_permlane16_swap_b32 v209, v211
    buffer_store_dwordx4 v[208:211], v19, s[4:7], s88 offen offset:2048 sc1
    v_mfma_f32_16x16x32_bf16 v[244:247], a[44:47], a[76:79], v[244:247]
    buffer_load_dwordx4 v11, s[20:23], s38 offen offset:2048 lds
    v_mfma_f32_16x16x32_bf16 v[240:243], a[40:43], a[56:59], v[240:243]
    buffer_store_dwordx4 v[216:219], v19, s[4:7], s89 offen offset:2048 sc1
    v_mfma_f32_16x16x32_bf16 v[240:243], a[44:47], a[72:75], v[240:243]
    ds_read_b64_tr_b16 v[160:161], v7 offset:0
    ds_read_b64_tr_b16 v[162:163], v7 offset:8192
    buffer_load_dwordx4 v12, s[20:23], s38 offen offset:3072 lds
    ds_read_b64_tr_b16 v[164:165], v7 offset:2048
    ds_read_b64_tr_b16 v[166:167], v7 offset:10240
    ds_read_b64_tr_b16 v[168:169], v8 offset:0
    ds_read_b64_tr_b16 v[170:171], v8 offset:8192
    ds_read_b64_tr_b16 v[172:173], v8 offset:2048
    ds_read_b64_tr_b16 v[174:175], v8 offset:10240
    ds_read_b64_tr_b16 v[176:177], v9 offset:0
    ds_read_b64_tr_b16 v[178:179], v9 offset:8192
    ds_read_b64_tr_b16 v[180:181], v9 offset:2048
    ds_read_b64_tr_b16 v[182:183], v9 offset:10240
    ds_read_b64_tr_b16 v[184:185], v10 offset:0
    ds_read_b64_tr_b16 v[186:187], v10 offset:8192
    ds_read_b64_tr_b16 v[188:189], v10 offset:2048
    ds_read_b64_tr_b16 v[190:191], v10 offset:10240
    v_pk_mul_f32 v[232:233], v[232:233], v[248:249]
    v_pk_mul_f32 v[234:235], v[234:235], v[250:251]
    v_pk_mul_f32 v[236:237], v[236:237], v[252:253]
    v_pk_mul_f32 v[238:239], v[238:239], v[254:255]
    v_pk_mul_f32 v[224:225], v[224:225], v[240:241]
    v_pk_mul_f32 v[226:227], v[226:227], v[242:243]
    v_pk_mul_f32 v[228:229], v[228:229], v[244:245]
    v_pk_mul_f32 v[230:231], v[230:231], v[246:247]
    v_cvt_pk_bf16_f32 v248, v232, v233
    v_cvt_pk_bf16_f32 v249, v234, v235
    v_cvt_pk_bf16_f32 v250, v236, v237
    v_cvt_pk_bf16_f32 v251, v238, v239
    v_cvt_pk_bf16_f32 v240, v224, v225
    v_cvt_pk_bf16_f32 v241, v226, v227
    v_cvt_pk_bf16_f32 v242, v228, v229
    v_cvt_pk_bf16_f32 v243, v230, v231
    v_permlane16_swap_b32 v248, v250
    v_permlane16_swap_b32 v249, v251
    v_permlane16_swap_b32 v240, v242
    v_permlane16_swap_b32 v241, v243
    s_waitcnt vmcnt(11)
    v_readfirstlane_b32 s57, v17
    s_cmp_lt_u32 s57, s82
    s_cbranch_scc1 L_interlea_hc39b
L_interlea_hc39:
    s_barrier
    s_nop 0
    buffer_load_dwordx4 a[0:3], v15, s[4:7], s51 offen offset:0
    buffer_load_dwordx4 a[4:7], v15, s[4:7], s51 offen offset:256
    buffer_load_dwordx4 a[16:19], v15, s[4:7], s51 offen offset:2048
    buffer_load_dwordx4 a[20:23], v15, s[4:7], s51 offen offset:2304
    s_add_u32 s51, s51, 8192
    buffer_load_dwordx4 a[8:11], v15, s[4:7], s91 offen offset:0
    buffer_load_dwordx4 a[12:15], v15, s[4:7], s91 offen offset:256
    buffer_load_dwordx4 a[24:27], v15, s[4:7], s91 offen offset:2048
    buffer_load_dwordx4 a[28:31], v15, s[4:7], s91 offen offset:2304
    s_add_u32 s91, s91, 8192
    buffer_store_dwordx4 v[248:251], v19, s[4:7], s89 offen offset:3072 sc1
    buffer_store_dwordx4 v[240:243], v19, s[4:7], s88 offen offset:3072 sc1
    ds_read_b64_tr_b16 v[192:193], v7 offset:1024
    ds_read_b64_tr_b16 v[194:195], v7 offset:9216
    ds_read_b64_tr_b16 v[196:197], v7 offset:3072
    ds_read_b64_tr_b16 v[198:199], v7 offset:11264
    ds_read_b64_tr_b16 v[200:201], v8 offset:1024
    ds_read_b64_tr_b16 v[202:203], v8 offset:9216
    ds_read_b64_tr_b16 v[204:205], v8 offset:3072
    ds_read_b64_tr_b16 v[206:207], v8 offset:11264
    v_subrev_u32 v232, 0x10000, v7
    v_add_u32 v244, 0x10000, v7
    v_subrev_u32 v233, 0x10000, v8
    v_add_u32 v245, 0x10000, v8
    v_subrev_u32 v234, 0x10000, v9
    v_add_u32 v246, 0x10000, v9
    v_subrev_u32 v235, 0x10000, v10
    v_add_u32 v247, 0x10000, v10
    v_lshrrev_b32 v230, 2, v1
    v_and_b32 v231, 1, v0
    v_lshlrev_b32 v231, 4, v231
    v_lshlrev_b32 v231, v231, v26
    v_mul_u32_u24 v231, 0x3f80, v231
    v_cmp_eq_u32 vcc, v230, v2
    s_nop 1
    v_cndmask_b32 v231, 0, v231, vcc
    v_and_b32 v230, 2, v0
    v_cmp_eq_u32 vcc, 0, v230
    s_nop 1
    v_cndmask_b32 v226, 0, v231, vcc
    v_cndmask_b32 v227, v231, 0, vcc
    v_mov_b64 v[224:225], 0
    v_mov_b64 v[228:229], 0
    s_lshl_b32 s56, s41, 13
    s_add_u32 s57, s56, 0x10000
    v_add_u32 v230, s57, v19
    s_xor_b32 s56, s56, 0x4000
    s_add_u32 s57, s56, 0x10000
    v_add_u32 v231, s57, v19
    v_lshlrev_b32 v236, 6, v1
    v_lshl_add_u32 v236, v2, 4, v236
    s_waitcnt vmcnt(9) lgkmcnt(8)
    v_mfma_f32_16x16x32_bf16 v[32:35], v[160:163], a[0:3], 0
    ds_read_b64_tr_b16 v[208:209], v9 offset:1024
    v_mfma_f32_16x16x32_bf16 v[48:51], v[168:171], a[0:3], 0
    buffer_load_dwordx4 a[32:35], v15, s[4:7], s51 offen offset:0
    v_mfma_f32_16x16x32_bf16 v[64:67], v[176:179], a[0:3], 0
    ds_read_b64_tr_b16 v[210:211], v9 offset:9216
    v_mfma_f32_16x16x32_bf16 v[80:83], v[184:187], a[0:3], 0
    ds_read_b64_tr_b16 v[212:213], v9 offset:3072
    s_waitcnt vmcnt(9)
    v_mfma_f32_16x16x32_bf16 v[36:39], v[160:163], a[4:7], 0
    ds_read_b64_tr_b16 v[214:215], v9 offset:11264
    v_mfma_f32_16x16x32_bf16 v[52:55], v[168:171], a[4:7], 0
    buffer_load_dwordx4 a[36:39], v15, s[4:7], s51 offen offset:256
    v_mfma_f32_16x16x32_bf16 v[68:71], v[176:179], a[4:7], 0
    v_mfma_f32_16x16x32_bf16 v[84:87], v[184:187], a[4:7], 0
    s_waitcnt vmcnt(9)
    v_mfma_f32_16x16x32_bf16 v[32:35], v[164:167], a[16:19], v[32:35]
    ds_read_b64_tr_b16 v[216:217], v10 offset:1024
    v_mfma_f32_16x16x32_bf16 v[48:51], v[172:175], a[16:19], v[48:51]
    buffer_load_dwordx4 a[48:51], v15, s[4:7], s51 offen offset:2048
    v_mfma_f32_16x16x32_bf16 v[64:67], v[180:183], a[16:19], v[64:67]
    ds_read_b64_tr_b16 v[218:219], v10 offset:9216
    v_mfma_f32_16x16x32_bf16 v[80:83], v[188:191], a[16:19], v[80:83]
    ds_read_b64_tr_b16 v[220:221], v10 offset:3072
    s_waitcnt vmcnt(9)
    v_mfma_f32_16x16x32_bf16 v[36:39], v[164:167], a[20:23], v[36:39]
    ds_read_b64_tr_b16 v[222:223], v10 offset:11264
    v_mfma_f32_16x16x32_bf16 v[52:55], v[172:175], a[20:23], v[52:55]
    buffer_load_dwordx4 a[52:55], v15, s[4:7], s51 offen offset:2304
    v_mfma_f32_16x16x32_bf16 v[68:71], v[180:183], a[20:23], v[68:71]
    s_add_u32 s51, s51, 8192
    v_mfma_f32_16x16x32_bf16 v[84:87], v[188:191], a[20:23], v[84:87]
    s_waitcnt vmcnt(9)
    v_mfma_f32_16x16x32_bf16 v[40:43], v[160:163], a[8:11], 0
    v_mfma_f32_16x16x32_bf16 v[56:59], v[168:171], a[8:11], 0
    buffer_load_dwordx4 a[40:43], v15, s[4:7], s91 offen offset:0
    v_mfma_f32_16x16x32_bf16 v[72:75], v[176:179], a[8:11], 0
    v_mfma_f32_16x16x32_bf16 v[88:91], v[184:187], a[8:11], 0
    s_waitcnt vmcnt(9)
    v_mfma_f32_16x16x32_bf16 v[44:47], v[160:163], a[12:15], 0
    v_mfma_f32_16x16x32_bf16 v[60:63], v[168:171], a[12:15], 0
    buffer_load_dwordx4 a[44:47], v15, s[4:7], s91 offen offset:256
    v_mfma_f32_16x16x32_bf16 v[76:79], v[176:179], a[12:15], 0
    v_mfma_f32_16x16x32_bf16 v[92:95], v[184:187], a[12:15], 0
    s_waitcnt vmcnt(9)
    v_mfma_f32_16x16x32_bf16 v[40:43], v[164:167], a[24:27], v[40:43]
    v_mfma_f32_16x16x32_bf16 v[56:59], v[172:175], a[24:27], v[56:59]
    buffer_load_dwordx4 a[56:59], v15, s[4:7], s91 offen offset:2048
    v_mfma_f32_16x16x32_bf16 v[72:75], v[180:183], a[24:27], v[72:75]
    v_mfma_f32_16x16x32_bf16 v[88:91], v[188:191], a[24:27], v[88:91]
    s_waitcnt vmcnt(9)
    v_mfma_f32_16x16x32_bf16 v[44:47], v[164:167], a[28:31], v[44:47]
    v_mfma_f32_16x16x32_bf16 v[60:63], v[172:175], a[28:31], v[60:63]
    buffer_load_dwordx4 a[60:63], v15, s[4:7], s91 offen offset:2304
    v_mfma_f32_16x16x32_bf16 v[76:79], v[180:183], a[28:31], v[76:79]
    s_add_u32 s91, s91, 8192
    v_mfma_f32_16x16x32_bf16 v[92:95], v[188:191], a[28:31], v[92:95]
    s_waitcnt vmcnt(63) lgkmcnt(0)
    s_barrier
    v_mfma_f32_16x16x32_bf16 v[96:99], v[192:195], a[0:3], 0
    ds_read_b64_tr_b16 v[160:161], v7 offset:32768
    v_mfma_f32_16x16x32_bf16 v[96:99], v[196:199], a[16:19], v[96:99]
    buffer_load_dwordx4 a[64:67], v15, s[4:7], s51 offen offset:0
    v_mfma_f32_16x16x32_bf16 v[100:103], v[192:195], a[4:7], 0
    ds_read_b64_tr_b16 v[162:163], v7 offset:40960
    v_mfma_f32_16x16x32_bf16 v[100:103], v[196:199], a[20:23], v[100:103]
    ds_read_b64_tr_b16 v[164:165], v7 offset:34816
    v_mfma_f32_16x16x32_bf16 v[104:107], v[192:195], a[8:11], 0
    ds_read_b64_tr_b16 v[166:167], v7 offset:43008
    v_mfma_f32_16x16x32_bf16 v[104:107], v[196:199], a[24:27], v[104:107]
    buffer_load_dwordx4 a[68:71], v15, s[4:7], s51 offen offset:256
    v_mfma_f32_16x16x32_bf16 v[108:111], v[192:195], a[12:15], 0
    ds_read_b64_tr_b16 v[168:169], v8 offset:32768
    v_mfma_f32_16x16x32_bf16 v[108:111], v[196:199], a[28:31], v[108:111]
    ds_read_b64_tr_b16 v[170:171], v8 offset:40960
    ds_read_b64_tr_b16 v[172:173], v8 offset:34816
    ds_read_b64_tr_b16 v[174:175], v8 offset:43008
    v_mfma_f32_16x16x32_bf16 v[112:115], v[200:203], a[0:3], 0
    ds_read_b64_tr_b16 v[176:177], v9 offset:32768
    v_mfma_f32_16x16x32_bf16 v[112:115], v[204:207], a[16:19], v[112:115]
    ds_read_b64_tr_b16 v[178:179], v9 offset:40960
    v_mfma_f32_16x16x32_bf16 v[116:119], v[200:203], a[4:7], 0
    ds_read_b64_tr_b16 v[180:181], v9 offset:34816
    v_mfma_f32_16x16x32_bf16 v[116:119], v[204:207], a[20:23], v[116:119]
    ds_read_b64_tr_b16 v[182:183], v9 offset:43008
    v_mfma_f32_16x16x32_bf16 v[120:123], v[200:203], a[8:11], 0
    ds_read_b64_tr_b16 v[184:185], v10 offset:32768
    v_mfma_f32_16x16x32_bf16 v[120:123], v[204:207], a[24:27], v[120:123]
    buffer_load_dwordx4 a[80:83], v15, s[4:7], s51 offen offset:2048
    v_mfma_f32_16x16x32_bf16 v[124:127], v[200:203], a[12:15], 0
    ds_read_b64_tr_b16 v[186:187], v10 offset:40960
    v_mfma_f32_16x16x32_bf16 v[124:127], v[204:207], a[28:31], v[124:127]
    ds_read_b64_tr_b16 v[188:189], v10 offset:34816
    ds_read_b64_tr_b16 v[190:191], v10 offset:43008
    v_mfma_f32_16x16x32_bf16 v[128:131], v[208:211], a[0:3], 0
    ds_read_b64_tr_b16 v[192:193], v7 offset:33792
    v_mfma_f32_16x16x32_bf16 v[128:131], v[212:215], a[16:19], v[128:131]
    buffer_load_dwordx4 a[84:87], v15, s[4:7], s51 offen offset:2304
    v_mfma_f32_16x16x32_bf16 v[132:135], v[208:211], a[4:7], 0
    s_add_u32 s51, s51, 8192
    v_mfma_f32_16x16x32_bf16 v[132:135], v[212:215], a[20:23], v[132:135]
    ds_read_b64_tr_b16 v[194:195], v7 offset:41984
    v_mfma_f32_16x16x32_bf16 v[136:139], v[208:211], a[8:11], 0
    ds_read_b64_tr_b16 v[196:197], v7 offset:35840
    v_mfma_f32_16x16x32_bf16 v[136:139], v[212:215], a[24:27], v[136:139]
    buffer_load_dwordx4 a[72:75], v15, s[4:7], s91 offen offset:0
    v_mfma_f32_16x16x32_bf16 v[140:143], v[208:211], a[12:15], 0
    ds_read_b64_tr_b16 v[198:199], v7 offset:44032
    v_mfma_f32_16x16x32_bf16 v[140:143], v[212:215], a[28:31], v[140:143]
    v_mfma_f32_16x16x32_bf16 v[156:159], v[216:219], a[12:15], 0
    ds_read_b64_tr_b16 v[200:201], v8 offset:33792
    v_mfma_f32_16x16x32_bf16 v[156:159], v[220:223], a[28:31], v[156:159]
    buffer_load_dwordx4 a[76:79], v15, s[4:7], s91 offen offset:256
    v_mfma_f32_16x16x32_bf16 v[152:155], v[216:219], a[8:11], 0
    ds_read_b64_tr_b16 v[202:203], v8 offset:41984
    v_mfma_f32_16x16x32_bf16 v[152:155], v[220:223], a[24:27], v[152:155]
    ds_read_b64_tr_b16 v[204:205], v8 offset:35840
    v_mfma_f32_16x16x32_bf16 v[148:151], v[216:219], a[4:7], 0
    ds_read_b64_tr_b16 v[206:207], v8 offset:44032
    v_mfma_f32_16x16x32_bf16 v[148:151], v[220:223], a[20:23], v[148:151]
    buffer_load_dwordx4 a[88:91], v15, s[4:7], s91 offen offset:2048
    v_mfma_f32_16x16x32_bf16 v[144:147], v[216:219], a[0:3], 0
    v_mfma_f32_16x16x32_bf16 v[144:147], v[220:223], a[16:19], v[144:147]
    s_waitcnt vmcnt(7) lgkmcnt(12)
    v_mfma_f32_16x16x32_bf16 v[32:35], v[160:163], a[32:35], v[32:35]
    ds_read_b64_tr_b16 v[208:209], v9 offset:33792
    v_mfma_f32_16x16x32_bf16 v[32:35], v[164:167], a[48:51], v[32:35]
    buffer_load_dwordx4 a[92:95], v15, s[4:7], s91 offen offset:2304
    v_mfma_f32_16x16x32_bf16 v[36:39], v[160:163], a[36:39], v[36:39]
    s_add_u32 s91, s91, 8192
    v_mfma_f32_16x16x32_bf16 v[36:39], v[164:167], a[52:55], v[36:39]
    ds_read_b64_tr_b16 v[210:211], v9 offset:41984
    v_mfma_f32_16x16x32_bf16 v[40:43], v[160:163], a[40:43], v[40:43]
    ds_read_b64_tr_b16 v[212:213], v9 offset:35840
    v_mfma_f32_16x16x32_bf16 v[40:43], v[164:167], a[56:59], v[40:43]
    buffer_load_dwordx4 a[96:99], v15, s[4:7], s51 offen offset:0
    v_mfma_f32_16x16x32_bf16 v[44:47], v[160:163], a[44:47], v[44:47]
    ds_read_b64_tr_b16 v[214:215], v9 offset:44032
    v_mfma_f32_16x16x32_bf16 v[44:47], v[164:167], a[60:63], v[44:47]
    v_mfma_f32_16x16x32_bf16 v[60:63], v[168:171], a[44:47], v[60:63]
    ds_read_b64_tr_b16 v[216:217], v10 offset:33792
    v_mfma_f32_16x16x32_bf16 v[60:63], v[172:175], a[60:63], v[60:63]
    buffer_load_dwordx4 a[100:103], v15, s[4:7], s51 offen offset:256
    v_mfma_f32_16x16x32_bf16 v[56:59], v[168:171], a[40:43], v[56:59]
    ds_read_b64_tr_b16 v[218:219], v10 offset:41984
    v_mfma_f32_16x16x32_bf16 v[56:59], v[172:175], a[56:59], v[56:59]
    ds_read_b64_tr_b16 v[220:221], v10 offset:35840
    v_mfma_f32_16x16x32_bf16 v[52:55], v[168:171], a[36:39], v[52:55]
    ds_read_b64_tr_b16 v[222:223], v10 offset:44032
    v_mfma_f32_16x16x32_bf16 v[52:55], v[172:175], a[52:55], v[52:55]
    buffer_load_dwordx4 a[112:115], v15, s[4:7], s51 offen offset:2048
    v_mfma_f32_16x16x32_bf16 v[48:51], v[168:171], a[32:35], v[48:51]
    v_mfma_f32_16x16x32_bf16 v[48:51], v[172:175], a[48:51], v[48:51]
    s_waitcnt vmcnt(19) lgkmcnt(0)
    s_barrier
    v_mfma_f32_16x16x32_bf16 v[64:67], v[176:179], a[32:35], v[64:67]
    buffer_atomic_add v26, v13, s[28:31], s92 offen offset:1024 sc1
    v_mfma_f32_16x16x32_bf16 v[64:67], v[180:183], a[48:51], v[64:67]
    buffer_load_dwordx4 a[116:119], v15, s[4:7], s51 offen offset:2304
    v_mfma_f32_16x16x32_bf16 v[68:71], v[176:179], a[36:39], v[68:71]
    s_add_u32 s51, s51, 8192
    v_mfma_f32_16x16x32_bf16 v[68:71], v[180:183], a[52:55], v[68:71]
    ds_read_b64_tr_b16 v[160:161], v232 offset:32768
    v_mfma_f32_16x16x32_bf16 v[72:75], v[176:179], a[40:43], v[72:75]
    ds_read_b64_tr_b16 v[162:163], v232 offset:40960
    v_mfma_f32_16x16x32_bf16 v[72:75], v[180:183], a[56:59], v[72:75]
    buffer_load_dwordx4 a[104:107], v15, s[4:7], s91 offen offset:0
    v_mfma_f32_16x16x32_bf16 v[76:79], v[176:179], a[44:47], v[76:79]
    ds_read_b64_tr_b16 v[164:165], v232 offset:34816
    v_mfma_f32_16x16x32_bf16 v[76:79], v[180:183], a[60:63], v[76:79]
    ds_read_b64_tr_b16 v[166:167], v232 offset:43008
    v_mfma_f32_16x16x32_bf16 v[92:95], v[184:187], a[44:47], v[92:95]
    ds_read_b64_tr_b16 v[168:169], v233 offset:32768
    v_mfma_f32_16x16x32_bf16 v[92:95], v[188:191], a[60:63], v[92:95]
    ds_read_b64_tr_b16 v[170:171], v233 offset:40960
    v_mfma_f32_16x16x32_bf16 v[88:91], v[184:187], a[40:43], v[88:91]
    ds_read_b64_tr_b16 v[172:173], v233 offset:34816
    v_mfma_f32_16x16x32_bf16 v[88:91], v[188:191], a[56:59], v[88:91]
    ds_read_b64_tr_b16 v[174:175], v233 offset:43008
    v_mfma_f32_16x16x32_bf16 v[84:87], v[184:187], a[36:39], v[84:87]
    v_mfma_f32_16x16x32_bf16 v[84:87], v[188:191], a[52:55], v[84:87]
    buffer_load_dwordx4 a[108:111], v15, s[4:7], s91 offen offset:256
    v_mfma_f32_16x16x32_bf16 v[80:83], v[184:187], a[32:35], v[80:83]
    v_mfma_f32_16x16x32_bf16 v[80:83], v[188:191], a[48:51], v[80:83]
    v_mfma_f32_16x16x32_bf16 v[96:99], v[192:195], a[32:35], v[96:99]
    ds_read_b64_tr_b16 v[176:177], v234 offset:32768
    v_mfma_f32_16x16x32_bf16 v[96:99], v[196:199], a[48:51], v[96:99]
    buffer_load_dwordx4 a[120:123], v15, s[4:7], s91 offen offset:2048
    v_mfma_f32_16x16x32_bf16 v[100:103], v[192:195], a[36:39], v[100:103]
    ds_read_b64_tr_b16 v[178:179], v234 offset:40960
    v_mfma_f32_16x16x32_bf16 v[100:103], v[196:199], a[52:55], v[100:103]
    ds_read_b64_tr_b16 v[180:181], v234 offset:34816
    v_mfma_f32_16x16x32_bf16 v[104:107], v[192:195], a[40:43], v[104:107]
    ds_read_b64_tr_b16 v[182:183], v234 offset:43008
    v_mfma_f32_16x16x32_bf16 v[104:107], v[196:199], a[56:59], v[104:107]
    buffer_load_dwordx4 a[124:127], v15, s[4:7], s91 offen offset:2304
    v_mfma_f32_16x16x32_bf16 v[108:111], v[192:195], a[44:47], v[108:111]
    s_add_u32 s91, s91, 8192
    v_mfma_f32_16x16x32_bf16 v[108:111], v[196:199], a[60:63], v[108:111]
    v_mfma_f32_16x16x32_bf16 v[124:127], v[200:203], a[44:47], v[124:127]
    ds_read_b64_tr_b16 v[184:185], v235 offset:32768
    v_mfma_f32_16x16x32_bf16 v[124:127], v[204:207], a[60:63], v[124:127]
    buffer_load_dwordx4 a[0:3], v15, s[4:7], s51 offen offset:0
    v_mfma_f32_16x16x32_bf16 v[120:123], v[200:203], a[40:43], v[120:123]
    ds_read_b64_tr_b16 v[186:187], v235 offset:40960
    v_mfma_f32_16x16x32_bf16 v[120:123], v[204:207], a[56:59], v[120:123]
    ds_read_b64_tr_b16 v[188:189], v235 offset:34816
    v_mfma_f32_16x16x32_bf16 v[116:119], v[200:203], a[36:39], v[116:119]
    ds_read_b64_tr_b16 v[190:191], v235 offset:43008
    v_mfma_f32_16x16x32_bf16 v[116:119], v[204:207], a[52:55], v[116:119]
    buffer_load_dwordx4 a[4:7], v15, s[4:7], s51 offen offset:256
    v_mfma_f32_16x16x32_bf16 v[112:115], v[200:203], a[32:35], v[112:115]
    v_mfma_f32_16x16x32_bf16 v[112:115], v[204:207], a[48:51], v[112:115]
    v_mfma_f32_16x16x32_bf16 v[128:131], v[208:211], a[32:35], v[128:131]
    ds_read_b64_tr_b16 v[192:193], v232 offset:33792
    v_mfma_f32_16x16x32_bf16 v[128:131], v[212:215], a[48:51], v[128:131]
    buffer_load_dwordx4 a[16:19], v15, s[4:7], s51 offen offset:2048
    v_mfma_f32_16x16x32_bf16 v[132:135], v[208:211], a[36:39], v[132:135]
    ds_read_b64_tr_b16 v[194:195], v232 offset:41984
    v_mfma_f32_16x16x32_bf16 v[132:135], v[212:215], a[52:55], v[132:135]
    ds_read_b64_tr_b16 v[196:197], v232 offset:35840
    v_mfma_f32_16x16x32_bf16 v[136:139], v[208:211], a[40:43], v[136:139]
    ds_read_b64_tr_b16 v[198:199], v232 offset:44032
    v_mfma_f32_16x16x32_bf16 v[136:139], v[212:215], a[56:59], v[136:139]
    buffer_load_dwordx4 a[20:23], v15, s[4:7], s51 offen offset:2304
    v_mfma_f32_16x16x32_bf16 v[140:143], v[208:211], a[44:47], v[140:143]
    s_add_u32 s51, s51, 8192
    v_mfma_f32_16x16x32_bf16 v[140:143], v[212:215], a[60:63], v[140:143]
    v_mfma_f32_16x16x32_bf16 v[156:159], v[216:219], a[44:47], v[156:159]
    ds_read_b64_tr_b16 v[200:201], v233 offset:33792
    v_mfma_f32_16x16x32_bf16 v[156:159], v[220:223], a[60:63], v[156:159]
    buffer_load_dwordx4 a[8:11], v15, s[4:7], s91 offen offset:0
    v_mfma_f32_16x16x32_bf16 v[152:155], v[216:219], a[40:43], v[152:155]
    ds_read_b64_tr_b16 v[202:203], v233 offset:41984
    v_mfma_f32_16x16x32_bf16 v[152:155], v[220:223], a[56:59], v[152:155]
    ds_read_b64_tr_b16 v[204:205], v233 offset:35840
    v_mfma_f32_16x16x32_bf16 v[148:151], v[216:219], a[36:39], v[148:151]
    ds_read_b64_tr_b16 v[206:207], v233 offset:44032
    v_mfma_f32_16x16x32_bf16 v[148:151], v[220:223], a[52:55], v[148:151]
    buffer_load_dwordx4 a[12:15], v15, s[4:7], s91 offen offset:256
    v_mfma_f32_16x16x32_bf16 v[144:147], v[216:219], a[32:35], v[144:147]
    v_mfma_f32_16x16x32_bf16 v[144:147], v[220:223], a[48:51], v[144:147]
    s_waitcnt vmcnt(15) lgkmcnt(12)
    v_mfma_f32_16x16x32_bf16 v[32:35], v[160:163], a[64:67], v[32:35]
    ds_read_b64_tr_b16 v[208:209], v234 offset:33792
    v_mfma_f32_16x16x32_bf16 v[32:35], v[164:167], a[80:83], v[32:35]
    buffer_load_dwordx4 a[24:27], v15, s[4:7], s91 offen offset:2048
    v_mfma_f32_16x16x32_bf16 v[36:39], v[160:163], a[68:71], v[36:39]
    ds_read_b64_tr_b16 v[210:211], v234 offset:41984
    v_mfma_f32_16x16x32_bf16 v[36:39], v[164:167], a[84:87], v[36:39]
    ds_read_b64_tr_b16 v[212:213], v234 offset:35840
    v_mfma_f32_16x16x32_bf16 v[40:43], v[160:163], a[72:75], v[40:43]
    ds_read_b64_tr_b16 v[214:215], v234 offset:44032
    v_mfma_f32_16x16x32_bf16 v[40:43], v[164:167], a[88:91], v[40:43]
    buffer_load_dwordx4 a[28:31], v15, s[4:7], s91 offen offset:2304
    v_mfma_f32_16x16x32_bf16 v[44:47], v[160:163], a[76:79], v[44:47]
    s_add_u32 s91, s91, 8192
    v_mfma_f32_16x16x32_bf16 v[44:47], v[164:167], a[92:95], v[44:47]
    v_mfma_f32_16x16x32_bf16 v[60:63], v[168:171], a[76:79], v[60:63]
    s_add_u32 m0, s53, 0x10000
    s_add_u32 s52, s37, 1900544
    v_mfma_f32_16x16x32_bf16 v[60:63], v[172:175], a[92:95], v[60:63]
    s_add_u32 s38, s37, 2357248
    v_mfma_f32_16x16x32_bf16 v[56:59], v[168:171], a[72:75], v[56:59]
    ds_read_b64_tr_b16 v[216:217], v235 offset:33792
    v_mfma_f32_16x16x32_bf16 v[56:59], v[172:175], a[88:91], v[56:59]
    ds_read_b64_tr_b16 v[218:219], v235 offset:41984
    v_mfma_f32_16x16x32_bf16 v[52:55], v[168:171], a[68:71], v[52:55]
    ds_read_b64_tr_b16 v[220:221], v235 offset:35840
    v_mfma_f32_16x16x32_bf16 v[52:55], v[172:175], a[84:87], v[52:55]
    buffer_load_dwordx4 v11, s[20:23], s52 offen offset:0 lds
    v_mfma_f32_16x16x32_bf16 v[48:51], v[168:171], a[64:67], v[48:51]
    ds_read_b64_tr_b16 v[222:223], v235 offset:44032
    v_mfma_f32_16x16x32_bf16 v[48:51], v[172:175], a[80:83], v[48:51]
    s_waitcnt vmcnt(54) lgkmcnt(0)
    s_barrier
    v_mfma_f32_16x16x32_bf16 v[64:67], v[176:179], a[64:67], v[64:67]
    ds_read_b64_tr_b16 v[160:161], v232 offset:0
    v_mfma_f32_16x16x32_bf16 v[64:67], v[180:183], a[80:83], v[64:67]
    buffer_load_dwordx4 v12, s[20:23], s52 offen offset:1024 lds
    v_mfma_f32_16x16x32_bf16 v[68:71], v[176:179], a[68:71], v[68:71]
    ds_read_b64_tr_b16 v[162:163], v232 offset:8192
    v_mfma_f32_16x16x32_bf16 v[68:71], v[180:183], a[84:87], v[68:71]
    ds_read_b64_tr_b16 v[164:165], v232 offset:2048
    v_mfma_f32_16x16x32_bf16 v[72:75], v[176:179], a[72:75], v[72:75]
    ds_read_b64_tr_b16 v[166:167], v232 offset:10240
    v_mfma_f32_16x16x32_bf16 v[72:75], v[180:183], a[88:91], v[72:75]
    buffer_load_dwordx4 v11, s[20:23], s38 offen offset:2048 lds
    v_mfma_f32_16x16x32_bf16 v[76:79], v[176:179], a[76:79], v[76:79]
    v_mfma_f32_16x16x32_bf16 v[76:79], v[180:183], a[92:95], v[76:79]
    v_mfma_f32_16x16x32_bf16 v[92:95], v[184:187], a[76:79], v[92:95]
    ds_read_b64_tr_b16 v[168:169], v233 offset:0
    v_mfma_f32_16x16x32_bf16 v[92:95], v[188:191], a[92:95], v[92:95]
    buffer_load_dwordx4 v12, s[20:23], s38 offen offset:3072 lds
    v_mfma_f32_16x16x32_bf16 v[88:91], v[184:187], a[72:75], v[88:91]
    s_add_u32 m0, s53, 0x14000
    s_add_u32 s52, s37, 2818048
    v_mfma_f32_16x16x32_bf16 v[88:91], v[188:191], a[88:91], v[88:91]
    s_add_u32 s38, s37, 3274752
    v_mfma_f32_16x16x32_bf16 v[84:87], v[184:187], a[68:71], v[84:87]
    ds_read_b64_tr_b16 v[170:171], v233 offset:8192
    v_mfma_f32_16x16x32_bf16 v[84:87], v[188:191], a[84:87], v[84:87]
    buffer_load_dwordx4 v11, s[20:23], s52 offen offset:0 lds
    v_mfma_f32_16x16x32_bf16 v[80:83], v[184:187], a[64:67], v[80:83]
    ds_read_b64_tr_b16 v[172:173], v233 offset:2048
    v_mfma_f32_16x16x32_bf16 v[80:83], v[188:191], a[80:83], v[80:83]
    ds_read_b64_tr_b16 v[174:175], v233 offset:10240
    v_mfma_f32_16x16x32_bf16 v[96:99], v[192:195], a[64:67], v[96:99]
    ds_read_b64_tr_b16 v[176:177], v234 offset:0
    v_mfma_f32_16x16x32_bf16 v[96:99], v[196:199], a[80:83], v[96:99]
    buffer_load_dwordx4 v12, s[20:23], s52 offen offset:1024 lds
    v_mfma_f32_16x16x32_bf16 v[100:103], v[192:195], a[68:71], v[100:103]
    ds_read_b64_tr_b16 v[178:179], v234 offset:8192
    v_mfma_f32_16x16x32_bf16 v[100:103], v[196:199], a[84:87], v[100:103]
    ds_read_b64_tr_b16 v[180:181], v234 offset:2048
    v_mfma_f32_16x16x32_bf16 v[104:107], v[192:195], a[72:75], v[104:107]
    ds_read_b64_tr_b16 v[182:183], v234 offset:10240
    v_mfma_f32_16x16x32_bf16 v[104:107], v[196:199], a[88:91], v[104:107]
    buffer_load_dwordx4 v11, s[20:23], s38 offen offset:2048 lds
    v_mfma_f32_16x16x32_bf16 v[108:111], v[192:195], a[76:79], v[108:111]
    v_mfma_f32_16x16x32_bf16 v[108:111], v[196:199], a[92:95], v[108:111]
    v_mfma_f32_16x16x32_bf16 v[124:127], v[200:203], a[76:79], v[124:127]
    ds_read_b64_tr_b16 v[184:185], v235 offset:0
    v_mfma_f32_16x16x32_bf16 v[124:127], v[204:207], a[92:95], v[124:127]
    buffer_load_dwordx4 v12, s[20:23], s38 offen offset:3072 lds
    v_mfma_f32_16x16x32_bf16 v[120:123], v[200:203], a[72:75], v[120:123]
    ds_read_b64_tr_b16 v[186:187], v235 offset:8192
    v_mfma_f32_16x16x32_bf16 v[120:123], v[204:207], a[88:91], v[120:123]
    ds_read_b64_tr_b16 v[188:189], v235 offset:2048
    v_mfma_f32_16x16x32_bf16 v[116:119], v[200:203], a[68:71], v[116:119]
    ds_read_b64_tr_b16 v[190:191], v235 offset:10240
    v_mfma_f32_16x16x32_bf16 v[116:119], v[204:207], a[84:87], v[116:119]
    buffer_load_dwordx4 a[32:35], v15, s[4:7], s51 offen offset:0
    v_mfma_f32_16x16x32_bf16 v[112:115], v[200:203], a[64:67], v[112:115]
    v_mfma_f32_16x16x32_bf16 v[112:115], v[204:207], a[80:83], v[112:115]
    v_mfma_f32_16x16x32_bf16 v[128:131], v[208:211], a[64:67], v[128:131]
    ds_read_b64_tr_b16 v[192:193], v232 offset:1024
    v_mfma_f32_16x16x32_bf16 v[128:131], v[212:215], a[80:83], v[128:131]
    buffer_load_dwordx4 a[36:39], v15, s[4:7], s51 offen offset:256
    v_mfma_f32_16x16x32_bf16 v[132:135], v[208:211], a[68:71], v[132:135]
    ds_read_b64_tr_b16 v[194:195], v232 offset:9216
    v_mfma_f32_16x16x32_bf16 v[132:135], v[212:215], a[84:87], v[132:135]
    ds_read_b64_tr_b16 v[196:197], v232 offset:3072
    v_mfma_f32_16x16x32_bf16 v[136:139], v[208:211], a[72:75], v[136:139]
    ds_read_b64_tr_b16 v[198:199], v232 offset:11264
    v_mfma_f32_16x16x32_bf16 v[136:139], v[212:215], a[88:91], v[136:139]
    buffer_load_dwordx4 a[48:51], v15, s[4:7], s51 offen offset:2048
    v_mfma_f32_16x16x32_bf16 v[140:143], v[208:211], a[76:79], v[140:143]
    v_mfma_f32_16x16x32_bf16 v[140:143], v[212:215], a[92:95], v[140:143]
    v_mfma_f32_16x16x32_bf16 v[156:159], v[216:219], a[76:79], v[156:159]
    ds_read_b64_tr_b16 v[200:201], v233 offset:1024
    v_mfma_f32_16x16x32_bf16 v[156:159], v[220:223], a[92:95], v[156:159]
    ds_read_b64_tr_b16 v[202:203], v233 offset:9216
    v_mfma_f32_16x16x32_bf16 v[152:155], v[216:219], a[72:75], v[152:155]
    ds_read_b64_tr_b16 v[204:205], v233 offset:3072
    v_mfma_f32_16x16x32_bf16 v[152:155], v[220:223], a[88:91], v[152:155]
    ds_read_b64_tr_b16 v[206:207], v233 offset:11264
    v_mfma_f32_16x16x32_bf16 v[148:151], v[216:219], a[68:71], v[148:151]
    v_mfma_f32_16x16x32_bf16 v[148:151], v[220:223], a[84:87], v[148:151]
    buffer_load_dwordx4 a[52:55], v15, s[4:7], s51 offen offset:2304
    v_mfma_f32_16x16x32_bf16 v[144:147], v[216:219], a[64:67], v[144:147]
    s_add_u32 s51, s51, 8192
    v_mfma_f32_16x16x32_bf16 v[144:147], v[220:223], a[80:83], v[144:147]
    s_waitcnt vmcnt(20) lgkmcnt(12)
    v_mfma_f32_16x16x32_bf16 v[32:35], v[160:163], a[96:99], v[32:35]
    v_mov_b32_e64 v17, 0
    buffer_atomic_add v17, v14, s[28:31], s93 offen offset:1024 sc0 sc1
    v_mfma_f32_16x16x32_bf16 v[32:35], v[164:167], a[112:115], v[32:35]
    buffer_load_dwordx4 a[40:43], v15, s[4:7], s91 offen offset:0
    v_mfma_f32_16x16x32_bf16 v[36:39], v[160:163], a[100:103], v[36:39]
    ds_read_b64_tr_b16 v[208:209], v234 offset:1024
    v_mfma_f32_16x16x32_bf16 v[36:39], v[164:167], a[116:119], v[36:39]
    ds_read_b64_tr_b16 v[210:211], v234 offset:9216
    v_mfma_f32_16x16x32_bf16 v[40:43], v[160:163], a[104:107], v[40:43]
    ds_read_b64_tr_b16 v[212:213], v234 offset:3072
    v_mfma_f32_16x16x32_bf16 v[40:43], v[164:167], a[120:123], v[40:43]
    buffer_load_dwordx4 a[44:47], v15, s[4:7], s91 offen offset:256
    v_mfma_f32_16x16x32_bf16 v[44:47], v[160:163], a[108:111], v[44:47]
    ds_read_b64_tr_b16 v[214:215], v234 offset:11264
    v_mfma_f32_16x16x32_bf16 v[44:47], v[164:167], a[124:127], v[44:47]
    v_mfma_f32_16x16x32_bf16 v[60:63], v[168:171], a[108:111], v[60:63]
    ds_read_b64_tr_b16 v[216:217], v235 offset:1024
    v_mfma_f32_16x16x32_bf16 v[60:63], v[172:175], a[124:127], v[60:63]
    buffer_load_dwordx4 a[56:59], v15, s[4:7], s91 offen offset:2048
    v_mfma_f32_16x16x32_bf16 v[56:59], v[168:171], a[104:107], v[56:59]
    ds_read_b64_tr_b16 v[218:219], v235 offset:9216
    v_mfma_f32_16x16x32_bf16 v[56:59], v[172:175], a[120:123], v[56:59]
    ds_read_b64_tr_b16 v[220:221], v235 offset:3072
    v_mfma_f32_16x16x32_bf16 v[52:55], v[168:171], a[100:103], v[52:55]
    ds_read_b64_tr_b16 v[222:223], v235 offset:11264
    v_mfma_f32_16x16x32_bf16 v[52:55], v[172:175], a[116:119], v[52:55]
    buffer_load_dwordx4 a[60:63], v15, s[4:7], s91 offen offset:2304
    v_mfma_f32_16x16x32_bf16 v[48:51], v[168:171], a[96:99], v[48:51]
    s_add_u32 s91, s91, 8192
    v_mfma_f32_16x16x32_bf16 v[48:51], v[172:175], a[112:115], v[48:51]
    s_waitcnt vmcnt(60) lgkmcnt(0)
    s_barrier
    v_mfma_f32_16x16x32_bf16 v[64:67], v[176:179], a[96:99], v[64:67]
    s_add_u32 m0, s53, 0x18000
    s_add_u32 s52, s36, 98304
    v_mfma_f32_16x16x32_bf16 v[64:67], v[180:183], a[112:115], v[64:67]
    s_add_u32 s38, s36, 161792
    v_mfma_f32_16x16x32_bf16 v[68:71], v[176:179], a[100:103], v[68:71]
    ds_read_b64_tr_b16 v[160:161], v244 offset:0
    v_mfma_f32_16x16x32_bf16 v[68:71], v[180:183], a[116:119], v[68:71]
    ds_read_b64_tr_b16 v[162:163], v244 offset:8192
    v_mfma_f32_16x16x32_bf16 v[72:75], v[176:179], a[104:107], v[72:75]
    ds_read_b64_tr_b16 v[164:165], v244 offset:2048
    v_mfma_f32_16x16x32_bf16 v[72:75], v[180:183], a[120:123], v[72:75]
    buffer_load_dwordx4 v11, s[20:23], s52 offen offset:0 lds
    v_mfma_f32_16x16x32_bf16 v[76:79], v[176:179], a[108:111], v[76:79]
    ds_read_b64_tr_b16 v[166:167], v244 offset:10240
    v_mfma_f32_16x16x32_bf16 v[76:79], v[180:183], a[124:127], v[76:79]
    v_mfma_f32_16x16x32_bf16 v[92:95], v[184:187], a[108:111], v[92:95]
    ds_read_b64_tr_b16 v[168:169], v245 offset:0
    v_mfma_f32_16x16x32_bf16 v[92:95], v[188:191], a[124:127], v[92:95]
    buffer_load_dwordx4 v12, s[20:23], s52 offen offset:1024 lds
    v_mfma_f32_16x16x32_bf16 v[88:91], v[184:187], a[104:107], v[88:91]
    ds_read_b64_tr_b16 v[170:171], v245 offset:8192
    v_mfma_f32_16x16x32_bf16 v[88:91], v[188:191], a[120:123], v[88:91]
    ds_read_b64_tr_b16 v[172:173], v245 offset:2048
    v_mfma_f32_16x16x32_bf16 v[84:87], v[184:187], a[100:103], v[84:87]
    ds_read_b64_tr_b16 v[174:175], v245 offset:10240
    v_mfma_f32_16x16x32_bf16 v[84:87], v[188:191], a[116:119], v[84:87]
    buffer_load_dwordx4 v11, s[20:23], s38 offen offset:2048 lds
    v_mfma_f32_16x16x32_bf16 v[80:83], v[184:187], a[96:99], v[80:83]
    v_mfma_f32_16x16x32_bf16 v[80:83], v[188:191], a[112:115], v[80:83]
    v_mfma_f32_16x16x32_bf16 v[96:99], v[192:195], a[96:99], v[96:99]
    ds_read_b64_tr_b16 v[176:177], v246 offset:0
    v_mfma_f32_16x16x32_bf16 v[96:99], v[196:199], a[112:115], v[96:99]
    buffer_load_dwordx4 v12, s[20:23], s38 offen offset:3072 lds
    v_mfma_f32_16x16x32_bf16 v[100:103], v[192:195], a[100:103], v[100:103]
    s_add_u32 m0, s53, 0x1c000
    s_add_u32 s52, s36, 327680
    v_mfma_f32_16x16x32_bf16 v[100:103], v[196:199], a[116:119], v[100:103]
    s_add_u32 s38, s36, 391168
    v_mfma_f32_16x16x32_bf16 v[104:107], v[192:195], a[104:107], v[104:107]
    ds_read_b64_tr_b16 v[178:179], v246 offset:8192
    v_mfma_f32_16x16x32_bf16 v[104:107], v[196:199], a[120:123], v[104:107]
    buffer_load_dwordx4 v11, s[20:23], s52 offen offset:0 lds
    v_mfma_f32_16x16x32_bf16 v[108:111], v[192:195], a[108:111], v[108:111]
    ds_read_b64_tr_b16 v[180:181], v246 offset:2048
    v_mfma_f32_16x16x32_bf16 v[108:111], v[196:199], a[124:127], v[108:111]
    ds_read_b64_tr_b16 v[182:183], v246 offset:10240
    v_mfma_f32_16x16x32_bf16 v[124:127], v[200:203], a[108:111], v[124:127]
    ds_read_b64_tr_b16 v[184:185], v247 offset:0
    v_mfma_f32_16x16x32_bf16 v[124:127], v[204:207], a[124:127], v[124:127]
    buffer_load_dwordx4 v12, s[20:23], s52 offen offset:1024 lds
    v_mfma_f32_16x16x32_bf16 v[120:123], v[200:203], a[104:107], v[120:123]
    ds_read_b64_tr_b16 v[186:187], v247 offset:8192
    v_mfma_f32_16x16x32_bf16 v[120:123], v[204:207], a[120:123], v[120:123]
    ds_read_b64_tr_b16 v[188:189], v247 offset:2048
    v_mfma_f32_16x16x32_bf16 v[116:119], v[200:203], a[100:103], v[116:119]
    ds_read_b64_tr_b16 v[190:191], v247 offset:10240
    v_mfma_f32_16x16x32_bf16 v[116:119], v[204:207], a[116:119], v[116:119]
    buffer_load_dwordx4 v11, s[20:23], s38 offen offset:2048 lds
    v_mfma_f32_16x16x32_bf16 v[112:115], v[200:203], a[96:99], v[112:115]
    v_mfma_f32_16x16x32_bf16 v[112:115], v[204:207], a[112:115], v[112:115]
    v_mfma_f32_16x16x32_bf16 v[128:131], v[208:211], a[96:99], v[128:131]
    ds_read_b64_tr_b16 v[192:193], v244 offset:1024
    v_mfma_f32_16x16x32_bf16 v[128:131], v[212:215], a[112:115], v[128:131]
    buffer_load_dwordx4 v12, s[20:23], s38 offen offset:3072 lds
    v_mfma_f32_16x16x32_bf16 v[132:135], v[208:211], a[100:103], v[132:135]
    s_add_u32 m0, s53, 0x8000
    s_add_u32 s52, s36, 557056
    v_mfma_f32_16x16x32_bf16 v[132:135], v[212:215], a[116:119], v[132:135]
    s_add_u32 s38, s36, 620544
    v_mfma_f32_16x16x32_bf16 v[136:139], v[208:211], a[104:107], v[136:139]
    ds_read_b64_tr_b16 v[194:195], v244 offset:9216
    v_mfma_f32_16x16x32_bf16 v[136:139], v[212:215], a[120:123], v[136:139]
    buffer_load_dwordx4 v11, s[20:23], s52 offen offset:0 lds
    v_mfma_f32_16x16x32_bf16 v[140:143], v[208:211], a[108:111], v[140:143]
    ds_read_b64_tr_b16 v[196:197], v244 offset:3072
    v_mfma_f32_16x16x32_bf16 v[140:143], v[212:215], a[124:127], v[140:143]
    ds_read_b64_tr_b16 v[198:199], v244 offset:11264
    v_mfma_f32_16x16x32_bf16 v[156:159], v[216:219], a[108:111], v[156:159]
    ds_read_b64_tr_b16 v[200:201], v245 offset:1024
    v_mfma_f32_16x16x32_bf16 v[156:159], v[220:223], a[124:127], v[156:159]
    buffer_load_dwordx4 v12, s[20:23], s52 offen offset:1024 lds
    v_mfma_f32_16x16x32_bf16 v[152:155], v[216:219], a[104:107], v[152:155]
    ds_read_b64_tr_b16 v[202:203], v245 offset:9216
    v_mfma_f32_16x16x32_bf16 v[152:155], v[220:223], a[120:123], v[152:155]
    ds_read_b64_tr_b16 v[204:205], v245 offset:3072
    v_mfma_f32_16x16x32_bf16 v[148:151], v[216:219], a[100:103], v[148:151]
    ds_read_b64_tr_b16 v[206:207], v245 offset:11264
    v_mfma_f32_16x16x32_bf16 v[148:151], v[220:223], a[116:119], v[148:151]
    buffer_load_dwordx4 v11, s[20:23], s38 offen offset:2048 lds
    v_mfma_f32_16x16x32_bf16 v[144:147], v[216:219], a[96:99], v[144:147]
    v_mfma_f32_16x16x32_bf16 v[144:147], v[220:223], a[112:115], v[144:147]
    s_waitcnt vmcnt(15) lgkmcnt(12)
    v_readfirstlane_b32 s57, v17
    s_cmp_lt_u32 s57, s82
    s_cbranch_scc1 L_interlea_hc40b
L_interlea_hc40:
    s_barrier
    v_mfma_f32_16x16x32_bf16 v[32:35], v[160:163], a[0:3], v[32:35]
    ds_read_b64_tr_b16 v[208:209], v246 offset:1024
    v_mfma_f32_16x16x32_bf16 v[32:35], v[164:167], a[16:19], v[32:35]
    buffer_load_dwordx4 v12, s[20:23], s38 offen offset:3072 lds
    v_mfma_f32_16x16x32_bf16 v[36:39], v[160:163], a[4:7], v[36:39]
    ds_read_b64_tr_b16 v[210:211], v246 offset:9216
    v_mfma_f32_16x16x32_bf16 v[36:39], v[164:167], a[20:23], v[36:39]
    ds_read_b64_tr_b16 v[212:213], v246 offset:3072
    v_mfma_f32_16x16x32_bf16 v[40:43], v[160:163], a[8:11], v[40:43]
    ds_read_b64_tr_b16 v[214:215], v246 offset:11264
    v_mfma_f32_16x16x32_bf16 v[40:43], v[164:167], a[24:27], v[40:43]
    buffer_load_dwordx4 a[64:67], v15, s[4:7], s51 offen offset:0
    v_mfma_f32_16x16x32_bf16 v[44:47], v[160:163], a[12:15], v[44:47]
    v_mfma_f32_16x16x32_bf16 v[44:47], v[164:167], a[28:31], v[44:47]
    v_mfma_f32_16x16x32_bf16 v[60:63], v[168:171], a[12:15], v[60:63]
    ds_read_b64_tr_b16 v[216:217], v247 offset:1024
    v_mfma_f32_16x16x32_bf16 v[60:63], v[172:175], a[28:31], v[60:63]
    ds_read_b64_tr_b16 v[218:219], v247 offset:9216
    v_mfma_f32_16x16x32_bf16 v[56:59], v[168:171], a[8:11], v[56:59]
    ds_read_b64_tr_b16 v[220:221], v247 offset:3072
    v_mfma_f32_16x16x32_bf16 v[56:59], v[172:175], a[24:27], v[56:59]
    ds_read_b64_tr_b16 v[222:223], v247 offset:11264
    v_mfma_f32_16x16x32_bf16 v[52:55], v[168:171], a[4:7], v[52:55]
    v_mfma_f32_16x16x32_bf16 v[52:55], v[172:175], a[20:23], v[52:55]
    buffer_load_dwordx4 a[68:71], v15, s[4:7], s51 offen offset:256
    v_mfma_f32_16x16x32_bf16 v[48:51], v[168:171], a[0:3], v[48:51]
    v_mfma_f32_16x16x32_bf16 v[48:51], v[172:175], a[16:19], v[48:51]
    s_waitcnt vmcnt(23) lgkmcnt(0)
    s_barrier
    v_mfma_f32_16x16x32_bf16 v[64:67], v[176:179], a[0:3], v[64:67]
    ds_read_b64_tr_b16 v[160:161], v7 offset:0
    v_mfma_f32_16x16x32_bf16 v[64:67], v[180:183], a[16:19], v[64:67]
    buffer_load_dwordx4 a[80:83], v15, s[4:7], s51 offen offset:2048
    v_mfma_f32_16x16x32_bf16 v[68:71], v[176:179], a[4:7], v[68:71]
    ds_read_b64_tr_b16 v[162:163], v7 offset:8192
    v_mfma_f32_16x16x32_bf16 v[68:71], v[180:183], a[20:23], v[68:71]
    ds_read_b64_tr_b16 v[164:165], v7 offset:2048
    v_mfma_f32_16x16x32_bf16 v[72:75], v[176:179], a[8:11], v[72:75]
    ds_read_b64_tr_b16 v[166:167], v7 offset:10240
    v_mfma_f32_16x16x32_bf16 v[72:75], v[180:183], a[24:27], v[72:75]
    buffer_load_dwordx4 a[84:87], v15, s[4:7], s51 offen offset:2304
    v_mfma_f32_16x16x32_bf16 v[76:79], v[176:179], a[12:15], v[76:79]
    s_add_u32 s51, s51, 8192
    v_mfma_f32_16x16x32_bf16 v[76:79], v[180:183], a[28:31], v[76:79]
    v_mfma_f32_16x16x32_bf16 v[92:95], v[184:187], a[12:15], v[92:95]
    ds_read_b64_tr_b16 v[168:169], v8 offset:0
    v_mfma_f32_16x16x32_bf16 v[92:95], v[188:191], a[28:31], v[92:95]
    buffer_load_dwordx4 a[72:75], v15, s[4:7], s91 offen offset:0
    v_mfma_f32_16x16x32_bf16 v[88:91], v[184:187], a[8:11], v[88:91]
    ds_read_b64_tr_b16 v[170:171], v8 offset:8192
    v_mfma_f32_16x16x32_bf16 v[88:91], v[188:191], a[24:27], v[88:91]
    ds_read_b64_tr_b16 v[172:173], v8 offset:2048
    v_mfma_f32_16x16x32_bf16 v[84:87], v[184:187], a[4:7], v[84:87]
    ds_read_b64_tr_b16 v[174:175], v8 offset:10240
    v_mfma_f32_16x16x32_bf16 v[84:87], v[188:191], a[20:23], v[84:87]
    buffer_load_dwordx4 a[76:79], v15, s[4:7], s91 offen offset:256
    v_mfma_f32_16x16x32_bf16 v[80:83], v[184:187], a[0:3], v[80:83]
    v_mfma_f32_16x16x32_bf16 v[80:83], v[188:191], a[16:19], v[80:83]
    v_mfma_f32_16x16x32_bf16 v[96:99], v[192:195], a[0:3], v[96:99]
    ds_read_b64_tr_b16 v[176:177], v9 offset:0
    v_mfma_f32_16x16x32_bf16 v[96:99], v[196:199], a[16:19], v[96:99]
    buffer_load_dwordx4 a[88:91], v15, s[4:7], s91 offen offset:2048
    v_mfma_f32_16x16x32_bf16 v[100:103], v[192:195], a[4:7], v[100:103]
    ds_read_b64_tr_b16 v[178:179], v9 offset:8192
    v_mfma_f32_16x16x32_bf16 v[100:103], v[196:199], a[20:23], v[100:103]
    ds_read_b64_tr_b16 v[180:181], v9 offset:2048
    v_mfma_f32_16x16x32_bf16 v[104:107], v[192:195], a[8:11], v[104:107]
    ds_read_b64_tr_b16 v[182:183], v9 offset:10240
    v_mfma_f32_16x16x32_bf16 v[104:107], v[196:199], a[24:27], v[104:107]
    buffer_load_dwordx4 a[92:95], v15, s[4:7], s91 offen offset:2304
    v_mfma_f32_16x16x32_bf16 v[108:111], v[192:195], a[12:15], v[108:111]
    s_add_u32 s91, s91, 8192
    v_mfma_f32_16x16x32_bf16 v[108:111], v[196:199], a[28:31], v[108:111]
    v_mfma_f32_16x16x32_bf16 v[124:127], v[200:203], a[12:15], v[124:127]
    s_add_u32 m0, s53, 0xc000
    s_add_u32 s52, s36, 786432
    v_mfma_f32_16x16x32_bf16 v[124:127], v[204:207], a[28:31], v[124:127]
    s_add_u32 s38, s36, 849920
    v_mfma_f32_16x16x32_bf16 v[120:123], v[200:203], a[8:11], v[120:123]
    ds_read_b64_tr_b16 v[184:185], v10 offset:0
    v_mfma_f32_16x16x32_bf16 v[120:123], v[204:207], a[24:27], v[120:123]
    ds_read_b64_tr_b16 v[186:187], v10 offset:8192
    v_mfma_f32_16x16x32_bf16 v[116:119], v[200:203], a[4:7], v[116:119]
    ds_read_b64_tr_b16 v[188:189], v10 offset:2048
    v_mfma_f32_16x16x32_bf16 v[116:119], v[204:207], a[20:23], v[116:119]
    buffer_load_dwordx4 v11, s[20:23], s52 offen offset:0 lds
    v_mfma_f32_16x16x32_bf16 v[112:115], v[200:203], a[0:3], v[112:115]
    ds_read_b64_tr_b16 v[190:191], v10 offset:10240
    v_mfma_f32_16x16x32_bf16 v[112:115], v[204:207], a[16:19], v[112:115]
    v_mfma_f32_16x16x32_bf16 v[128:131], v[208:211], a[0:3], v[128:131]
    ds_read_b64_tr_b16 v[192:193], v7 offset:1024
    v_mfma_f32_16x16x32_bf16 v[128:131], v[212:215], a[16:19], v[128:131]
    buffer_load_dwordx4 v12, s[20:23], s52 offen offset:1024 lds
    v_mfma_f32_16x16x32_bf16 v[132:135], v[208:211], a[4:7], v[132:135]
    ds_read_b64_tr_b16 v[194:195], v7 offset:9216
    v_mfma_f32_16x16x32_bf16 v[132:135], v[212:215], a[20:23], v[132:135]
    ds_read_b64_tr_b16 v[196:197], v7 offset:3072
    v_mfma_f32_16x16x32_bf16 v[136:139], v[208:211], a[8:11], v[136:139]
    ds_read_b64_tr_b16 v[198:199], v7 offset:11264
    v_mfma_f32_16x16x32_bf16 v[136:139], v[212:215], a[24:27], v[136:139]
    buffer_load_dwordx4 v11, s[20:23], s38 offen offset:2048 lds
    v_mfma_f32_16x16x32_bf16 v[140:143], v[208:211], a[12:15], v[140:143]
    v_mfma_f32_16x16x32_bf16 v[140:143], v[212:215], a[28:31], v[140:143]
    v_mfma_f32_16x16x32_bf16 v[156:159], v[216:219], a[12:15], v[156:159]
    ds_read_b64_tr_b16 v[200:201], v8 offset:1024
    v_mfma_f32_16x16x32_bf16 v[156:159], v[220:223], a[28:31], v[156:159]
    buffer_load_dwordx4 v12, s[20:23], s38 offen offset:3072 lds
    v_mfma_f32_16x16x32_bf16 v[152:155], v[216:219], a[8:11], v[152:155]
    ds_read_b64_tr_b16 v[202:203], v8 offset:9216
    v_mfma_f32_16x16x32_bf16 v[152:155], v[220:223], a[24:27], v[152:155]
    ds_read_b64_tr_b16 v[204:205], v8 offset:3072
    v_mfma_f32_16x16x32_bf16 v[148:151], v[216:219], a[4:7], v[148:151]
    ds_read_b64_tr_b16 v[206:207], v8 offset:11264
    v_mfma_f32_16x16x32_bf16 v[148:151], v[220:223], a[20:23], v[148:151]
    buffer_load_dwordx4 a[96:99], v15, s[4:7], s51 offen offset:0
    v_mfma_f32_16x16x32_bf16 v[144:147], v[216:219], a[0:3], v[144:147]
    v_mfma_f32_16x16x32_bf16 v[144:147], v[220:223], a[16:19], v[144:147]
    s_waitcnt vmcnt(25) lgkmcnt(12)
    v_mfma_f32_16x16x32_bf16 v[32:35], v[160:163], a[32:35], v[32:35]
    ds_read_b64_tr_b16 v[208:209], v9 offset:1024
    v_mfma_f32_16x16x32_bf16 v[32:35], v[164:167], a[48:51], v[32:35]
    buffer_load_dwordx4 a[100:103], v15, s[4:7], s51 offen offset:256
    v_mfma_f32_16x16x32_bf16 v[36:39], v[160:163], a[36:39], v[36:39]
    ds_read_b64_tr_b16 v[210:211], v9 offset:9216
    v_mfma_f32_16x16x32_bf16 v[36:39], v[164:167], a[52:55], v[36:39]
    ds_read_b64_tr_b16 v[212:213], v9 offset:3072
    v_mfma_f32_16x16x32_bf16 v[40:43], v[160:163], a[40:43], v[40:43]
    ds_read_b64_tr_b16 v[214:215], v9 offset:11264
    v_mfma_f32_16x16x32_bf16 v[40:43], v[164:167], a[56:59], v[40:43]
    buffer_load_dwordx4 a[112:115], v15, s[4:7], s51 offen offset:2048
    v_mfma_f32_16x16x32_bf16 v[44:47], v[160:163], a[44:47], v[44:47]
    v_mfma_f32_16x16x32_bf16 v[44:47], v[164:167], a[60:63], v[44:47]
    v_mfma_f32_16x16x32_bf16 v[60:63], v[168:171], a[44:47], v[60:63]
    ds_read_b64_tr_b16 v[216:217], v10 offset:1024
    v_mfma_f32_16x16x32_bf16 v[60:63], v[172:175], a[60:63], v[60:63]
    buffer_load_dwordx4 a[116:119], v15, s[4:7], s51 offen offset:2304
    v_mfma_f32_16x16x32_bf16 v[56:59], v[168:171], a[40:43], v[56:59]
    s_add_u32 s51, s51, 8192
    v_mfma_f32_16x16x32_bf16 v[56:59], v[172:175], a[56:59], v[56:59]
    ds_read_b64_tr_b16 v[218:219], v10 offset:9216
    v_mfma_f32_16x16x32_bf16 v[52:55], v[168:171], a[36:39], v[52:55]
    ds_read_b64_tr_b16 v[220:221], v10 offset:3072
    v_mfma_f32_16x16x32_bf16 v[52:55], v[172:175], a[52:55], v[52:55]
    buffer_load_dwordx4 a[104:107], v15, s[4:7], s91 offen offset:0
    v_mfma_f32_16x16x32_bf16 v[48:51], v[168:171], a[32:35], v[48:51]
    ds_read_b64_tr_b16 v[222:223], v10 offset:11264
    v_mfma_f32_16x16x32_bf16 v[48:51], v[172:175], a[48:51], v[48:51]
    s_waitcnt vmcnt(21) lgkmcnt(0)
    s_barrier
    v_mfma_f32_16x16x32_bf16 v[64:67], v[176:179], a[32:35], v[64:67]
    ds_read_b64_tr_b16 v[160:161], v7 offset:32768
    v_mfma_f32_16x16x32_bf16 v[64:67], v[180:183], a[48:51], v[64:67]
    buffer_load_dwordx4 a[108:111], v15, s[4:7], s91 offen offset:256
    v_mfma_f32_16x16x32_bf16 v[68:71], v[176:179], a[36:39], v[68:71]
    ds_read_b64_tr_b16 v[162:163], v7 offset:40960
    v_mfma_f32_16x16x32_bf16 v[68:71], v[180:183], a[52:55], v[68:71]
    ds_read_b64_tr_b16 v[164:165], v7 offset:34816
    v_mfma_f32_16x16x32_bf16 v[72:75], v[176:179], a[40:43], v[72:75]
    ds_read_b64_tr_b16 v[166:167], v7 offset:43008
    v_mfma_f32_16x16x32_bf16 v[72:75], v[180:183], a[56:59], v[72:75]
    buffer_load_dwordx4 a[120:123], v15, s[4:7], s91 offen offset:2048
    v_mfma_f32_16x16x32_bf16 v[76:79], v[176:179], a[44:47], v[76:79]
    v_mfma_f32_16x16x32_bf16 v[76:79], v[180:183], a[60:63], v[76:79]
    v_mfma_f32_16x16x32_bf16 v[92:95], v[184:187], a[44:47], v[92:95]
    ds_read_b64_tr_b16 v[168:169], v8 offset:32768
    v_mfma_f32_16x16x32_bf16 v[92:95], v[188:191], a[60:63], v[92:95]
    buffer_load_dwordx4 a[124:127], v15, s[4:7], s91 offen offset:2304
    v_mfma_f32_16x16x32_bf16 v[88:91], v[184:187], a[40:43], v[88:91]
    s_add_u32 s91, s91, 8192
    s_add_u32 m0, s53, 0x0
    v_mfma_f32_16x16x32_bf16 v[88:91], v[188:191], a[56:59], v[88:91]
    s_add_u32 s52, s36, 1015808
    s_add_u32 s38, s36, 1079296
    v_mfma_f32_16x16x32_bf16 v[84:87], v[184:187], a[36:39], v[84:87]
    ds_read_b64_tr_b16 v[170:171], v8 offset:40960
    v_mfma_f32_16x16x32_bf16 v[84:87], v[188:191], a[52:55], v[84:87]
    buffer_load_dwordx4 v11, s[20:23], s52 offen offset:0 lds
    v_mfma_f32_16x16x32_bf16 v[80:83], v[184:187], a[32:35], v[80:83]
    ds_read_b64_tr_b16 v[172:173], v8 offset:34816
    v_mfma_f32_16x16x32_bf16 v[80:83], v[188:191], a[48:51], v[80:83]
    ds_read_b64_tr_b16 v[174:175], v8 offset:43008
    v_mfma_f32_16x16x32_bf16 v[96:99], v[192:195], a[32:35], v[96:99]
    ds_read_b64_tr_b16 v[176:177], v9 offset:32768
    v_mfma_f32_16x16x32_bf16 v[96:99], v[196:199], a[48:51], v[96:99]
    ds_read_b64_tr_b16 v[178:179], v9 offset:40960
    v_mfma_f32_16x16x32_bf16 v[100:103], v[192:195], a[36:39], v[100:103]
    ds_read_b64_tr_b16 v[180:181], v9 offset:34816
    v_mfma_f32_16x16x32_bf16 v[100:103], v[196:199], a[52:55], v[100:103]
    ds_read_b64_tr_b16 v[182:183], v9 offset:43008
    v_mfma_f32_16x16x32_bf16 v[104:107], v[192:195], a[40:43], v[104:107]
    v_mfma_f32_16x16x32_bf16 v[104:107], v[196:199], a[56:59], v[104:107]
    buffer_load_dwordx4 v12, s[20:23], s52 offen offset:1024 lds
    v_mfma_f32_16x16x32_bf16 v[108:111], v[192:195], a[44:47], v[108:111]
    v_mfma_f32_16x16x32_bf16 v[108:111], v[196:199], a[60:63], v[108:111]
    v_mfma_f32_16x16x32_bf16 v[124:127], v[200:203], a[44:47], v[124:127]
    ds_read_b64_tr_b16 v[184:185], v10 offset:32768
    v_mfma_f32_16x16x32_bf16 v[124:127], v[204:207], a[60:63], v[124:127]
    buffer_load_dwordx4 v11, s[20:23], s38 offen offset:2048 lds
    v_mfma_f32_16x16x32_bf16 v[120:123], v[200:203], a[40:43], v[120:123]
    ds_read_b64_tr_b16 v[186:187], v10 offset:40960
    v_mfma_f32_16x16x32_bf16 v[120:123], v[204:207], a[56:59], v[120:123]
    ds_read_b64_tr_b16 v[188:189], v10 offset:34816
    v_mfma_f32_16x16x32_bf16 v[116:119], v[200:203], a[36:39], v[116:119]
    ds_read_b64_tr_b16 v[190:191], v10 offset:43008
    v_mfma_f32_16x16x32_bf16 v[116:119], v[204:207], a[52:55], v[116:119]
    buffer_load_dwordx4 v12, s[20:23], s38 offen offset:3072 lds
    v_mfma_f32_16x16x32_bf16 v[112:115], v[200:203], a[32:35], v[112:115]
    v_mfma_f32_16x16x32_bf16 v[112:115], v[204:207], a[48:51], v[112:115]
    v_mfma_f32_16x16x32_bf16 v[128:131], v[208:211], a[32:35], v[128:131]
    s_add_u32 m0, s53, 0x4000
    s_add_u32 s52, s36, 1245184
    v_mfma_f32_16x16x32_bf16 v[128:131], v[212:215], a[48:51], v[128:131]
    s_add_u32 s38, s36, 1308672
    v_mfma_f32_16x16x32_bf16 v[132:135], v[208:211], a[36:39], v[132:135]
    ds_read_b64_tr_b16 v[192:193], v7 offset:33792
    v_mfma_f32_16x16x32_bf16 v[132:135], v[212:215], a[52:55], v[132:135]
    ds_read_b64_tr_b16 v[194:195], v7 offset:41984
    v_mfma_f32_16x16x32_bf16 v[136:139], v[208:211], a[40:43], v[136:139]
    ds_read_b64_tr_b16 v[196:197], v7 offset:35840
    v_mfma_f32_16x16x32_bf16 v[136:139], v[212:215], a[56:59], v[136:139]
    buffer_load_dwordx4 v11, s[20:23], s52 offen offset:0 lds
    v_mfma_f32_16x16x32_bf16 v[140:143], v[208:211], a[44:47], v[140:143]
    ds_read_b64_tr_b16 v[198:199], v7 offset:44032
    v_mfma_f32_16x16x32_bf16 v[140:143], v[212:215], a[60:63], v[140:143]
    v_mfma_f32_16x16x32_bf16 v[156:159], v[216:219], a[44:47], v[156:159]
    ds_read_b64_tr_b16 v[200:201], v8 offset:33792
    v_mfma_f32_16x16x32_bf16 v[156:159], v[220:223], a[60:63], v[156:159]
    buffer_load_dwordx4 v12, s[20:23], s52 offen offset:1024 lds
    v_mfma_f32_16x16x32_bf16 v[152:155], v[216:219], a[40:43], v[152:155]
    ds_read_b64_tr_b16 v[202:203], v8 offset:41984
    v_mfma_f32_16x16x32_bf16 v[152:155], v[220:223], a[56:59], v[152:155]
    ds_read_b64_tr_b16 v[204:205], v8 offset:35840
    v_mfma_f32_16x16x32_bf16 v[148:151], v[216:219], a[36:39], v[148:151]
    ds_read_b64_tr_b16 v[206:207], v8 offset:44032
    v_mfma_f32_16x16x32_bf16 v[148:151], v[220:223], a[52:55], v[148:151]
    buffer_load_dwordx4 v11, s[20:23], s38 offen offset:2048 lds
    v_mfma_f32_16x16x32_bf16 v[144:147], v[216:219], a[32:35], v[144:147]
    v_mfma_f32_16x16x32_bf16 v[144:147], v[220:223], a[48:51], v[144:147]
    s_waitcnt vmcnt(19) lgkmcnt(12)
    v_mfma_f32_16x16x32_bf16 v[32:35], v[160:163], a[64:67], v[32:35]
    ds_read_b64_tr_b16 v[208:209], v9 offset:33792
    v_mfma_f32_16x16x32_bf16 v[32:35], v[164:167], a[80:83], v[32:35]
    buffer_load_dwordx4 v12, s[20:23], s38 offen offset:3072 lds
    v_mfma_f32_16x16x32_bf16 v[36:39], v[160:163], a[68:71], v[36:39]
    ds_read_b64_tr_b16 v[210:211], v9 offset:41984
    v_mfma_f32_16x16x32_bf16 v[36:39], v[164:167], a[84:87], v[36:39]
    ds_read_b64_tr_b16 v[212:213], v9 offset:35840
    v_mfma_f32_16x16x32_bf16 v[40:43], v[160:163], a[72:75], v[40:43]
    ds_read_b64_tr_b16 v[214:215], v9 offset:44032
    v_mfma_f32_16x16x32_bf16 v[40:43], v[164:167], a[88:91], v[40:43]
    buffer_load_dwordx4 a[0:3], v15, s[4:7], s51 offen offset:0
    v_mfma_f32_16x16x32_bf16 v[44:47], v[160:163], a[76:79], v[44:47]
    v_mfma_f32_16x16x32_bf16 v[44:47], v[164:167], a[92:95], v[44:47]
    v_mfma_f32_16x16x32_bf16 v[60:63], v[168:171], a[76:79], v[60:63]
    ds_read_b64_tr_b16 v[216:217], v10 offset:33792
    v_mfma_f32_16x16x32_bf16 v[60:63], v[172:175], a[92:95], v[60:63]
    buffer_load_dwordx4 a[4:7], v15, s[4:7], s51 offen offset:256
    v_mfma_f32_16x16x32_bf16 v[56:59], v[168:171], a[72:75], v[56:59]
    ds_read_b64_tr_b16 v[218:219], v10 offset:41984
    v_mfma_f32_16x16x32_bf16 v[56:59], v[172:175], a[88:91], v[56:59]
    ds_read_b64_tr_b16 v[220:221], v10 offset:35840
    v_mfma_f32_16x16x32_bf16 v[52:55], v[168:171], a[68:71], v[52:55]
    ds_read_b64_tr_b16 v[222:223], v10 offset:44032
    v_mfma_f32_16x16x32_bf16 v[52:55], v[172:175], a[84:87], v[52:55]
    buffer_load_dwordx4 a[16:19], v15, s[4:7], s51 offen offset:2048
    v_mfma_f32_16x16x32_bf16 v[48:51], v[168:171], a[64:67], v[48:51]
    v_mfma_f32_16x16x32_bf16 v[48:51], v[172:175], a[80:83], v[48:51]
    s_waitcnt vmcnt(19) lgkmcnt(0)
    s_barrier
    v_mfma_f32_16x16x32_bf16 v[64:67], v[176:179], a[64:67], v[64:67]
    ds_read_b64_tr_b16 v[160:161], v232 offset:32768
    v_mfma_f32_16x16x32_bf16 v[64:67], v[180:183], a[80:83], v[64:67]
    buffer_load_dwordx4 a[20:23], v15, s[4:7], s51 offen offset:2304
    v_mfma_f32_16x16x32_bf16 v[68:71], v[176:179], a[68:71], v[68:71]
    s_add_u32 s51, s51, 8192
    v_mfma_f32_16x16x32_bf16 v[68:71], v[180:183], a[84:87], v[68:71]
    ds_read_b64_tr_b16 v[162:163], v232 offset:40960
    v_mfma_f32_16x16x32_bf16 v[72:75], v[176:179], a[72:75], v[72:75]
    ds_read_b64_tr_b16 v[164:165], v232 offset:34816
    v_mfma_f32_16x16x32_bf16 v[72:75], v[180:183], a[88:91], v[72:75]
    buffer_load_dwordx4 a[8:11], v15, s[4:7], s91 offen offset:0
    v_mfma_f32_16x16x32_bf16 v[76:79], v[176:179], a[76:79], v[76:79]
    ds_read_b64_tr_b16 v[166:167], v232 offset:43008
    v_mfma_f32_16x16x32_bf16 v[76:79], v[180:183], a[92:95], v[76:79]
    v_mfma_f32_16x16x32_bf16 v[92:95], v[184:187], a[76:79], v[92:95]
    ds_read_b64_tr_b16 v[168:169], v233 offset:32768
    v_mfma_f32_16x16x32_bf16 v[92:95], v[188:191], a[92:95], v[92:95]
    buffer_load_dwordx4 a[12:15], v15, s[4:7], s91 offen offset:256
    v_mfma_f32_16x16x32_bf16 v[88:91], v[184:187], a[72:75], v[88:91]
    ds_read_b64_tr_b16 v[170:171], v233 offset:40960
    v_mfma_f32_16x16x32_bf16 v[88:91], v[188:191], a[88:91], v[88:91]
    ds_read_b64_tr_b16 v[172:173], v233 offset:34816
    v_mfma_f32_16x16x32_bf16 v[84:87], v[184:187], a[68:71], v[84:87]
    ds_read_b64_tr_b16 v[174:175], v233 offset:43008
    v_mfma_f32_16x16x32_bf16 v[84:87], v[188:191], a[84:87], v[84:87]
    buffer_load_dwordx4 a[24:27], v15, s[4:7], s91 offen offset:2048
    v_mfma_f32_16x16x32_bf16 v[80:83], v[184:187], a[64:67], v[80:83]
    v_mfma_f32_16x16x32_bf16 v[80:83], v[188:191], a[80:83], v[80:83]
    v_mfma_f32_16x16x32_bf16 v[96:99], v[192:195], a[64:67], v[96:99]
    ds_read_b64_tr_b16 v[176:177], v234 offset:32768
    v_mfma_f32_16x16x32_bf16 v[96:99], v[196:199], a[80:83], v[96:99]
    buffer_load_dwordx4 a[28:31], v15, s[4:7], s91 offen offset:2304
    v_mfma_f32_16x16x32_bf16 v[100:103], v[192:195], a[68:71], v[100:103]
    s_add_u32 s91, s91, 8192
    s_add_u32 m0, s53, 0x20000
    v_mfma_f32_16x16x32_bf16 v[100:103], v[196:199], a[84:87], v[100:103]
    s_add_u32 s52, s36, 1474560
    s_add_u32 s38, s36, 1538048
    v_mfma_f32_16x16x32_bf16 v[104:107], v[192:195], a[72:75], v[104:107]
    ds_read_b64_tr_b16 v[178:179], v234 offset:40960
    v_mfma_f32_16x16x32_bf16 v[104:107], v[196:199], a[88:91], v[104:107]
    buffer_load_dwordx4 v11, s[20:23], s52 offen offset:0 lds
    v_mfma_f32_16x16x32_bf16 v[108:111], v[192:195], a[76:79], v[108:111]
    ds_read_b64_tr_b16 v[180:181], v234 offset:34816
    v_mfma_f32_16x16x32_bf16 v[108:111], v[196:199], a[92:95], v[108:111]
    ds_read_b64_tr_b16 v[182:183], v234 offset:43008
    v_mfma_f32_16x16x32_bf16 v[124:127], v[200:203], a[76:79], v[124:127]
    ds_read_b64_tr_b16 v[184:185], v235 offset:32768
    v_mfma_f32_16x16x32_bf16 v[124:127], v[204:207], a[92:95], v[124:127]
    ds_read_b64_tr_b16 v[186:187], v235 offset:40960
    v_mfma_f32_16x16x32_bf16 v[120:123], v[200:203], a[72:75], v[120:123]
    ds_read_b64_tr_b16 v[188:189], v235 offset:34816
    v_mfma_f32_16x16x32_bf16 v[120:123], v[204:207], a[88:91], v[120:123]
    ds_read_b64_tr_b16 v[190:191], v235 offset:43008
    v_mfma_f32_16x16x32_bf16 v[116:119], v[200:203], a[68:71], v[116:119]
    v_mfma_f32_16x16x32_bf16 v[116:119], v[204:207], a[84:87], v[116:119]
    buffer_load_dwordx4 v12, s[20:23], s52 offen offset:1024 lds
    v_mfma_f32_16x16x32_bf16 v[112:115], v[200:203], a[64:67], v[112:115]
    v_mfma_f32_16x16x32_bf16 v[112:115], v[204:207], a[80:83], v[112:115]
    v_mfma_f32_16x16x32_bf16 v[128:131], v[208:211], a[64:67], v[128:131]
    ds_read_b64_tr_b16 v[192:193], v232 offset:33792
    v_mfma_f32_16x16x32_bf16 v[128:131], v[212:215], a[80:83], v[128:131]
    buffer_load_dwordx4 v11, s[20:23], s38 offen offset:2048 lds
    v_mfma_f32_16x16x32_bf16 v[132:135], v[208:211], a[68:71], v[132:135]
    ds_read_b64_tr_b16 v[194:195], v232 offset:41984
    v_mfma_f32_16x16x32_bf16 v[132:135], v[212:215], a[84:87], v[132:135]
    ds_read_b64_tr_b16 v[196:197], v232 offset:35840
    v_mfma_f32_16x16x32_bf16 v[136:139], v[208:211], a[72:75], v[136:139]
    ds_read_b64_tr_b16 v[198:199], v232 offset:44032
    v_mfma_f32_16x16x32_bf16 v[136:139], v[212:215], a[88:91], v[136:139]
    buffer_load_dwordx4 v12, s[20:23], s38 offen offset:3072 lds
    v_mfma_f32_16x16x32_bf16 v[140:143], v[208:211], a[76:79], v[140:143]
    v_mfma_f32_16x16x32_bf16 v[140:143], v[212:215], a[92:95], v[140:143]
    v_mfma_f32_16x16x32_bf16 v[156:159], v[216:219], a[76:79], v[156:159]
    s_add_u32 m0, s53, 0x24000
    s_add_u32 s52, s36, 1703936
    v_mfma_f32_16x16x32_bf16 v[156:159], v[220:223], a[92:95], v[156:159]
    s_add_u32 s38, s36, 1767424
    v_mfma_f32_16x16x32_bf16 v[152:155], v[216:219], a[72:75], v[152:155]
    ds_read_b64_tr_b16 v[200:201], v233 offset:33792
    v_mfma_f32_16x16x32_bf16 v[152:155], v[220:223], a[88:91], v[152:155]
    ds_read_b64_tr_b16 v[202:203], v233 offset:41984
    v_mfma_f32_16x16x32_bf16 v[148:151], v[216:219], a[68:71], v[148:151]
    ds_read_b64_tr_b16 v[204:205], v233 offset:35840
    v_mfma_f32_16x16x32_bf16 v[148:151], v[220:223], a[84:87], v[148:151]
    buffer_load_dwordx4 v11, s[20:23], s52 offen offset:0 lds
    v_mfma_f32_16x16x32_bf16 v[144:147], v[216:219], a[64:67], v[144:147]
    ds_read_b64_tr_b16 v[206:207], v233 offset:44032
    v_mfma_f32_16x16x32_bf16 v[144:147], v[220:223], a[80:83], v[144:147]
    s_waitcnt vmcnt(21) lgkmcnt(12)
    v_mfma_f32_16x16x32_bf16 v[32:35], v[160:163], a[96:99], v[32:35]
    ds_read_b64_tr_b16 v[208:209], v234 offset:33792
    v_mfma_f32_16x16x32_bf16 v[32:35], v[164:167], a[112:115], v[32:35]
    buffer_load_dwordx4 v12, s[20:23], s52 offen offset:1024 lds
    v_mfma_f32_16x16x32_bf16 v[36:39], v[160:163], a[100:103], v[36:39]
    ds_read_b64_tr_b16 v[210:211], v234 offset:41984
    v_mfma_f32_16x16x32_bf16 v[36:39], v[164:167], a[116:119], v[36:39]
    ds_read_b64_tr_b16 v[212:213], v234 offset:35840
    v_mfma_f32_16x16x32_bf16 v[40:43], v[160:163], a[104:107], v[40:43]
    ds_read_b64_tr_b16 v[214:215], v234 offset:44032
    v_mfma_f32_16x16x32_bf16 v[40:43], v[164:167], a[120:123], v[40:43]
    buffer_load_dwordx4 v11, s[20:23], s38 offen offset:2048 lds
    v_mfma_f32_16x16x32_bf16 v[44:47], v[160:163], a[108:111], v[44:47]
    v_mfma_f32_16x16x32_bf16 v[44:47], v[164:167], a[124:127], v[44:47]
    v_mfma_f32_16x16x32_bf16 v[60:63], v[168:171], a[108:111], v[60:63]
    ds_read_b64_tr_b16 v[216:217], v235 offset:33792
    v_mfma_f32_16x16x32_bf16 v[60:63], v[172:175], a[124:127], v[60:63]
    buffer_load_dwordx4 v12, s[20:23], s38 offen offset:3072 lds
    v_mfma_f32_16x16x32_bf16 v[56:59], v[168:171], a[104:107], v[56:59]
    ds_read_b64_tr_b16 v[218:219], v235 offset:41984
    v_mfma_f32_16x16x32_bf16 v[56:59], v[172:175], a[120:123], v[56:59]
    ds_read_b64_tr_b16 v[220:221], v235 offset:35840
    v_mfma_f32_16x16x32_bf16 v[52:55], v[168:171], a[100:103], v[52:55]
    ds_read_b64_tr_b16 v[222:223], v235 offset:44032
    v_mfma_f32_16x16x32_bf16 v[52:55], v[172:175], a[116:119], v[52:55]
    buffer_load_dwordx4 a[32:35], v15, s[4:7], s51 offen offset:0
    v_mfma_f32_16x16x32_bf16 v[48:51], v[168:171], a[96:99], v[48:51]
    v_mfma_f32_16x16x32_bf16 v[48:51], v[172:175], a[112:115], v[48:51]
    s_waitcnt vmcnt(17) lgkmcnt(0)
    s_barrier
    v_mfma_f32_16x16x32_bf16 v[64:67], v[176:179], a[96:99], v[64:67]
    ds_read_b64_tr_b16 v[160:161], v232 offset:0
    v_mfma_f32_16x16x32_bf16 v[64:67], v[180:183], a[112:115], v[64:67]
    buffer_load_dwordx4 a[36:39], v15, s[4:7], s51 offen offset:256
    v_mfma_f32_16x16x32_bf16 v[68:71], v[176:179], a[100:103], v[68:71]
    ds_read_b64_tr_b16 v[162:163], v232 offset:8192
    v_mfma_f32_16x16x32_bf16 v[68:71], v[180:183], a[116:119], v[68:71]
    ds_read_b64_tr_b16 v[164:165], v232 offset:2048
    v_mfma_f32_16x16x32_bf16 v[72:75], v[176:179], a[104:107], v[72:75]
    ds_read_b64_tr_b16 v[166:167], v232 offset:10240
    v_mfma_f32_16x16x32_bf16 v[72:75], v[180:183], a[120:123], v[72:75]
    buffer_load_dwordx4 a[48:51], v15, s[4:7], s51 offen offset:2048
    v_mfma_f32_16x16x32_bf16 v[76:79], v[176:179], a[108:111], v[76:79]
    v_mfma_f32_16x16x32_bf16 v[76:79], v[180:183], a[124:127], v[76:79]
    v_mfma_f32_16x16x32_bf16 v[92:95], v[184:187], a[108:111], v[92:95]
    ds_read_b64_tr_b16 v[168:169], v233 offset:0
    v_mfma_f32_16x16x32_bf16 v[92:95], v[188:191], a[124:127], v[92:95]
    buffer_load_dwordx4 a[52:55], v15, s[4:7], s51 offen offset:2304
    v_mfma_f32_16x16x32_bf16 v[88:91], v[184:187], a[104:107], v[88:91]
    s_add_u32 s51, s51, 8192
    v_mfma_f32_16x16x32_bf16 v[88:91], v[188:191], a[120:123], v[88:91]
    ds_read_b64_tr_b16 v[170:171], v233 offset:8192
    v_mfma_f32_16x16x32_bf16 v[84:87], v[184:187], a[100:103], v[84:87]
    ds_read_b64_tr_b16 v[172:173], v233 offset:2048
    v_mfma_f32_16x16x32_bf16 v[84:87], v[188:191], a[116:119], v[84:87]
    buffer_load_dwordx4 a[40:43], v15, s[4:7], s91 offen offset:0
    v_mfma_f32_16x16x32_bf16 v[80:83], v[184:187], a[96:99], v[80:83]
    ds_read_b64_tr_b16 v[174:175], v233 offset:10240
    v_mfma_f32_16x16x32_bf16 v[80:83], v[188:191], a[112:115], v[80:83]
    v_mfma_f32_16x16x32_bf16 v[96:99], v[192:195], a[96:99], v[96:99]
    ds_read_b64_tr_b16 v[176:177], v234 offset:0
    v_mfma_f32_16x16x32_bf16 v[96:99], v[196:199], a[112:115], v[96:99]
    buffer_load_dwordx4 a[44:47], v15, s[4:7], s91 offen offset:256
    v_mfma_f32_16x16x32_bf16 v[100:103], v[192:195], a[100:103], v[100:103]
    ds_read_b64_tr_b16 v[178:179], v234 offset:8192
    v_mfma_f32_16x16x32_bf16 v[100:103], v[196:199], a[116:119], v[100:103]
    ds_read_b64_tr_b16 v[180:181], v234 offset:2048
    v_mfma_f32_16x16x32_bf16 v[104:107], v[192:195], a[104:107], v[104:107]
    ds_read_b64_tr_b16 v[182:183], v234 offset:10240
    v_mfma_f32_16x16x32_bf16 v[104:107], v[196:199], a[120:123], v[104:107]
    buffer_load_dwordx4 a[56:59], v15, s[4:7], s91 offen offset:2048
    v_mfma_f32_16x16x32_bf16 v[108:111], v[192:195], a[108:111], v[108:111]
    v_mfma_f32_16x16x32_bf16 v[108:111], v[196:199], a[124:127], v[108:111]
    v_mfma_f32_16x16x32_bf16 v[124:127], v[200:203], a[108:111], v[124:127]
    ds_read_b64_tr_b16 v[184:185], v235 offset:0
    v_mfma_f32_16x16x32_bf16 v[124:127], v[204:207], a[124:127], v[124:127]
    buffer_load_dwordx4 a[60:63], v15, s[4:7], s91 offen offset:2304
    v_mfma_f32_16x16x32_bf16 v[120:123], v[200:203], a[104:107], v[120:123]
    s_add_u32 s91, s91, 8192
    s_add_u32 m0, s53, 0x10000
    v_mfma_f32_16x16x32_bf16 v[120:123], v[204:207], a[120:123], v[120:123]
    s_add_u32 s52, s36, 1933312
    s_add_u32 s38, s36, 1996800
    v_mfma_f32_16x16x32_bf16 v[116:119], v[200:203], a[100:103], v[116:119]
    ds_read_b64_tr_b16 v[186:187], v235 offset:8192
    v_mfma_f32_16x16x32_bf16 v[116:119], v[204:207], a[116:119], v[116:119]
    buffer_load_dwordx4 v11, s[20:23], s52 offen offset:0 lds
    v_mfma_f32_16x16x32_bf16 v[112:115], v[200:203], a[96:99], v[112:115]
    ds_read_b64_tr_b16 v[188:189], v235 offset:2048
    v_mfma_f32_16x16x32_bf16 v[112:115], v[204:207], a[112:115], v[112:115]
    ds_read_b64_tr_b16 v[190:191], v235 offset:10240
    v_mfma_f32_16x16x32_bf16 v[128:131], v[208:211], a[96:99], v[128:131]
    ds_read_b64_tr_b16 v[192:193], v232 offset:1024
    v_mfma_f32_16x16x32_bf16 v[128:131], v[212:215], a[112:115], v[128:131]
    ds_read_b64_tr_b16 v[194:195], v232 offset:9216
    v_mfma_f32_16x16x32_bf16 v[132:135], v[208:211], a[100:103], v[132:135]
    ds_read_b64_tr_b16 v[196:197], v232 offset:3072
    v_mfma_f32_16x16x32_bf16 v[132:135], v[212:215], a[116:119], v[132:135]
    ds_read_b64_tr_b16 v[198:199], v232 offset:11264
    v_mfma_f32_16x16x32_bf16 v[136:139], v[208:211], a[104:107], v[136:139]
    v_mfma_f32_16x16x32_bf16 v[136:139], v[212:215], a[120:123], v[136:139]
    buffer_load_dwordx4 v12, s[20:23], s52 offen offset:1024 lds
    v_mfma_f32_16x16x32_bf16 v[140:143], v[208:211], a[108:111], v[140:143]
    v_mfma_f32_16x16x32_bf16 v[140:143], v[212:215], a[124:127], v[140:143]
    v_mfma_f32_16x16x32_bf16 v[156:159], v[216:219], a[108:111], v[156:159]
    ds_read_b64_tr_b16 v[200:201], v233 offset:1024
    v_mfma_f32_16x16x32_bf16 v[156:159], v[220:223], a[124:127], v[156:159]
    buffer_load_dwordx4 v11, s[20:23], s38 offen offset:2048 lds
    v_mfma_f32_16x16x32_bf16 v[152:155], v[216:219], a[104:107], v[152:155]
    ds_read_b64_tr_b16 v[202:203], v233 offset:9216
    v_mfma_f32_16x16x32_bf16 v[152:155], v[220:223], a[120:123], v[152:155]
    ds_read_b64_tr_b16 v[204:205], v233 offset:3072
    v_mfma_f32_16x16x32_bf16 v[148:151], v[216:219], a[100:103], v[148:151]
    ds_read_b64_tr_b16 v[206:207], v233 offset:11264
    v_mfma_f32_16x16x32_bf16 v[148:151], v[220:223], a[116:119], v[148:151]
    buffer_load_dwordx4 v12, s[20:23], s38 offen offset:3072 lds
    v_mfma_f32_16x16x32_bf16 v[144:147], v[216:219], a[96:99], v[144:147]
    v_mfma_f32_16x16x32_bf16 v[144:147], v[220:223], a[112:115], v[144:147]
    s_waitcnt vmcnt(20) lgkmcnt(12)
    v_mfma_f32_16x16x32_bf16 v[32:35], v[160:163], a[0:3], v[32:35]
    s_add_u32 m0, s53, 0x14000
    s_add_u32 s52, s36, 2162688
    v_mfma_f32_16x16x32_bf16 v[32:35], v[164:167], a[16:19], v[32:35]
    s_add_u32 s38, s36, 2226176
    v_mfma_f32_16x16x32_bf16 v[36:39], v[160:163], a[4:7], v[36:39]
    ds_read_b64_tr_b16 v[208:209], v234 offset:1024
    v_mfma_f32_16x16x32_bf16 v[36:39], v[164:167], a[20:23], v[36:39]
    ds_read_b64_tr_b16 v[210:211], v234 offset:9216
    v_mfma_f32_16x16x32_bf16 v[40:43], v[160:163], a[8:11], v[40:43]
    ds_read_b64_tr_b16 v[212:213], v234 offset:3072
    v_mfma_f32_16x16x32_bf16 v[40:43], v[164:167], a[24:27], v[40:43]
    buffer_load_dwordx4 v11, s[20:23], s52 offen offset:0 lds
    v_mfma_f32_16x16x32_bf16 v[44:47], v[160:163], a[12:15], v[44:47]
    ds_read_b64_tr_b16 v[214:215], v234 offset:11264
    v_mfma_f32_16x16x32_bf16 v[44:47], v[164:167], a[28:31], v[44:47]
    v_mfma_f32_16x16x32_bf16 v[60:63], v[168:171], a[12:15], v[60:63]
    ds_read_b64_tr_b16 v[216:217], v235 offset:1024
    v_mfma_f32_16x16x32_bf16 v[60:63], v[172:175], a[28:31], v[60:63]
    buffer_load_dwordx4 v12, s[20:23], s52 offen offset:1024 lds
    v_mfma_f32_16x16x32_bf16 v[56:59], v[168:171], a[8:11], v[56:59]
    ds_read_b64_tr_b16 v[218:219], v235 offset:9216
    v_mfma_f32_16x16x32_bf16 v[56:59], v[172:175], a[24:27], v[56:59]
    ds_read_b64_tr_b16 v[220:221], v235 offset:3072
    v_mfma_f32_16x16x32_bf16 v[52:55], v[168:171], a[4:7], v[52:55]
    ds_read_b64_tr_b16 v[222:223], v235 offset:11264
    v_mfma_f32_16x16x32_bf16 v[52:55], v[172:175], a[20:23], v[52:55]
    buffer_load_dwordx4 v11, s[20:23], s38 offen offset:2048 lds
    v_mfma_f32_16x16x32_bf16 v[48:51], v[168:171], a[0:3], v[48:51]
    v_mfma_f32_16x16x32_bf16 v[48:51], v[172:175], a[16:19], v[48:51]
    s_waitcnt vmcnt(15) lgkmcnt(0)
    s_barrier
    v_mfma_f32_16x16x32_bf16 v[64:67], v[176:179], a[0:3], v[64:67]
    ds_read_b64_tr_b16 v[160:161], v244 offset:0
    v_mfma_f32_16x16x32_bf16 v[64:67], v[180:183], a[16:19], v[64:67]
    buffer_load_dwordx4 v12, s[20:23], s38 offen offset:3072 lds
    v_mfma_f32_16x16x32_bf16 v[68:71], v[176:179], a[4:7], v[68:71]
    ds_read_b64_tr_b16 v[162:163], v244 offset:8192
    v_mfma_f32_16x16x32_bf16 v[68:71], v[180:183], a[20:23], v[68:71]
    ds_read_b64_tr_b16 v[164:165], v244 offset:2048
    v_mfma_f32_16x16x32_bf16 v[72:75], v[176:179], a[8:11], v[72:75]
    ds_read_b64_tr_b16 v[166:167], v244 offset:10240
    v_mfma_f32_16x16x32_bf16 v[72:75], v[180:183], a[24:27], v[72:75]
    buffer_load_dwordx4 a[64:67], v15, s[4:7], s51 offen offset:0
    v_mfma_f32_16x16x32_bf16 v[76:79], v[176:179], a[12:15], v[76:79]
    v_mfma_f32_16x16x32_bf16 v[76:79], v[180:183], a[28:31], v[76:79]
    v_mfma_f32_16x16x32_bf16 v[92:95], v[184:187], a[12:15], v[92:95]
    ds_read_b64_tr_b16 v[168:169], v245 offset:0
    v_mfma_f32_16x16x32_bf16 v[92:95], v[188:191], a[28:31], v[92:95]
    buffer_load_dwordx4 a[68:71], v15, s[4:7], s51 offen offset:256
    v_mfma_f32_16x16x32_bf16 v[88:91], v[184:187], a[8:11], v[88:91]
    ds_read_b64_tr_b16 v[170:171], v245 offset:8192
    v_mfma_f32_16x16x32_bf16 v[88:91], v[188:191], a[24:27], v[88:91]
    ds_read_b64_tr_b16 v[172:173], v245 offset:2048
    v_mfma_f32_16x16x32_bf16 v[84:87], v[184:187], a[4:7], v[84:87]
    ds_read_b64_tr_b16 v[174:175], v245 offset:10240
    v_mfma_f32_16x16x32_bf16 v[84:87], v[188:191], a[20:23], v[84:87]
    buffer_load_dwordx4 a[80:83], v15, s[4:7], s51 offen offset:2048
    v_mfma_f32_16x16x32_bf16 v[80:83], v[184:187], a[0:3], v[80:83]
    v_mfma_f32_16x16x32_bf16 v[80:83], v[188:191], a[16:19], v[80:83]
    v_mfma_f32_16x16x32_bf16 v[96:99], v[192:195], a[0:3], v[96:99]
    ds_read_b64_tr_b16 v[176:177], v246 offset:0
    v_mfma_f32_16x16x32_bf16 v[96:99], v[196:199], a[16:19], v[96:99]
    buffer_load_dwordx4 a[84:87], v15, s[4:7], s51 offen offset:2304
    v_mfma_f32_16x16x32_bf16 v[100:103], v[192:195], a[4:7], v[100:103]
    s_add_u32 s51, s51, 8192
    v_mfma_f32_16x16x32_bf16 v[100:103], v[196:199], a[20:23], v[100:103]
    ds_read_b64_tr_b16 v[178:179], v246 offset:8192
    v_mfma_f32_16x16x32_bf16 v[104:107], v[192:195], a[8:11], v[104:107]
    ds_read_b64_tr_b16 v[180:181], v246 offset:2048
    v_mfma_f32_16x16x32_bf16 v[104:107], v[196:199], a[24:27], v[104:107]
    buffer_load_dwordx4 a[72:75], v15, s[4:7], s91 offen offset:0
    v_mfma_f32_16x16x32_bf16 v[108:111], v[192:195], a[12:15], v[108:111]
    ds_read_b64_tr_b16 v[182:183], v246 offset:10240
    v_mfma_f32_16x16x32_bf16 v[108:111], v[196:199], a[28:31], v[108:111]
    v_mfma_f32_16x16x32_bf16 v[124:127], v[200:203], a[12:15], v[124:127]
    ds_read_b64_tr_b16 v[184:185], v247 offset:0
    v_mfma_f32_16x16x32_bf16 v[124:127], v[204:207], a[28:31], v[124:127]
    buffer_load_dwordx4 a[76:79], v15, s[4:7], s91 offen offset:256
    v_mfma_f32_16x16x32_bf16 v[120:123], v[200:203], a[8:11], v[120:123]
    ds_read_b64_tr_b16 v[186:187], v247 offset:8192
    v_mfma_f32_16x16x32_bf16 v[120:123], v[204:207], a[24:27], v[120:123]
    ds_read_b64_tr_b16 v[188:189], v247 offset:2048
    v_mfma_f32_16x16x32_bf16 v[116:119], v[200:203], a[4:7], v[116:119]
    ds_read_b64_tr_b16 v[190:191], v247 offset:10240
    v_mfma_f32_16x16x32_bf16 v[116:119], v[204:207], a[20:23], v[116:119]
    buffer_load_dwordx4 a[88:91], v15, s[4:7], s91 offen offset:2048
    v_mfma_f32_16x16x32_bf16 v[112:115], v[200:203], a[0:3], v[112:115]
    v_mfma_f32_16x16x32_bf16 v[112:115], v[204:207], a[16:19], v[112:115]
    v_mfma_f32_16x16x32_bf16 v[128:131], v[208:211], a[0:3], v[128:131]
    ds_read_b64_tr_b16 v[192:193], v244 offset:1024
    v_mfma_f32_16x16x32_bf16 v[128:131], v[212:215], a[16:19], v[128:131]
    buffer_load_dwordx4 a[92:95], v15, s[4:7], s91 offen offset:2304
    v_mfma_f32_16x16x32_bf16 v[132:135], v[208:211], a[4:7], v[132:135]
    s_add_u32 s91, s91, 8192
    s_add_u32 m0, s53, 0x18000
    v_mfma_f32_16x16x32_bf16 v[132:135], v[212:215], a[20:23], v[132:135]
    s_add_u32 s52, s36, 2392064
    s_add_u32 s38, s36, 2455552
    v_mfma_f32_16x16x32_bf16 v[136:139], v[208:211], a[8:11], v[136:139]
    ds_read_b64_tr_b16 v[194:195], v244 offset:9216
    v_mfma_f32_16x16x32_bf16 v[136:139], v[212:215], a[24:27], v[136:139]
    buffer_load_dwordx4 v11, s[20:23], s52 offen offset:0 lds
    v_mfma_f32_16x16x32_bf16 v[140:143], v[208:211], a[12:15], v[140:143]
    ds_read_b64_tr_b16 v[196:197], v244 offset:3072
    v_mfma_f32_16x16x32_bf16 v[140:143], v[212:215], a[28:31], v[140:143]
    ds_read_b64_tr_b16 v[198:199], v244 offset:11264
    v_mfma_f32_16x16x32_bf16 v[156:159], v[216:219], a[12:15], v[156:159]
    ds_read_b64_tr_b16 v[200:201], v245 offset:1024
    v_mfma_f32_16x16x32_bf16 v[156:159], v[220:223], a[28:31], v[156:159]
    ds_read_b64_tr_b16 v[202:203], v245 offset:9216
    v_mfma_f32_16x16x32_bf16 v[152:155], v[216:219], a[8:11], v[152:155]
    ds_read_b64_tr_b16 v[204:205], v245 offset:3072
    v_mfma_f32_16x16x32_bf16 v[152:155], v[220:223], a[24:27], v[152:155]
    ds_read_b64_tr_b16 v[206:207], v245 offset:11264
    v_mfma_f32_16x16x32_bf16 v[148:151], v[216:219], a[4:7], v[148:151]
    v_mfma_f32_16x16x32_bf16 v[148:151], v[220:223], a[20:23], v[148:151]
    buffer_load_dwordx4 v12, s[20:23], s52 offen offset:1024 lds
    v_mfma_f32_16x16x32_bf16 v[144:147], v[216:219], a[0:3], v[144:147]
    v_mfma_f32_16x16x32_bf16 v[144:147], v[220:223], a[16:19], v[144:147]
    s_waitcnt vmcnt(18) lgkmcnt(12)
    v_mfma_f32_16x16x32_bf16 v[32:35], v[160:163], a[32:35], v[32:35]
    ds_read_b64_tr_b16 v[208:209], v246 offset:1024
    v_mfma_f32_16x16x32_bf16 v[32:35], v[164:167], a[48:51], v[32:35]
    buffer_load_dwordx4 v11, s[20:23], s38 offen offset:2048 lds
    v_mfma_f32_16x16x32_bf16 v[36:39], v[160:163], a[36:39], v[36:39]
    ds_read_b64_tr_b16 v[210:211], v246 offset:9216
    v_mfma_f32_16x16x32_bf16 v[36:39], v[164:167], a[52:55], v[36:39]
    ds_read_b64_tr_b16 v[212:213], v246 offset:3072
    v_mfma_f32_16x16x32_bf16 v[40:43], v[160:163], a[40:43], v[40:43]
    ds_read_b64_tr_b16 v[214:215], v246 offset:11264
    v_mfma_f32_16x16x32_bf16 v[40:43], v[164:167], a[56:59], v[40:43]
    buffer_load_dwordx4 v12, s[20:23], s38 offen offset:3072 lds
    v_mfma_f32_16x16x32_bf16 v[44:47], v[160:163], a[44:47], v[44:47]
    v_mfma_f32_16x16x32_bf16 v[44:47], v[164:167], a[60:63], v[44:47]
    v_mfma_f32_16x16x32_bf16 v[60:63], v[168:171], a[44:47], v[60:63]
    s_add_u32 m0, s53, 0x1c000
    s_add_u32 s52, s36, 2621440
    v_mfma_f32_16x16x32_bf16 v[60:63], v[172:175], a[60:63], v[60:63]
    s_add_u32 s38, s36, 2684928
    v_mfma_f32_16x16x32_bf16 v[56:59], v[168:171], a[40:43], v[56:59]
    ds_read_b64_tr_b16 v[216:217], v247 offset:1024
    v_mfma_f32_16x16x32_bf16 v[56:59], v[172:175], a[56:59], v[56:59]
    ds_read_b64_tr_b16 v[218:219], v247 offset:9216
    v_mfma_f32_16x16x32_bf16 v[52:55], v[168:171], a[36:39], v[52:55]
    ds_read_b64_tr_b16 v[220:221], v247 offset:3072
    v_mfma_f32_16x16x32_bf16 v[52:55], v[172:175], a[52:55], v[52:55]
    buffer_load_dwordx4 v11, s[20:23], s52 offen offset:0 lds
    v_mfma_f32_16x16x32_bf16 v[48:51], v[168:171], a[32:35], v[48:51]
    ds_read_b64_tr_b16 v[222:223], v247 offset:11264
    v_mfma_f32_16x16x32_bf16 v[48:51], v[172:175], a[48:51], v[48:51]
    s_waitcnt vmcnt(13) lgkmcnt(0)
    s_barrier
    v_mfma_f32_16x16x32_bf16 v[64:67], v[176:179], a[32:35], v[64:67]
    ds_read_b64_tr_b16 v[160:161], v7 offset:0
    v_mfma_f32_16x16x32_bf16 v[64:67], v[180:183], a[48:51], v[64:67]
    buffer_load_dwordx4 v12, s[20:23], s52 offen offset:1024 lds
    v_mfma_f32_16x16x32_bf16 v[68:71], v[176:179], a[36:39], v[68:71]
    ds_read_b64_tr_b16 v[162:163], v7 offset:8192
    v_mfma_f32_16x16x32_bf16 v[68:71], v[180:183], a[52:55], v[68:71]
    ds_read_b64_tr_b16 v[164:165], v7 offset:2048
    v_mfma_f32_16x16x32_bf16 v[72:75], v[176:179], a[40:43], v[72:75]
    ds_read_b64_tr_b16 v[166:167], v7 offset:10240
    v_mfma_f32_16x16x32_bf16 v[72:75], v[180:183], a[56:59], v[72:75]
    buffer_load_dwordx4 v11, s[20:23], s38 offen offset:2048 lds
    v_mfma_f32_16x16x32_bf16 v[76:79], v[176:179], a[44:47], v[76:79]
    v_mfma_f32_16x16x32_bf16 v[76:79], v[180:183], a[60:63], v[76:79]
    v_mfma_f32_16x16x32_bf16 v[92:95], v[184:187], a[44:47], v[92:95]
    ds_read_b64_tr_b16 v[168:169], v8 offset:0
    v_mfma_f32_16x16x32_bf16 v[92:95], v[188:191], a[60:63], v[92:95]
    buffer_load_dwordx4 v12, s[20:23], s38 offen offset:3072 lds
    v_mfma_f32_16x16x32_bf16 v[88:91], v[184:187], a[40:43], v[88:91]
    ds_read_b64_tr_b16 v[170:171], v8 offset:8192
    v_mfma_f32_16x16x32_bf16 v[88:91], v[188:191], a[56:59], v[88:91]
    ds_read_b64_tr_b16 v[172:173], v8 offset:2048
    v_mfma_f32_16x16x32_bf16 v[84:87], v[184:187], a[36:39], v[84:87]
    ds_read_b64_tr_b16 v[174:175], v8 offset:10240
    v_mfma_f32_16x16x32_bf16 v[84:87], v[188:191], a[52:55], v[84:87]
    buffer_load_dwordx4 a[96:99], v15, s[4:7], s51 offen offset:0
    v_mfma_f32_16x16x32_bf16 v[80:83], v[184:187], a[32:35], v[80:83]
    v_mfma_f32_16x16x32_bf16 v[80:83], v[188:191], a[48:51], v[80:83]
    v_mfma_f32_16x16x32_bf16 v[96:99], v[192:195], a[32:35], v[96:99]
    ds_read_b64_tr_b16 v[176:177], v9 offset:0
    v_mfma_f32_16x16x32_bf16 v[96:99], v[196:199], a[48:51], v[96:99]
    buffer_load_dwordx4 a[100:103], v15, s[4:7], s51 offen offset:256
    v_mfma_f32_16x16x32_bf16 v[100:103], v[192:195], a[36:39], v[100:103]
    ds_read_b64_tr_b16 v[178:179], v9 offset:8192
    v_mfma_f32_16x16x32_bf16 v[100:103], v[196:199], a[52:55], v[100:103]
    ds_read_b64_tr_b16 v[180:181], v9 offset:2048
    v_mfma_f32_16x16x32_bf16 v[104:107], v[192:195], a[40:43], v[104:107]
    ds_read_b64_tr_b16 v[182:183], v9 offset:10240
    v_mfma_f32_16x16x32_bf16 v[104:107], v[196:199], a[56:59], v[104:107]
    buffer_load_dwordx4 a[112:115], v15, s[4:7], s51 offen offset:2048
    v_mfma_f32_16x16x32_bf16 v[108:111], v[192:195], a[44:47], v[108:111]
    v_mfma_f32_16x16x32_bf16 v[108:111], v[196:199], a[60:63], v[108:111]
    v_mfma_f32_16x16x32_bf16 v[124:127], v[200:203], a[44:47], v[124:127]
    ds_read_b64_tr_b16 v[184:185], v10 offset:0
    v_mfma_f32_16x16x32_bf16 v[124:127], v[204:207], a[60:63], v[124:127]
    buffer_load_dwordx4 a[116:119], v15, s[4:7], s51 offen offset:2304
    v_mfma_f32_16x16x32_bf16 v[120:123], v[200:203], a[40:43], v[120:123]
    s_add_u32 s51, s51, 8192
    v_mfma_f32_16x16x32_bf16 v[120:123], v[204:207], a[56:59], v[120:123]
    ds_read_b64_tr_b16 v[186:187], v10 offset:8192
    v_mfma_f32_16x16x32_bf16 v[116:119], v[200:203], a[36:39], v[116:119]
    ds_read_b64_tr_b16 v[188:189], v10 offset:2048
    v_mfma_f32_16x16x32_bf16 v[116:119], v[204:207], a[52:55], v[116:119]
    buffer_load_dwordx4 a[104:107], v15, s[4:7], s91 offen offset:0
    v_mfma_f32_16x16x32_bf16 v[112:115], v[200:203], a[32:35], v[112:115]
    ds_read_b64_tr_b16 v[190:191], v10 offset:10240
    v_mfma_f32_16x16x32_bf16 v[112:115], v[204:207], a[48:51], v[112:115]
    v_mfma_f32_16x16x32_bf16 v[128:131], v[208:211], a[32:35], v[128:131]
    ds_read_b64_tr_b16 v[192:193], v7 offset:1024
    v_mfma_f32_16x16x32_bf16 v[128:131], v[212:215], a[48:51], v[128:131]
    buffer_load_dwordx4 a[108:111], v15, s[4:7], s91 offen offset:256
    v_mfma_f32_16x16x32_bf16 v[132:135], v[208:211], a[36:39], v[132:135]
    ds_read_b64_tr_b16 v[194:195], v7 offset:9216
    v_mfma_f32_16x16x32_bf16 v[132:135], v[212:215], a[52:55], v[132:135]
    ds_read_b64_tr_b16 v[196:197], v7 offset:3072
    v_mfma_f32_16x16x32_bf16 v[136:139], v[208:211], a[40:43], v[136:139]
    ds_read_b64_tr_b16 v[198:199], v7 offset:11264
    v_mfma_f32_16x16x32_bf16 v[136:139], v[212:215], a[56:59], v[136:139]
    buffer_load_dwordx4 a[120:123], v15, s[4:7], s91 offen offset:2048
    v_mfma_f32_16x16x32_bf16 v[140:143], v[208:211], a[44:47], v[140:143]
    v_mfma_f32_16x16x32_bf16 v[140:143], v[212:215], a[60:63], v[140:143]
    v_mfma_f32_16x16x32_bf16 v[156:159], v[216:219], a[44:47], v[156:159]
    ds_read_b64_tr_b16 v[200:201], v8 offset:1024
    v_mfma_f32_16x16x32_bf16 v[156:159], v[220:223], a[60:63], v[156:159]
    buffer_load_dwordx4 a[124:127], v15, s[4:7], s91 offen offset:2304
    v_mfma_f32_16x16x32_bf16 v[152:155], v[216:219], a[40:43], v[152:155]
    s_add_u32 s91, s91, 8192
    s_add_u32 m0, s53, 0x8000
    v_mfma_f32_16x16x32_bf16 v[152:155], v[220:223], a[56:59], v[152:155]
    s_add_u32 s52, s36, 2850816
    s_add_u32 s38, s36, 2914304
    v_mfma_f32_16x16x32_bf16 v[148:151], v[216:219], a[36:39], v[148:151]
    ds_read_b64_tr_b16 v[202:203], v8 offset:9216
    v_mfma_f32_16x16x32_bf16 v[148:151], v[220:223], a[52:55], v[148:151]
    buffer_load_dwordx4 v11, s[20:23], s52 offen offset:0 lds
    v_mfma_f32_16x16x32_bf16 v[144:147], v[216:219], a[32:35], v[144:147]
    ds_read_b64_tr_b16 v[204:205], v8 offset:3072
    v_mfma_f32_16x16x32_bf16 v[144:147], v[220:223], a[48:51], v[144:147]
    ds_read_b64_tr_b16 v[206:207], v8 offset:11264
    s_waitcnt vmcnt(17) lgkmcnt(12)
    v_mfma_f32_16x16x32_bf16 v[32:35], v[160:163], a[64:67], v[32:35]
    ds_read_b64_tr_b16 v[208:209], v9 offset:1024
    v_mfma_f32_16x16x32_bf16 v[32:35], v[164:167], a[80:83], v[32:35]
    ds_read_b64_tr_b16 v[210:211], v9 offset:9216
    v_mfma_f32_16x16x32_bf16 v[36:39], v[160:163], a[68:71], v[36:39]
    ds_read_b64_tr_b16 v[212:213], v9 offset:3072
    v_mfma_f32_16x16x32_bf16 v[36:39], v[164:167], a[84:87], v[36:39]
    ds_read_b64_tr_b16 v[214:215], v9 offset:11264
    v_mfma_f32_16x16x32_bf16 v[40:43], v[160:163], a[72:75], v[40:43]
    v_mfma_f32_16x16x32_bf16 v[40:43], v[164:167], a[88:91], v[40:43]
    buffer_load_dwordx4 v12, s[20:23], s52 offen offset:1024 lds
    v_mfma_f32_16x16x32_bf16 v[44:47], v[160:163], a[76:79], v[44:47]
    v_mfma_f32_16x16x32_bf16 v[44:47], v[164:167], a[92:95], v[44:47]
    v_mfma_f32_16x16x32_bf16 v[60:63], v[168:171], a[76:79], v[60:63]
    ds_read_b64_tr_b16 v[216:217], v10 offset:1024
    v_mfma_f32_16x16x32_bf16 v[60:63], v[172:175], a[92:95], v[60:63]
    buffer_load_dwordx4 v11, s[20:23], s38 offen offset:2048 lds
    v_mfma_f32_16x16x32_bf16 v[56:59], v[168:171], a[72:75], v[56:59]
    ds_read_b64_tr_b16 v[218:219], v10 offset:9216
    v_mfma_f32_16x16x32_bf16 v[56:59], v[172:175], a[88:91], v[56:59]
    ds_read_b64_tr_b16 v[220:221], v10 offset:3072
    v_mfma_f32_16x16x32_bf16 v[52:55], v[168:171], a[68:71], v[52:55]
    ds_read_b64_tr_b16 v[222:223], v10 offset:11264
    v_mfma_f32_16x16x32_bf16 v[52:55], v[172:175], a[84:87], v[52:55]
    buffer_load_dwordx4 v12, s[20:23], s38 offen offset:3072 lds
    v_mfma_f32_16x16x32_bf16 v[48:51], v[168:171], a[64:67], v[48:51]
    v_mfma_f32_16x16x32_bf16 v[48:51], v[172:175], a[80:83], v[48:51]
    s_waitcnt vmcnt(12) lgkmcnt(0)
    s_barrier
    v_mfma_f32_16x16x32_bf16 v[64:67], v[176:179], a[64:67], v[64:67]
    s_add_u32 m0, s53, 0xc000
    s_add_u32 s52, s36, 3080192
    v_mfma_f32_16x16x32_bf16 v[64:67], v[180:183], a[80:83], v[64:67]
    s_add_u32 s38, s36, 3143680
    v_mfma_f32_16x16x32_bf16 v[68:71], v[176:179], a[68:71], v[68:71]
    ds_read_b64_tr_b16 v[160:161], v7 offset:32768
    v_mfma_f32_16x16x32_bf16 v[68:71], v[180:183], a[84:87], v[68:71]
    ds_read_b64_tr_b16 v[162:163], v7 offset:40960
    v_mfma_f32_16x16x32_bf16 v[72:75], v[176:179], a[72:75], v[72:75]
    ds_read_b64_tr_b16 v[164:165], v7 offset:34816
    v_mfma_f32_16x16x32_bf16 v[72:75], v[180:183], a[88:91], v[72:75]
    buffer_load_dwordx4 v11, s[20:23], s52 offen offset:0 lds
    v_mfma_f32_16x16x32_bf16 v[76:79], v[176:179], a[76:79], v[76:79]
    ds_read_b64_tr_b16 v[166:167], v7 offset:43008
    v_mfma_f32_16x16x32_bf16 v[76:79], v[180:183], a[92:95], v[76:79]
    v_mfma_f32_16x16x32_bf16 v[92:95], v[184:187], a[76:79], v[92:95]
    ds_read_b64_tr_b16 v[168:169], v8 offset:32768
    v_mfma_f32_16x16x32_bf16 v[92:95], v[188:191], a[92:95], v[92:95]
    buffer_load_dwordx4 v12, s[20:23], s52 offen offset:1024 lds
    v_mfma_f32_16x16x32_bf16 v[88:91], v[184:187], a[72:75], v[88:91]
    ds_read_b64_tr_b16 v[170:171], v8 offset:40960
    v_mfma_f32_16x16x32_bf16 v[88:91], v[188:191], a[88:91], v[88:91]
    ds_read_b64_tr_b16 v[172:173], v8 offset:34816
    v_mfma_f32_16x16x32_bf16 v[84:87], v[184:187], a[68:71], v[84:87]
    ds_read_b64_tr_b16 v[174:175], v8 offset:43008
    v_mfma_f32_16x16x32_bf16 v[84:87], v[188:191], a[84:87], v[84:87]
    buffer_load_dwordx4 v11, s[20:23], s38 offen offset:2048 lds
    v_mfma_f32_16x16x32_bf16 v[80:83], v[184:187], a[64:67], v[80:83]
    v_mfma_f32_16x16x32_bf16 v[80:83], v[188:191], a[80:83], v[80:83]
    v_mfma_f32_16x16x32_bf16 v[96:99], v[192:195], a[64:67], v[96:99]
    ds_read_b64_tr_b16 v[176:177], v9 offset:32768
    v_mfma_f32_16x16x32_bf16 v[96:99], v[196:199], a[80:83], v[96:99]
    buffer_load_dwordx4 v12, s[20:23], s38 offen offset:3072 lds
    v_mfma_f32_16x16x32_bf16 v[100:103], v[192:195], a[68:71], v[100:103]
    ds_read_b64_tr_b16 v[178:179], v9 offset:40960
    v_mfma_f32_16x16x32_bf16 v[100:103], v[196:199], a[84:87], v[100:103]
    ds_read_b64_tr_b16 v[180:181], v9 offset:34816
    v_mfma_f32_16x16x32_bf16 v[104:107], v[192:195], a[72:75], v[104:107]
    ds_read_b64_tr_b16 v[182:183], v9 offset:43008
    v_mfma_f32_16x16x32_bf16 v[104:107], v[196:199], a[88:91], v[104:107]
    buffer_load_dwordx4 a[0:3], v15, s[4:7], s51 offen offset:0
    v_mfma_f32_16x16x32_bf16 v[108:111], v[192:195], a[76:79], v[108:111]
    v_mfma_f32_16x16x32_bf16 v[108:111], v[196:199], a[92:95], v[108:111]
    v_mfma_f32_16x16x32_bf16 v[124:127], v[200:203], a[76:79], v[124:127]
    ds_read_b64_tr_b16 v[184:185], v10 offset:32768
    v_mfma_f32_16x16x32_bf16 v[124:127], v[204:207], a[92:95], v[124:127]
    buffer_load_dwordx4 a[4:7], v15, s[4:7], s51 offen offset:256
    v_mfma_f32_16x16x32_bf16 v[120:123], v[200:203], a[72:75], v[120:123]
    ds_read_b64_tr_b16 v[186:187], v10 offset:40960
    v_mfma_f32_16x16x32_bf16 v[120:123], v[204:207], a[88:91], v[120:123]
    ds_read_b64_tr_b16 v[188:189], v10 offset:34816
    v_mfma_f32_16x16x32_bf16 v[116:119], v[200:203], a[68:71], v[116:119]
    ds_read_b64_tr_b16 v[190:191], v10 offset:43008
    v_mfma_f32_16x16x32_bf16 v[116:119], v[204:207], a[84:87], v[116:119]
    buffer_load_dwordx4 a[16:19], v15, s[4:7], s51 offen offset:2048
    v_mfma_f32_16x16x32_bf16 v[112:115], v[200:203], a[64:67], v[112:115]
    v_mfma_f32_16x16x32_bf16 v[112:115], v[204:207], a[80:83], v[112:115]
    v_mfma_f32_16x16x32_bf16 v[128:131], v[208:211], a[64:67], v[128:131]
    ds_read_b64_tr_b16 v[192:193], v7 offset:33792
    v_mfma_f32_16x16x32_bf16 v[128:131], v[212:215], a[80:83], v[128:131]
    buffer_load_dwordx4 a[20:23], v15, s[4:7], s51 offen offset:2304
    v_mfma_f32_16x16x32_bf16 v[132:135], v[208:211], a[68:71], v[132:135]
    s_add_u32 s51, s51, 8192
    v_mfma_f32_16x16x32_bf16 v[132:135], v[212:215], a[84:87], v[132:135]
    ds_read_b64_tr_b16 v[194:195], v7 offset:41984
    v_mfma_f32_16x16x32_bf16 v[136:139], v[208:211], a[72:75], v[136:139]
    ds_read_b64_tr_b16 v[196:197], v7 offset:35840
    v_mfma_f32_16x16x32_bf16 v[136:139], v[212:215], a[88:91], v[136:139]
    buffer_load_dwordx4 a[8:11], v15, s[4:7], s91 offen offset:0
    v_mfma_f32_16x16x32_bf16 v[140:143], v[208:211], a[76:79], v[140:143]
    ds_read_b64_tr_b16 v[198:199], v7 offset:44032
    v_mfma_f32_16x16x32_bf16 v[140:143], v[212:215], a[92:95], v[140:143]
    v_mfma_f32_16x16x32_bf16 v[156:159], v[216:219], a[76:79], v[156:159]
    ds_read_b64_tr_b16 v[200:201], v8 offset:33792
    v_mfma_f32_16x16x32_bf16 v[156:159], v[220:223], a[92:95], v[156:159]
    buffer_load_dwordx4 a[12:15], v15, s[4:7], s91 offen offset:256
    v_mfma_f32_16x16x32_bf16 v[152:155], v[216:219], a[72:75], v[152:155]
    ds_read_b64_tr_b16 v[202:203], v8 offset:41984
    v_mfma_f32_16x16x32_bf16 v[152:155], v[220:223], a[88:91], v[152:155]
    ds_read_b64_tr_b16 v[204:205], v8 offset:35840
    v_mfma_f32_16x16x32_bf16 v[148:151], v[216:219], a[68:71], v[148:151]
    ds_read_b64_tr_b16 v[206:207], v8 offset:44032
    v_mfma_f32_16x16x32_bf16 v[148:151], v[220:223], a[84:87], v[148:151]
    buffer_load_dwordx4 a[24:27], v15, s[4:7], s91 offen offset:2048
    v_mfma_f32_16x16x32_bf16 v[144:147], v[216:219], a[64:67], v[144:147]
    v_mfma_f32_16x16x32_bf16 v[144:147], v[220:223], a[80:83], v[144:147]
    s_waitcnt vmcnt(15) lgkmcnt(12)
    v_mfma_f32_16x16x32_bf16 v[32:35], v[160:163], a[96:99], v[32:35]
    ds_read_b64_tr_b16 v[208:209], v9 offset:33792
    v_mfma_f32_16x16x32_bf16 v[32:35], v[164:167], a[112:115], v[32:35]
    buffer_load_dwordx4 a[28:31], v15, s[4:7], s91 offen offset:2304
    v_mfma_f32_16x16x32_bf16 v[36:39], v[160:163], a[100:103], v[36:39]
    s_add_u32 s91, s91, 8192
    s_add_u32 m0, s53, 0x0
    v_mfma_f32_16x16x32_bf16 v[36:39], v[164:167], a[116:119], v[36:39]
    s_add_u32 s52, s36, 3309568
    s_add_u32 s38, s36, 3373056
    v_mfma_f32_16x16x32_bf16 v[40:43], v[160:163], a[104:107], v[40:43]
    ds_read_b64_tr_b16 v[210:211], v9 offset:41984
    v_mfma_f32_16x16x32_bf16 v[40:43], v[164:167], a[120:123], v[40:43]
    buffer_load_dwordx4 v11, s[20:23], s52 offen offset:0 lds
    v_mfma_f32_16x16x32_bf16 v[44:47], v[160:163], a[108:111], v[44:47]
    ds_read_b64_tr_b16 v[212:213], v9 offset:35840
    v_mfma_f32_16x16x32_bf16 v[44:47], v[164:167], a[124:127], v[44:47]
    ds_read_b64_tr_b16 v[214:215], v9 offset:44032
    v_mfma_f32_16x16x32_bf16 v[60:63], v[168:171], a[108:111], v[60:63]
    ds_read_b64_tr_b16 v[216:217], v10 offset:33792
    v_mfma_f32_16x16x32_bf16 v[60:63], v[172:175], a[124:127], v[60:63]
    ds_read_b64_tr_b16 v[218:219], v10 offset:41984
    v_mfma_f32_16x16x32_bf16 v[56:59], v[168:171], a[104:107], v[56:59]
    ds_read_b64_tr_b16 v[220:221], v10 offset:35840
    v_mfma_f32_16x16x32_bf16 v[56:59], v[172:175], a[120:123], v[56:59]
    ds_read_b64_tr_b16 v[222:223], v10 offset:44032
    v_mfma_f32_16x16x32_bf16 v[52:55], v[168:171], a[100:103], v[52:55]
    v_mfma_f32_16x16x32_bf16 v[52:55], v[172:175], a[116:119], v[52:55]
    buffer_load_dwordx4 v12, s[20:23], s52 offen offset:1024 lds
    v_mfma_f32_16x16x32_bf16 v[48:51], v[168:171], a[96:99], v[48:51]
    v_mfma_f32_16x16x32_bf16 v[48:51], v[172:175], a[112:115], v[48:51]
    s_waitcnt vmcnt(10) lgkmcnt(0)
    s_barrier
    v_mfma_f32_16x16x32_bf16 v[64:67], v[176:179], a[96:99], v[64:67]
    ds_read_b64_tr_b16 v[160:161], v232 offset:32768
    v_mfma_f32_16x16x32_bf16 v[64:67], v[180:183], a[112:115], v[64:67]
    buffer_load_dwordx4 v11, s[20:23], s38 offen offset:2048 lds
    v_mfma_f32_16x16x32_bf16 v[68:71], v[176:179], a[100:103], v[68:71]
    ds_read_b64_tr_b16 v[162:163], v232 offset:40960
    v_mfma_f32_16x16x32_bf16 v[68:71], v[180:183], a[116:119], v[68:71]
    ds_read_b64_tr_b16 v[164:165], v232 offset:34816
    v_mfma_f32_16x16x32_bf16 v[72:75], v[176:179], a[104:107], v[72:75]
    ds_read_b64_tr_b16 v[166:167], v232 offset:43008
    v_mfma_f32_16x16x32_bf16 v[72:75], v[180:183], a[120:123], v[72:75]
    buffer_load_dwordx4 v12, s[20:23], s38 offen offset:3072 lds
    v_mfma_f32_16x16x32_bf16 v[76:79], v[176:179], a[108:111], v[76:79]
    v_mfma_f32_16x16x32_bf16 v[76:79], v[180:183], a[124:127], v[76:79]
    v_mfma_f32_16x16x32_bf16 v[92:95], v[184:187], a[108:111], v[92:95]
    s_add_u32 m0, s53, 0x4000
    s_add_u32 s52, s36, 3538944
    v_mfma_f32_16x16x32_bf16 v[92:95], v[188:191], a[124:127], v[92:95]
    s_add_u32 s38, s36, 3602432
    v_mfma_f32_16x16x32_bf16 v[88:91], v[184:187], a[104:107], v[88:91]
    ds_read_b64_tr_b16 v[168:169], v233 offset:32768
    v_mfma_f32_16x16x32_bf16 v[88:91], v[188:191], a[120:123], v[88:91]
    ds_read_b64_tr_b16 v[170:171], v233 offset:40960
    v_mfma_f32_16x16x32_bf16 v[84:87], v[184:187], a[100:103], v[84:87]
    ds_read_b64_tr_b16 v[172:173], v233 offset:34816
    v_mfma_f32_16x16x32_bf16 v[84:87], v[188:191], a[116:119], v[84:87]
    buffer_load_dwordx4 v11, s[20:23], s52 offen offset:0 lds
    v_mfma_f32_16x16x32_bf16 v[80:83], v[184:187], a[96:99], v[80:83]
    ds_read_b64_tr_b16 v[174:175], v233 offset:43008
    v_mfma_f32_16x16x32_bf16 v[80:83], v[188:191], a[112:115], v[80:83]
    v_mfma_f32_16x16x32_bf16 v[96:99], v[192:195], a[96:99], v[96:99]
    ds_read_b64_tr_b16 v[176:177], v234 offset:32768
    v_mfma_f32_16x16x32_bf16 v[96:99], v[196:199], a[112:115], v[96:99]
    buffer_load_dwordx4 v12, s[20:23], s52 offen offset:1024 lds
    v_mfma_f32_16x16x32_bf16 v[100:103], v[192:195], a[100:103], v[100:103]
    ds_read_b64_tr_b16 v[178:179], v234 offset:40960
    v_mfma_f32_16x16x32_bf16 v[100:103], v[196:199], a[116:119], v[100:103]
    ds_read_b64_tr_b16 v[180:181], v234 offset:34816
    v_mfma_f32_16x16x32_bf16 v[104:107], v[192:195], a[104:107], v[104:107]
    ds_read_b64_tr_b16 v[182:183], v234 offset:43008
    v_mfma_f32_16x16x32_bf16 v[104:107], v[196:199], a[120:123], v[104:107]
    buffer_load_dwordx4 v11, s[20:23], s38 offen offset:2048 lds
    v_mfma_f32_16x16x32_bf16 v[108:111], v[192:195], a[108:111], v[108:111]
    v_mfma_f32_16x16x32_bf16 v[108:111], v[196:199], a[124:127], v[108:111]
    v_mfma_f32_16x16x32_bf16 v[124:127], v[200:203], a[108:111], v[124:127]
    ds_read_b64_tr_b16 v[184:185], v235 offset:32768
    v_mfma_f32_16x16x32_bf16 v[124:127], v[204:207], a[124:127], v[124:127]
    buffer_load_dwordx4 v12, s[20:23], s38 offen offset:3072 lds
    v_mfma_f32_16x16x32_bf16 v[120:123], v[200:203], a[104:107], v[120:123]
    ds_read_b64_tr_b16 v[186:187], v235 offset:40960
    v_mfma_f32_16x16x32_bf16 v[120:123], v[204:207], a[120:123], v[120:123]
    ds_read_b64_tr_b16 v[188:189], v235 offset:34816
    v_mfma_f32_16x16x32_bf16 v[116:119], v[200:203], a[100:103], v[116:119]
    ds_read_b64_tr_b16 v[190:191], v235 offset:43008
    v_mfma_f32_16x16x32_bf16 v[116:119], v[204:207], a[116:119], v[116:119]
    buffer_load_dwordx4 a[32:35], v15, s[4:7], s51 offen offset:0
    v_mfma_f32_16x16x32_bf16 v[112:115], v[200:203], a[96:99], v[112:115]
    v_mfma_f32_16x16x32_bf16 v[112:115], v[204:207], a[112:115], v[112:115]
    v_mfma_f32_16x16x32_bf16 v[128:131], v[208:211], a[96:99], v[128:131]
    ds_read_b64_tr_b16 v[192:193], v232 offset:33792
    v_mfma_f32_16x16x32_bf16 v[128:131], v[212:215], a[112:115], v[128:131]
    buffer_load_dwordx4 a[36:39], v15, s[4:7], s51 offen offset:256
    v_mfma_f32_16x16x32_bf16 v[132:135], v[208:211], a[100:103], v[132:135]
    ds_read_b64_tr_b16 v[194:195], v232 offset:41984
    v_mfma_f32_16x16x32_bf16 v[132:135], v[212:215], a[116:119], v[132:135]
    ds_read_b64_tr_b16 v[196:197], v232 offset:35840
    v_mfma_f32_16x16x32_bf16 v[136:139], v[208:211], a[104:107], v[136:139]
    ds_read_b64_tr_b16 v[198:199], v232 offset:44032
    v_mfma_f32_16x16x32_bf16 v[136:139], v[212:215], a[120:123], v[136:139]
    buffer_load_dwordx4 a[48:51], v15, s[4:7], s51 offen offset:2048
    v_mfma_f32_16x16x32_bf16 v[140:143], v[208:211], a[108:111], v[140:143]
    v_mfma_f32_16x16x32_bf16 v[140:143], v[212:215], a[124:127], v[140:143]
    v_mfma_f32_16x16x32_bf16 v[156:159], v[216:219], a[108:111], v[156:159]
    ds_read_b64_tr_b16 v[200:201], v233 offset:33792
    v_mfma_f32_16x16x32_bf16 v[156:159], v[220:223], a[124:127], v[156:159]
    buffer_load_dwordx4 a[52:55], v15, s[4:7], s51 offen offset:2304
    v_mfma_f32_16x16x32_bf16 v[152:155], v[216:219], a[104:107], v[152:155]
    s_add_u32 s51, s51, 8192
    v_mfma_f32_16x16x32_bf16 v[152:155], v[220:223], a[120:123], v[152:155]
    ds_read_b64_tr_b16 v[202:203], v233 offset:41984
    v_mfma_f32_16x16x32_bf16 v[148:151], v[216:219], a[100:103], v[148:151]
    ds_read_b64_tr_b16 v[204:205], v233 offset:35840
    v_mfma_f32_16x16x32_bf16 v[148:151], v[220:223], a[116:119], v[148:151]
    buffer_load_dwordx4 a[40:43], v15, s[4:7], s91 offen offset:0
    v_mfma_f32_16x16x32_bf16 v[144:147], v[216:219], a[96:99], v[144:147]
    ds_read_b64_tr_b16 v[206:207], v233 offset:44032
    v_mfma_f32_16x16x32_bf16 v[144:147], v[220:223], a[112:115], v[144:147]
    s_waitcnt vmcnt(13) lgkmcnt(12)
    v_mfma_f32_16x16x32_bf16 v[32:35], v[160:163], a[0:3], v[32:35]
    ds_read_b64_tr_b16 v[208:209], v234 offset:33792
    v_mfma_f32_16x16x32_bf16 v[32:35], v[164:167], a[16:19], v[32:35]
    buffer_load_dwordx4 a[44:47], v15, s[4:7], s91 offen offset:256
    v_mfma_f32_16x16x32_bf16 v[36:39], v[160:163], a[4:7], v[36:39]
    ds_read_b64_tr_b16 v[210:211], v234 offset:41984
    v_mfma_f32_16x16x32_bf16 v[36:39], v[164:167], a[20:23], v[36:39]
    ds_read_b64_tr_b16 v[212:213], v234 offset:35840
    v_mfma_f32_16x16x32_bf16 v[40:43], v[160:163], a[8:11], v[40:43]
    ds_read_b64_tr_b16 v[214:215], v234 offset:44032
    v_mfma_f32_16x16x32_bf16 v[40:43], v[164:167], a[24:27], v[40:43]
    buffer_load_dwordx4 a[56:59], v15, s[4:7], s91 offen offset:2048
    v_mfma_f32_16x16x32_bf16 v[44:47], v[160:163], a[12:15], v[44:47]
    v_mfma_f32_16x16x32_bf16 v[44:47], v[164:167], a[28:31], v[44:47]
    v_mfma_f32_16x16x32_bf16 v[60:63], v[168:171], a[12:15], v[60:63]
    ds_read_b64_tr_b16 v[216:217], v235 offset:33792
    v_mfma_f32_16x16x32_bf16 v[60:63], v[172:175], a[28:31], v[60:63]
    buffer_load_dwordx4 a[60:63], v15, s[4:7], s91 offen offset:2304
    v_mfma_f32_16x16x32_bf16 v[56:59], v[168:171], a[8:11], v[56:59]
    s_add_u32 s91, s91, 8192
    v_mfma_f32_16x16x32_bf16 v[56:59], v[172:175], a[24:27], v[56:59]
    ds_read_b64_tr_b16 v[218:219], v235 offset:41984
    v_mfma_f32_16x16x32_bf16 v[52:55], v[168:171], a[4:7], v[52:55]
    ds_read_b64_tr_b16 v[220:221], v235 offset:35840
    v_mfma_f32_16x16x32_bf16 v[52:55], v[172:175], a[20:23], v[52:55]
    ds_read_b64_tr_b16 v[222:223], v235 offset:44032
    v_mfma_f32_16x16x32_bf16 v[48:51], v[168:171], a[0:3], v[48:51]
    v_mfma_f32_16x16x32_bf16 v[48:51], v[172:175], a[16:19], v[48:51]
    s_waitcnt vmcnt(8) lgkmcnt(0)
    s_barrier
    v_mfma_f32_16x16x32_bf16 v[64:67], v[176:179], a[0:3], v[64:67]
    ds_read_b64_tr_b16 v[160:161], v232 offset:0
    v_mfma_f32_16x16x32_bf16 v[64:67], v[180:183], a[16:19], v[64:67]
    ds_read_b64_tr_b16 v[162:163], v232 offset:8192
    v_mfma_f32_16x16x32_bf16 v[68:71], v[176:179], a[4:7], v[68:71]
    ds_read_b64_tr_b16 v[164:165], v232 offset:2048
    v_mfma_f32_16x16x32_bf16 v[68:71], v[180:183], a[20:23], v[68:71]
    ds_read_b64_tr_b16 v[166:167], v232 offset:10240
    v_mfma_f32_16x16x32_bf16 v[72:75], v[176:179], a[8:11], v[72:75]
    v_mfma_f32_16x16x32_bf16 v[72:75], v[180:183], a[24:27], v[72:75]
    v_mfma_f32_16x16x32_bf16 v[76:79], v[176:179], a[12:15], v[76:79]
    v_mfma_f32_16x16x32_bf16 v[76:79], v[180:183], a[28:31], v[76:79]
    v_mfma_f32_16x16x32_bf16 v[92:95], v[184:187], a[12:15], v[92:95]
    ds_read_b64_tr_b16 v[168:169], v233 offset:0
    v_mfma_f32_16x16x32_bf16 v[92:95], v[188:191], a[28:31], v[92:95]
    ds_read_b64_tr_b16 v[170:171], v233 offset:8192
    v_mfma_f32_16x16x32_bf16 v[88:91], v[184:187], a[8:11], v[88:91]
    ds_read_b64_tr_b16 v[172:173], v233 offset:2048
    v_mfma_f32_16x16x32_bf16 v[88:91], v[188:191], a[24:27], v[88:91]
    ds_read_b64_tr_b16 v[174:175], v233 offset:10240
    v_mfma_f32_16x16x32_bf16 v[84:87], v[184:187], a[4:7], v[84:87]
    v_mfma_f32_16x16x32_bf16 v[84:87], v[188:191], a[20:23], v[84:87]
    v_mfma_f32_16x16x32_bf16 v[80:83], v[184:187], a[0:3], v[80:83]
    v_mfma_f32_16x16x32_bf16 v[80:83], v[188:191], a[16:19], v[80:83]
    v_mfma_f32_16x16x32_bf16 v[96:99], v[192:195], a[0:3], v[96:99]
    ds_read_b64_tr_b16 v[176:177], v234 offset:0
    v_mfma_f32_16x16x32_bf16 v[96:99], v[196:199], a[16:19], v[96:99]
    ds_read_b64_tr_b16 v[178:179], v234 offset:8192
    v_mfma_f32_16x16x32_bf16 v[100:103], v[192:195], a[4:7], v[100:103]
    ds_read_b64_tr_b16 v[180:181], v234 offset:2048
    v_mfma_f32_16x16x32_bf16 v[100:103], v[196:199], a[20:23], v[100:103]
    ds_read_b64_tr_b16 v[182:183], v234 offset:10240
    v_mfma_f32_16x16x32_bf16 v[104:107], v[192:195], a[8:11], v[104:107]
    v_mfma_f32_16x16x32_bf16 v[104:107], v[196:199], a[24:27], v[104:107]
    v_mfma_f32_16x16x32_bf16 v[108:111], v[192:195], a[12:15], v[108:111]
    v_mfma_f32_16x16x32_bf16 v[108:111], v[196:199], a[28:31], v[108:111]
    v_mfma_f32_16x16x32_bf16 v[124:127], v[200:203], a[12:15], v[124:127]
    ds_read_b64_tr_b16 v[184:185], v235 offset:0
    v_mfma_f32_16x16x32_bf16 v[124:127], v[204:207], a[28:31], v[124:127]
    ds_read_b64_tr_b16 v[186:187], v235 offset:8192
    v_mfma_f32_16x16x32_bf16 v[120:123], v[200:203], a[8:11], v[120:123]
    ds_read_b64_tr_b16 v[188:189], v235 offset:2048
    v_mfma_f32_16x16x32_bf16 v[120:123], v[204:207], a[24:27], v[120:123]
    ds_read_b64_tr_b16 v[190:191], v235 offset:10240
    v_mfma_f32_16x16x32_bf16 v[116:119], v[200:203], a[4:7], v[116:119]
    v_mfma_f32_16x16x32_bf16 v[116:119], v[204:207], a[20:23], v[116:119]
    v_mfma_f32_16x16x32_bf16 v[112:115], v[200:203], a[0:3], v[112:115]
    v_mfma_f32_16x16x32_bf16 v[112:115], v[204:207], a[16:19], v[112:115]
    v_mfma_f32_16x16x32_bf16 v[128:131], v[208:211], a[0:3], v[128:131]
    ds_read_b64_tr_b16 v[192:193], v232 offset:1024
    v_mfma_f32_16x16x32_bf16 v[128:131], v[212:215], a[16:19], v[128:131]
    ds_read_b64_tr_b16 v[194:195], v232 offset:9216
    v_mfma_f32_16x16x32_bf16 v[132:135], v[208:211], a[4:7], v[132:135]
    ds_read_b64_tr_b16 v[196:197], v232 offset:3072
    v_mfma_f32_16x16x32_bf16 v[132:135], v[212:215], a[20:23], v[132:135]
    ds_read_b64_tr_b16 v[198:199], v232 offset:11264
    v_mfma_f32_16x16x32_bf16 v[136:139], v[208:211], a[8:11], v[136:139]
    v_mfma_f32_16x16x32_bf16 v[136:139], v[212:215], a[24:27], v[136:139]
    v_mfma_f32_16x16x32_bf16 v[140:143], v[208:211], a[12:15], v[140:143]
    v_mfma_f32_16x16x32_bf16 v[140:143], v[212:215], a[28:31], v[140:143]
    v_mfma_f32_16x16x32_bf16 v[156:159], v[216:219], a[12:15], v[156:159]
    ds_read_b64_tr_b16 v[200:201], v233 offset:1024
    v_mfma_f32_16x16x32_bf16 v[156:159], v[220:223], a[28:31], v[156:159]
    ds_read_b64_tr_b16 v[202:203], v233 offset:9216
    v_mfma_f32_16x16x32_bf16 v[152:155], v[216:219], a[8:11], v[152:155]
    ds_read_b64_tr_b16 v[204:205], v233 offset:3072
    v_mfma_f32_16x16x32_bf16 v[152:155], v[220:223], a[24:27], v[152:155]
    ds_read_b64_tr_b16 v[206:207], v233 offset:11264
    v_mfma_f32_16x16x32_bf16 v[148:151], v[216:219], a[4:7], v[148:151]
    v_mfma_f32_16x16x32_bf16 v[148:151], v[220:223], a[20:23], v[148:151]
    v_mfma_f32_16x16x32_bf16 v[144:147], v[216:219], a[0:3], v[144:147]
    v_mfma_f32_16x16x32_bf16 v[144:147], v[220:223], a[16:19], v[144:147]
    s_waitcnt vmcnt(0) lgkmcnt(12)
    s_waitcnt lgkmcnt(4)
    v_mfma_f32_16x16x32_bf16 v[40:43], v[160:163], a[40:43], v[40:43]
    ds_read_b64_tr_b16 v[208:209], v234 offset:1024
    ds_read_b64_tr_b16 v[210:211], v234 offset:9216
    v_mfma_f32_16x16x32_bf16 v[40:43], v[164:167], a[56:59], v[40:43]
    ds_read_b64_tr_b16 v[212:213], v234 offset:3072
    ds_read_b64_tr_b16 v[214:215], v234 offset:11264
    v_mfma_f32_16x16x32_bf16 v[44:47], v[160:163], a[44:47], v[44:47]
    ds_read_b64_tr_b16 v[216:217], v235 offset:1024
    ds_read_b64_tr_b16 v[218:219], v235 offset:9216
    v_mfma_f32_16x16x32_bf16 v[44:47], v[164:167], a[60:63], v[44:47]
    ds_read_b64_tr_b16 v[220:221], v235 offset:3072
    ds_read_b64_tr_b16 v[222:223], v235 offset:11264
    v_mfma_f32_16x16x32_bf16 v[104:107], v[192:195], a[40:43], v[104:107]
    v_mfma_f32_16x16x32_bf16 v[104:107], v[196:199], a[56:59], v[104:107]
    v_mfma_f32_16x16x32_bf16 v[108:111], v[192:195], a[44:47], v[108:111]
    v_mfma_f32_16x16x32_bf16 v[108:111], v[196:199], a[60:63], v[108:111]
    s_waitcnt lgkmcnt(8)
    v_mfma_f32_16x16x32_bf16 v[56:59], v[168:171], a[40:43], v[56:59]
    v_mfma_f32_16x16x32_bf16 v[56:59], v[172:175], a[56:59], v[56:59]
    v_mfma_f32_16x16x32_bf16 v[60:63], v[168:171], a[44:47], v[60:63]
    v_cvt_pk_bf16_f32 v40, v40, v41
    v_cvt_pk_bf16_f32 v41, v42, v43
    v_mfma_f32_16x16x32_bf16 v[60:63], v[172:175], a[60:63], v[60:63]
    v_cvt_pk_bf16_f32 v42, v104, v105
    v_cvt_pk_bf16_f32 v43, v106, v107
    v_mfma_f32_16x16x32_bf16 v[120:123], v[200:203], a[40:43], v[120:123]
    ds_write_b128 v230, v[40:43] offset:0
    v_cvt_pk_bf16_f32 v44, v44, v45
    v_mfma_f32_16x16x32_bf16 v[120:123], v[204:207], a[56:59], v[120:123]
    v_cvt_pk_bf16_f32 v45, v46, v47
    v_cvt_pk_bf16_f32 v46, v108, v109
    v_mfma_f32_16x16x32_bf16 v[124:127], v[200:203], a[44:47], v[124:127]
    v_cvt_pk_bf16_f32 v47, v110, v111
    ds_write_b128 v230, v[44:47] offset:1024
    v_mfma_f32_16x16x32_bf16 v[124:127], v[204:207], a[60:63], v[124:127]
    s_waitcnt lgkmcnt(6)
    v_mfma_f32_16x16x32_bf16 v[72:75], v[176:179], a[40:43], v[72:75]
    v_mfma_f32_16x16x32_bf16 v[72:75], v[180:183], a[56:59], v[72:75]
    v_mfma_f32_16x16x32_bf16 v[76:79], v[176:179], a[44:47], v[76:79]
    v_cvt_pk_bf16_f32 v56, v56, v57
    v_cvt_pk_bf16_f32 v57, v58, v59
    v_mfma_f32_16x16x32_bf16 v[76:79], v[180:183], a[60:63], v[76:79]
    v_cvt_pk_bf16_f32 v58, v120, v121
    v_cvt_pk_bf16_f32 v59, v122, v123
    v_mfma_f32_16x16x32_bf16 v[136:139], v[208:211], a[40:43], v[136:139]
    ds_write_b128 v230, v[56:59] offset:2048
    v_cvt_pk_bf16_f32 v60, v60, v61
    v_mfma_f32_16x16x32_bf16 v[136:139], v[212:215], a[56:59], v[136:139]
    v_cvt_pk_bf16_f32 v61, v62, v63
    v_cvt_pk_bf16_f32 v62, v124, v125
    v_mfma_f32_16x16x32_bf16 v[140:143], v[208:211], a[44:47], v[140:143]
    v_cvt_pk_bf16_f32 v63, v126, v127
    ds_write_b128 v230, v[60:63] offset:3072
    v_mfma_f32_16x16x32_bf16 v[140:143], v[212:215], a[60:63], v[140:143]
    s_waitcnt lgkmcnt(4)
    v_mfma_f32_16x16x32_bf16 v[88:91], v[184:187], a[40:43], v[88:91]
    v_mfma_f32_16x16x32_bf16 v[88:91], v[188:191], a[56:59], v[88:91]
    v_mfma_f32_16x16x32_bf16 v[92:95], v[184:187], a[44:47], v[92:95]
    s_waitcnt vmcnt(63) lgkmcnt(0)
    s_barrier
    ds_read_b128 v[104:107], v231 offset:0
    v_mfma_f32_16x16x32_bf16 v[92:95], v[188:191], a[60:63], v[92:95]
    ds_read_b128 v[108:111], v231 offset:1024
    v_cvt_pk_bf16_f32 v72, v72, v73
    v_mfma_f32_16x16x32_bf16 v[152:155], v[216:219], a[40:43], v[152:155]
    v_cvt_pk_bf16_f32 v73, v74, v75
    v_cvt_pk_bf16_f32 v74, v136, v137
    v_mfma_f32_16x16x32_bf16 v[152:155], v[220:223], a[56:59], v[152:155]
    v_cvt_pk_bf16_f32 v75, v138, v139
    ds_write_b128 v230, v[72:75] offset:4096
    v_mfma_f32_16x16x32_bf16 v[156:159], v[216:219], a[44:47], v[156:159]
    v_cvt_pk_bf16_f32 v76, v76, v77
    v_cvt_pk_bf16_f32 v77, v78, v79
    v_mfma_f32_16x16x32_bf16 v[156:159], v[220:223], a[60:63], v[156:159]
    v_cvt_pk_bf16_f32 v78, v140, v141
    v_cvt_pk_bf16_f32 v79, v142, v143
    v_mfma_f32_16x16x32_bf16 v[32:35], v[160:163], a[32:35], v[32:35]
    ds_write_b128 v230, v[76:79] offset:5120
    v_cvt_pk_bf16_f32 v88, v88, v89
    v_mfma_f32_16x16x32_bf16 v[32:35], v[164:167], a[48:51], v[32:35]
    v_cvt_pk_bf16_f32 v89, v90, v91
    v_cvt_pk_bf16_f32 v90, v152, v153
    v_mfma_f32_16x16x32_bf16 v[36:39], v[160:163], a[36:39], v[36:39]
    v_cvt_pk_bf16_f32 v91, v154, v155
    ds_write_b128 v230, v[88:91] offset:6144
    v_mfma_f32_16x16x32_bf16 v[36:39], v[164:167], a[52:55], v[36:39]
    v_cvt_pk_bf16_f32 v92, v92, v93
    v_cvt_pk_bf16_f32 v93, v94, v95
    v_mfma_f32_16x16x32_bf16 v[96:99], v[192:195], a[32:35], v[96:99]
    v_cvt_pk_bf16_f32 v94, v156, v157
    v_cvt_pk_bf16_f32 v95, v158, v159
    v_mfma_f32_16x16x32_bf16 v[96:99], v[196:199], a[48:51], v[96:99]
    ds_write_b128 v230, v[92:95] offset:7168
    ds_read_b128 v[120:123], v231 offset:2048
    v_mfma_f32_16x16x32_bf16 v[100:103], v[192:195], a[36:39], v[100:103]
    ds_read_b128 v[124:127], v231 offset:3072
    v_mfma_f32_16x16x32_bf16 v[100:103], v[196:199], a[52:55], v[100:103]
    s_waitcnt lgkmcnt(6)
    v_mfma_f32_16x16x32_bf16 v[32:35], v[226:229], v[104:107], v[32:35]
    v_mfma_f32_16x16x32_bf16 v[96:99], v[224:227], v[104:107], v[96:99]
    v_mfma_f32_16x16x32_bf16 v[36:39], v[226:229], v[108:111], v[36:39]
    v_mfma_f32_16x16x32_bf16 v[100:103], v[224:227], v[108:111], v[100:103]
    v_mfma_f32_16x16x32_bf16 v[48:51], v[168:171], a[32:35], v[48:51]
    v_mfma_f32_16x16x32_bf16 v[48:51], v[172:175], a[48:51], v[48:51]
    v_mfma_f32_16x16x32_bf16 v[52:55], v[168:171], a[36:39], v[52:55]
    s_waitcnt lgkmcnt(0)
    s_barrier
    v_cvt_pk_bf16_f32 v32, v32, v33
    v_mfma_f32_16x16x32_bf16 v[52:55], v[172:175], a[52:55], v[52:55]
    v_cvt_pk_bf16_f32 v33, v34, v35
    v_cvt_pk_bf16_f32 v34, v96, v97
    v_mfma_f32_16x16x32_bf16 v[112:115], v[200:203], a[32:35], v[112:115]
    v_cvt_pk_bf16_f32 v35, v98, v99
    buffer_store_dwordx4 v[32:35], v236, s[4:7], s94 offen offset:0 sc1
    v_mfma_f32_16x16x32_bf16 v[112:115], v[204:207], a[48:51], v[112:115]
    v_cvt_pk_bf16_f32 v36, v36, v37
    v_cvt_pk_bf16_f32 v37, v38, v39
    v_mfma_f32_16x16x32_bf16 v[116:119], v[200:203], a[36:39], v[116:119]
    v_cvt_pk_bf16_f32 v38, v100, v101
    v_cvt_pk_bf16_f32 v39, v102, v103
    v_mfma_f32_16x16x32_bf16 v[116:119], v[204:207], a[52:55], v[116:119]
    buffer_store_dwordx4 v[36:39], v236, s[4:7], s95 offen offset:0 sc1
    v_mfma_f32_16x16x32_bf16 v[48:51], v[226:229], v[120:123], v[48:51]
    ds_read_b128 v[136:139], v231 offset:4096
    ds_read_b128 v[140:143], v231 offset:5120
    v_mfma_f32_16x16x32_bf16 v[112:115], v[224:227], v[120:123], v[112:115]
    ds_read_b128 v[152:155], v231 offset:6144
    ds_read_b128 v[156:159], v231 offset:7168
    v_mfma_f32_16x16x32_bf16 v[52:55], v[226:229], v[124:127], v[52:55]
    v_mfma_f32_16x16x32_bf16 v[116:119], v[224:227], v[124:127], v[116:119]
    v_mfma_f32_16x16x32_bf16 v[64:67], v[176:179], a[32:35], v[64:67]
    v_mfma_f32_16x16x32_bf16 v[64:67], v[180:183], a[48:51], v[64:67]
    v_mfma_f32_16x16x32_bf16 v[68:71], v[176:179], a[36:39], v[68:71]
    v_mfma_f32_16x16x32_bf16 v[68:71], v[180:183], a[52:55], v[68:71]
    v_cvt_pk_bf16_f32 v48, v48, v49
    v_cvt_pk_bf16_f32 v49, v50, v51
    v_mfma_f32_16x16x32_bf16 v[128:131], v[208:211], a[32:35], v[128:131]
    v_cvt_pk_bf16_f32 v50, v112, v113
    v_cvt_pk_bf16_f32 v51, v114, v115
    v_mfma_f32_16x16x32_bf16 v[128:131], v[212:215], a[48:51], v[128:131]
    buffer_store_dwordx4 v[48:51], v236, s[4:7], s94 offen offset:1024 sc1
    v_mfma_f32_16x16x32_bf16 v[132:135], v[208:211], a[36:39], v[132:135]
    v_cvt_pk_bf16_f32 v52, v52, v53
    v_cvt_pk_bf16_f32 v53, v54, v55
    v_mfma_f32_16x16x32_bf16 v[132:135], v[212:215], a[52:55], v[132:135]
    v_cvt_pk_bf16_f32 v54, v116, v117
    v_cvt_pk_bf16_f32 v55, v118, v119
    s_waitcnt lgkmcnt(2)
    v_mfma_f32_16x16x32_bf16 v[64:67], v[226:229], v[136:139], v[64:67]
    buffer_store_dwordx4 v[52:55], v236, s[4:7], s95 offen offset:1024 sc1
    v_mfma_f32_16x16x32_bf16 v[128:131], v[224:227], v[136:139], v[128:131]
    v_mfma_f32_16x16x32_bf16 v[68:71], v[226:229], v[140:143], v[68:71]
    v_mfma_f32_16x16x32_bf16 v[132:135], v[224:227], v[140:143], v[132:135]
    v_mfma_f32_16x16x32_bf16 v[80:83], v[184:187], a[32:35], v[80:83]
    v_mfma_f32_16x16x32_bf16 v[80:83], v[188:191], a[48:51], v[80:83]
    v_mfma_f32_16x16x32_bf16 v[84:87], v[184:187], a[36:39], v[84:87]
    v_mfma_f32_16x16x32_bf16 v[84:87], v[188:191], a[52:55], v[84:87]
    v_mfma_f32_16x16x32_bf16 v[144:147], v[216:219], a[32:35], v[144:147]
    v_cvt_pk_bf16_f32 v64, v64, v65
    v_cvt_pk_bf16_f32 v65, v66, v67
    v_mfma_f32_16x16x32_bf16 v[144:147], v[220:223], a[48:51], v[144:147]
    v_cvt_pk_bf16_f32 v66, v128, v129
    v_cvt_pk_bf16_f32 v67, v130, v131
    v_mfma_f32_16x16x32_bf16 v[148:151], v[216:219], a[36:39], v[148:151]
    buffer_store_dwordx4 v[64:67], v236, s[4:7], s94 offen offset:2048 sc1
    v_mfma_f32_16x16x32_bf16 v[148:151], v[220:223], a[52:55], v[148:151]
    v_cvt_pk_bf16_f32 v68, v68, v69
    v_cvt_pk_bf16_f32 v69, v70, v71
    s_waitcnt lgkmcnt(0)
    v_mfma_f32_16x16x32_bf16 v[80:83], v[226:229], v[152:155], v[80:83]
    v_cvt_pk_bf16_f32 v70, v132, v133
    v_cvt_pk_bf16_f32 v71, v134, v135
    v_mfma_f32_16x16x32_bf16 v[144:147], v[224:227], v[152:155], v[144:147]
    buffer_store_dwordx4 v[68:71], v236, s[4:7], s95 offen offset:2048 sc1
    v_mfma_f32_16x16x32_bf16 v[84:87], v[226:229], v[156:159], v[84:87]
    v_mfma_f32_16x16x32_bf16 v[148:151], v[224:227], v[156:159], v[148:151]
    s_nop 0
    s_nop 0
    v_cvt_pk_bf16_f32 v80, v80, v81
    v_cvt_pk_bf16_f32 v81, v82, v83
    s_nop 0
    v_cvt_pk_bf16_f32 v82, v144, v145
    v_cvt_pk_bf16_f32 v83, v146, v147
    buffer_store_dwordx4 v[80:83], v236, s[4:7], s94 offen offset:3072 sc1
    v_cvt_pk_bf16_f32 v84, v84, v85
    v_cvt_pk_bf16_f32 v85, v86, v87
    v_cvt_pk_bf16_f32 v86, v148, v149
    v_cvt_pk_bf16_f32 v87, v150, v151
    buffer_store_dwordx4 v[84:87], v236, s[4:7], s95 offen offset:3072 sc1
    v_accvgpr_read_b32 v32, a152
    v_accvgpr_read_b32 v33, a153
    v_accvgpr_read_b32 v34, a154
    v_accvgpr_read_b32 v35, a155
    v_accvgpr_read_b32 v36, a156
    v_accvgpr_read_b32 v37, a157
    v_accvgpr_read_b32 v38, a158
    v_accvgpr_read_b32 v39, a159
    v_accvgpr_read_b32 v40, a160
    v_accvgpr_read_b32 v41, a161
    v_accvgpr_read_b32 v42, a162
    v_accvgpr_read_b32 v43, a163
    v_accvgpr_read_b32 v44, a164
    v_accvgpr_read_b32 v45, a165
    v_accvgpr_read_b32 v46, a166
    v_accvgpr_read_b32 v47, a167
    v_accvgpr_read_b32 v253, a168
    v_accvgpr_read_b32 v254, a169
    v_rcp_f32 v255, v253
    s_nop 0
    v_readlane_b32 s92, v255, 0
    v_readlane_b32 s93, v255, 16
    v_readlane_b32 s94, v254, 0
    v_readlane_b32 s95, v254, 16
    s_add_u32 s8, s4, 0xc00000
    s_addc_u32 s9, s5, 0
    s_mov_b32 s10, 0x800000
    s_add_u32 s4, s4, 0x2400000
    s_addc_u32 s5, s5, 0
    s_add_u32 s48, s48, 0x24000
    s_cmp_eq_u32 s42, 0
    s_cselect_b32 s42, 1, 2
    s_cbranch_scc0 L_last
    s_branch L_layer
L_interlea_hc39b:
    s_mov_b32 s56, 0
L_interlea_hc39p:
    v_mov_b32 v17, 0
    buffer_atomic_add v17, v14, s[28:31], s93 offen offset:0 sc0 sc1
    s_waitcnt vmcnt(0)
    v_readfirstlane_b32 s57, v17
    s_cmp_ge_u32 s57, s82
    s_cbranch_scc1 L_interlea_hc39
    s_add_u32 s56, s56, 1
    s_cmp_lt_u32 s56, 0x40000
    s_cbranch_scc1 L_interlea_hc39p
    s_branch L_interlea_hc39
L_interlea_hc40b:
    s_mov_b32 s56, 0
L_interlea_hc40p:
    v_mov_b32 v17, 0
    buffer_atomic_add v17, v14, s[28:31], s93 offen offset:1024 sc0 sc1
    s_waitcnt vmcnt(0)
    v_readfirstlane_b32 s57, v17
    s_cmp_ge_u32 s57, s82
    s_cbranch_scc1 L_interlea_hc40
    s_add_u32 s56, s56, 1
    s_cmp_lt_u32 s56, 0x40000
    s_cbranch_scc1 L_interlea_hc40p
    s_branch L_interlea_hc40
L_final:
    s_lshl_b32 s56, s41, 20
    s_lshl_b32 s57, s40, 11
    s_add_u32 s56, s56, s57
    s_add_u32 s57, s56, 0x80000
    s_waitcnt vmcnt(7)
    v_lshlrev_b32 v17, 16, v48
    v_and_b32 v48, 0xffff0000, v48
    v_fmac_f32 v64, s92, v17
    v_fmac_f32 v68, s92, v48
    v_lshlrev_b32 v17, 16, v49
    v_and_b32 v49, 0xffff0000, v49
    v_fmac_f32 v72, s92, v17
    v_fmac_f32 v76, s92, v49
    v_lshlrev_b32 v17, 16, v50
    v_and_b32 v50, 0xffff0000, v50
    v_fmac_f32 v66, s92, v17
    v_fmac_f32 v70, s92, v50
    v_lshlrev_b32 v17, 16, v51
    v_and_b32 v51, 0xffff0000, v51
    v_fmac_f32 v74, s92, v17
    v_fmac_f32 v78, s92, v51
    s_waitcnt vmcnt(6)
    v_lshlrev_b32 v17, 16, v52
    v_and_b32 v52, 0xffff0000, v52
    v_fmac_f32 v65, s92, v17
    v_fmac_f32 v69, s92, v52
    v_lshlrev_b32 v17, 16, v53
    v_and_b32 v53, 0xffff0000, v53
    v_fmac_f32 v73, s92, v17
    v_fmac_f32 v77, s92, v53
    v_lshlrev_b32 v17, 16, v54
    v_and_b32 v54, 0xffff0000, v54
    v_fmac_f32 v67, s92, v17
    v_fmac_f32 v71, s92, v54
    v_lshlrev_b32 v17, 16, v55
    v_and_b32 v55, 0xffff0000, v55
    v_fmac_f32 v75, s92, v17
    v_fmac_f32 v79, s92, v55
    s_waitcnt vmcnt(5)
    v_lshlrev_b32 v17, 16, v56
    v_and_b32 v56, 0xffff0000, v56
    v_fmac_f32 v80, s93, v17
    v_fmac_f32 v84, s93, v56
    v_lshlrev_b32 v17, 16, v57
    v_and_b32 v57, 0xffff0000, v57
    v_fmac_f32 v88, s93, v17
    v_fmac_f32 v92, s93, v57
    v_lshlrev_b32 v17, 16, v58
    v_and_b32 v58, 0xffff0000, v58
    v_fmac_f32 v82, s93, v17
    v_fmac_f32 v86, s93, v58
    v_lshlrev_b32 v17, 16, v59
    v_and_b32 v59, 0xffff0000, v59
    v_fmac_f32 v90, s93, v17
    v_fmac_f32 v94, s93, v59
    s_waitcnt vmcnt(4)
    v_lshlrev_b32 v17, 16, v60
    v_and_b32 v60, 0xffff0000, v60
    v_fmac_f32 v81, s93, v17
    v_fmac_f32 v85, s93, v60
    v_lshlrev_b32 v17, 16, v61
    v_and_b32 v61, 0xffff0000, v61
    v_fmac_f32 v89, s93, v17
    v_fmac_f32 v93, s93, v61
    v_lshlrev_b32 v17, 16, v62
    v_and_b32 v62, 0xffff0000, v62
    v_fmac_f32 v83, s93, v17
    v_fmac_f32 v87, s93, v62
    v_lshlrev_b32 v17, 16, v63
    v_and_b32 v63, 0xffff0000, v63
    v_fmac_f32 v91, s93, v17
    v_fmac_f32 v95, s93, v63
    s_waitcnt vmcnt(3)
    v_lshlrev_b32 v17, 16, v208
    v_and_b32 v208, 0xffff0000, v208
    v_fmac_f32 v64, s92, v17
    v_fmac_f32 v68, s92, v208
    v_cvt_pk_bf16_f32 v208, v64, v68
    v_lshlrev_b32 v17, 16, v209
    v_and_b32 v209, 0xffff0000, v209
    v_fmac_f32 v72, s92, v17
    v_fmac_f32 v76, s92, v209
    v_cvt_pk_bf16_f32 v209, v72, v76
    buffer_store_dwordx2 v[208:209], v240, s[24:27], s56 offen offset:0 sc1
    v_lshlrev_b32 v17, 16, v210
    v_and_b32 v210, 0xffff0000, v210
    v_fmac_f32 v66, s92, v17
    v_fmac_f32 v70, s92, v210
    v_cvt_pk_bf16_f32 v210, v66, v70
    v_lshlrev_b32 v17, 16, v211
    v_and_b32 v211, 0xffff0000, v211
    v_fmac_f32 v74, s92, v17
    v_fmac_f32 v78, s92, v211
    v_cvt_pk_bf16_f32 v211, v74, v78
    buffer_store_dwordx2 v[210:211], v240, s[24:27], s56 offen offset:256 sc1
    s_waitcnt vmcnt(4)
    v_lshlrev_b32 v17, 16, v212
    v_and_b32 v212, 0xffff0000, v212
    v_fmac_f32 v65, s92, v17
    v_fmac_f32 v69, s92, v212
    v_cvt_pk_bf16_f32 v212, v65, v69
    v_lshlrev_b32 v17, 16, v213
    v_and_b32 v213, 0xffff0000, v213
    v_fmac_f32 v73, s92, v17
    v_fmac_f32 v77, s92, v213
    v_cvt_pk_bf16_f32 v213, v73, v77
    buffer_store_dwordx2 v[212:213], v240, s[24:27], s56 offen offset:128 sc1
    v_lshlrev_b32 v17, 16, v214
    v_and_b32 v214, 0xffff0000, v214
    v_fmac_f32 v67, s92, v17
    v_fmac_f32 v71, s92, v214
    v_cvt_pk_bf16_f32 v214, v67, v71
    v_lshlrev_b32 v17, 16, v215
    v_and_b32 v215, 0xffff0000, v215
    v_fmac_f32 v75, s92, v17
    v_fmac_f32 v79, s92, v215
    v_cvt_pk_bf16_f32 v215, v75, v79
    buffer_store_dwordx2 v[214:215], v240, s[24:27], s56 offen offset:384 sc1
    s_waitcnt vmcnt(5)
    v_lshlrev_b32 v17, 16, v216
    v_and_b32 v216, 0xffff0000, v216
    v_fmac_f32 v80, s93, v17
    v_fmac_f32 v84, s93, v216
    v_cvt_pk_bf16_f32 v216, v80, v84
    v_lshlrev_b32 v17, 16, v217
    v_and_b32 v217, 0xffff0000, v217
    v_fmac_f32 v88, s93, v17
    v_fmac_f32 v92, s93, v217
    v_cvt_pk_bf16_f32 v217, v88, v92
    buffer_store_dwordx2 v[216:217], v240, s[24:27], s57 offen offset:0 sc1
    v_lshlrev_b32 v17, 16, v218
    v_and_b32 v218, 0xffff0000, v218
    v_fmac_f32 v82, s93, v17
    v_fmac_f32 v86, s93, v218
    v_cvt_pk_bf16_f32 v218, v82, v86
    v_lshlrev_b32 v17, 16, v219
    v_and_b32 v219, 0xffff0000, v219
    v_fmac_f32 v90, s93, v17
    v_fmac_f32 v94, s93, v219
    v_cvt_pk_bf16_f32 v219, v90, v94
    buffer_store_dwordx2 v[218:219], v240, s[24:27], s57 offen offset:256 sc1
    s_waitcnt vmcnt(6)
    v_lshlrev_b32 v17, 16, v220
    v_and_b32 v220, 0xffff0000, v220
    v_fmac_f32 v81, s93, v17
    v_fmac_f32 v85, s93, v220
    v_cvt_pk_bf16_f32 v220, v81, v85
    v_lshlrev_b32 v17, 16, v221
    v_and_b32 v221, 0xffff0000, v221
    v_fmac_f32 v89, s93, v17
    v_fmac_f32 v93, s93, v221
    v_cvt_pk_bf16_f32 v221, v89, v93
    buffer_store_dwordx2 v[220:221], v240, s[24:27], s57 offen offset:128 sc1
    v_lshlrev_b32 v17, 16, v222
    v_and_b32 v222, 0xffff0000, v222
    v_fmac_f32 v83, s93, v17
    v_fmac_f32 v87, s93, v222
    v_cvt_pk_bf16_f32 v222, v83, v87
    v_lshlrev_b32 v17, 16, v223
    v_and_b32 v223, 0xffff0000, v223
    v_fmac_f32 v91, s93, v17
    v_fmac_f32 v95, s93, v223
    v_cvt_pk_bf16_f32 v223, v91, v95
    buffer_store_dwordx2 v[222:223], v240, s[24:27], s57 offen offset:384 sc1
L_fin:
L_end:
    s_endpgm

.section .rodata,"a"
.p2align 6
.amdhsa_kernel interleave_layers__spectral_gfnet__glu_gated_bilinear__prompt_kernel
  .amdhsa_next_free_vgpr 512
  .amdhsa_next_free_sgpr 102
  .amdhsa_accum_offset 256
  .amdhsa_group_segment_fixed_size 0
  .amdhsa_kernarg_size 80
  .amdhsa_user_sgpr_count 2
  .amdhsa_user_sgpr_kernarg_segment_ptr 1
  .amdhsa_system_sgpr_workgroup_id_x 1
  .amdhsa_float_denorm_mode_32 3
.end_amdhsa_kernel
```
